```python
import torch

def _softmax(x, axis=-1):
    return torch.softmax(x, dim=axis)

def _gelu(x):
    return torch.nn.functional.gelu(x, approximate='tanh')

def _silu(x):
    return torch.nn.functional.silu(x)

def _sigmoid(x):
    return torch.sigmoid(x)

def _layernorm(x, axis=-1, eps=1e-05):
    m = x.mean(dim=axis, keepdim=True)
    v = x.var(dim=axis, keepdim=True, unbiased=False)
    return (x - m) / torch.sqrt(v + eps)

def _scatter_add(tgt, idx, src, axis=0):
    return tgt.clone().index_add_(axis, idx, src)

def _segment_sum(src, seg, n):
    out = torch.zeros((n,) + src.shape[1:], dtype=src.dtype)
    return out.index_add_(0, seg, src)

def _pad(x, pw):
    flat = tuple((v for pair in reversed(pw) for v in pair))
    return torch.nn.functional.pad(x, flat)
kernel_name = 'interleave_layers__spectral_gfnet__memory_aug_recurrent_mem_tr__prompt'

def setup_inputs():

    _w = lambda a: (lambda t: t.to(torch.bfloat16) if t.is_floating_point() else t)(torch.as_tensor(a))

    def _A_setup():
        B, S, D = (1, 2048, 512)
        Df = D // 2 + 1
        return {'x': _w((lambda *s: torch.randn(*s, dtype=torch.bfloat16) * 0.05)(B, S, D)), 'w_r': _w((lambda *s: torch.randn(*s, dtype=torch.bfloat16) * 0.4)(S, Df) * 0.02), 'w_i': _w((lambda *s: torch.randn(*s, dtype=torch.bfloat16) * 0.4)(S, Df) * 0.02)}
    _A_in = _A_setup()

    def _B_setup():
        B, S, Dm = (1, 2048, 512)
        H, Dh = (32, 128)
        M, seg = (8, 32)
        seg = min(seg, S)
        S = S // seg * seg
        return {'x': _w((lambda *s: torch.randn(*s, dtype=torch.bfloat16) * 0.05)(B, S, Dm)), 'mem0': _w((lambda *s: torch.randn(*s, dtype=torch.bfloat16) * 0.2)(B, M, Dm)), 'Wq': _w((lambda *s: torch.randn(*s, dtype=torch.bfloat16) * 1.6)(Dm, H, Dh) * Dm ** (-0.5)), 'Wk': _w((lambda *s: torch.randn(*s, dtype=torch.bfloat16) * 1.6)(Dm, H, Dh) * Dm ** (-0.5)), 'Wv': _w((lambda *s: torch.randn(*s, dtype=torch.bfloat16) * 0.2)(Dm, H, Dh) * Dm ** (-0.5)), 'Wo': _w((lambda *s: torch.randn(*s, dtype=torch.bfloat16) * 0.2)(H, Dh, Dm) * (H * Dh) ** (-0.5)), 'seg_len': seg}
    _B_in = _B_setup()
    return {'A_x': _A_in['x'], 'A_w_r': _A_in['w_r'], 'A_w_i': _A_in['w_i'], 'B_x': _B_in['x'], 'B_mem0': _B_in['mem0'], 'B_Wq': _B_in['Wq'], 'B_Wk': _B_in['Wk'], 'B_Wv': _B_in['Wv'], 'B_Wo': _B_in['Wo'], 'B_seg_len': _B_in['seg_len']}

def reference(A_x, A_w_r, A_w_i, B_x, B_mem0, B_Wq, B_Wk, B_Wv, B_Wo, B_seg_len):

    def _A_ref(x, w_r, w_i):
        B, S, D = x.shape
        X = (lambda x, axes=(-2, -1): torch.fft.rfft2(x.float(), dim=axes))(x, axes=(-2, -1))
        W = w_r + 1j * w_i
        X = X * W
        y = (lambda x, s, axes=(-2, -1): torch.fft.irfft2(x, s=s, dim=axes).to(torch.bfloat16))(X, (S, D), axes=(-2, -1))
        return y

    def _B_ref(x, mem0, Wq, Wk, Wv, Wo, seg_len):
        B, S, Dm = x.shape
        H, Dh = (Wq.shape[1], Wq.shape[2])
        M = mem0.shape[1]
        scale = Dh ** (-0.5)
        n_seg = S // seg_len
        L = M + seg_len
        idx = torch.arange(L)
        mask = (idx[:, None] < M) | (idx[:, None] >= idx[None, :])
        mem = mem0
        outs = []
        for s in range(n_seg):
            xs = x[:, s * seg_len:(s + 1) * seg_len, :].clone()
            h = torch.concatenate([mem, xs], axis=1)
            q = torch.einsum('btd,dhe->bhte', h, Wq)
            k = torch.einsum('btd,dhe->bhte', h, Wk)
            v = torch.einsum('btd,dhe->bhte', h, Wv)
            scores = torch.einsum('bhqe,bhke->bhqk', q, k) * scale
            scores = torch.where(mask[None, None], scores, -1000000000.0)
            p = _softmax(scores, axis=-1)
            o = torch.einsum('bhqk,bhke->bhqe', p, v)
            o = torch.einsum('bhte,hed->btd', o, Wo)
            mem = o[:, :M, :].clone()
            outs.append(o[:, M:, :])
        return torch.concatenate(outs, axis=1)
    x = A_x
    x = x + _A_ref(_layernorm(x, axis=-1), A_w_r, A_w_i)
    x = x + _B_ref(_layernorm(x, axis=-1), B_mem0, B_Wq, B_Wk, B_Wv, B_Wo, B_seg_len)
    x = x + _A_ref(_layernorm(x, axis=-1), A_w_r, A_w_i)
    x = x + _B_ref(_layernorm(x, axis=-1), B_mem0, B_Wq, B_Wk, B_Wv, B_Wo, B_seg_len)
    return x
```

```asm
; @launch kernel=prep_kernel grid=(256,1,1) block=(256,1,1) lds=147456
; @launch kernel=main_kernel grid=(256,1,1) block=(256,1,1) lds=163840
.amdgcn_target "amdgcn-amd-amdhsa--gfx950"
.text
.globl prep_kernel
.p2align 8
.type prep_kernel,@function
prep_kernel:
s_cmp_ge_u32 s2, 256
s_cbranch_scc1 K0_end
s_load_dwordx2 s[4:5], s[0:1], 0
s_load_dwordx2 s[6:7], s[0:1], 80
s_load_dwordx2 s[8:9], s[0:1], 96
v_lshrrev_b32 v1, 6, v0
s_nop 0
v_readfirstlane_b32 s10, v1
s_load_dwordx4 s[24:27], s[0:1], 8
s_load_dwordx2 s[28:29], s[0:1], 32
v_mov_b32 v100, v0
v_and_b32 v0, 63, v0
s_and_b32 s11, s2, 31
s_lshr_b32 s12, s2, 5
s_waitcnt lgkmcnt(0)
v_lshrrev_b32 v3, 2, v0
v_lshlrev_b32 v1, 10, v3
v_and_b32 v3, 3, v0
v_lshl_add_u32 v1, v3, 4, v1
v_and_b32 v3, 32, v0
v_xor_b32 v1, v3, v1
s_lshl_b32 s14, s12, 18
s_lshl_b32 s15, s10, 16
s_add_u32 s14, s14, s15
s_lshl_b32 s37, s10, 15
s_add_u32 s37, s37, 16384
v_and_b32 v3, 15, v0
v_lshlrev_b32 v2, 6, v3
v_lshrrev_b32 v4, 4, v0
v_lshl_add_u32 v2, v4, 4, v2
v_and_b32 v3, 8, v0
v_lshlrev_b32 v3, 2, v3
v_xor_b32 v2, v3, v2
v_add_u32 v2, s37, v2
s_add_u32 s30, s4, s14
s_addc_u32 s31, s5, 0
s_add_u32 m0, s37, 0
s_nop 0
global_load_lds_dwordx4 v1, s[30:31] offset:0
s_add_u32 m0, s37, 960
s_nop 0
global_load_lds_dwordx4 v1, s[30:31] offset:64
s_add_u32 m0, s37, 1920
s_nop 0
global_load_lds_dwordx4 v1, s[30:31] offset:128
s_add_u32 m0, s37, 2880
s_nop 0
global_load_lds_dwordx4 v1, s[30:31] offset:192
s_add_u32 m0, s37, 3840
s_nop 0
global_load_lds_dwordx4 v1, s[30:31] offset:256
s_add_u32 m0, s37, 4800
s_nop 0
global_load_lds_dwordx4 v1, s[30:31] offset:320
s_add_u32 m0, s37, 5760
s_nop 0
global_load_lds_dwordx4 v1, s[30:31] offset:384
s_add_u32 m0, s37, 6720
s_nop 0
global_load_lds_dwordx4 v1, s[30:31] offset:448
s_add_u32 m0, s37, 7680
s_nop 0
global_load_lds_dwordx4 v1, s[30:31] offset:512
s_add_u32 m0, s37, 8640
s_nop 0
global_load_lds_dwordx4 v1, s[30:31] offset:576
s_add_u32 m0, s37, 9600
s_nop 0
global_load_lds_dwordx4 v1, s[30:31] offset:640
s_add_u32 m0, s37, 10560
s_nop 0
global_load_lds_dwordx4 v1, s[30:31] offset:704
s_add_u32 m0, s37, 11520
s_nop 0
global_load_lds_dwordx4 v1, s[30:31] offset:768
s_add_u32 m0, s37, 12480
s_nop 0
global_load_lds_dwordx4 v1, s[30:31] offset:832
s_add_u32 m0, s37, 13440
s_nop 0
global_load_lds_dwordx4 v1, s[30:31] offset:896
s_add_u32 m0, s37, 14400
s_nop 0
global_load_lds_dwordx4 v1, s[30:31] offset:960
s_add_u32 s30, s30, 0x4000
s_addc_u32 s31, s31, 0
s_add_u32 m0, s37, 16384
s_nop 0
global_load_lds_dwordx4 v1, s[30:31] offset:0
s_add_u32 m0, s37, 17344
s_nop 0
global_load_lds_dwordx4 v1, s[30:31] offset:64
s_add_u32 m0, s37, 18304
s_nop 0
global_load_lds_dwordx4 v1, s[30:31] offset:128
s_add_u32 m0, s37, 19264
s_nop 0
global_load_lds_dwordx4 v1, s[30:31] offset:192
s_add_u32 m0, s37, 20224
s_nop 0
global_load_lds_dwordx4 v1, s[30:31] offset:256
s_add_u32 m0, s37, 21184
s_nop 0
global_load_lds_dwordx4 v1, s[30:31] offset:320
s_add_u32 m0, s37, 22144
s_nop 0
global_load_lds_dwordx4 v1, s[30:31] offset:384
s_add_u32 m0, s37, 23104
s_nop 0
global_load_lds_dwordx4 v1, s[30:31] offset:448
s_add_u32 m0, s37, 24064
s_nop 0
global_load_lds_dwordx4 v1, s[30:31] offset:512
s_add_u32 m0, s37, 25024
s_nop 0
global_load_lds_dwordx4 v1, s[30:31] offset:576
s_add_u32 m0, s37, 25984
s_nop 0
global_load_lds_dwordx4 v1, s[30:31] offset:640
s_add_u32 m0, s37, 26944
s_nop 0
global_load_lds_dwordx4 v1, s[30:31] offset:704
s_add_u32 m0, s37, 27904
s_nop 0
global_load_lds_dwordx4 v1, s[30:31] offset:768
s_add_u32 m0, s37, 28864
s_nop 0
global_load_lds_dwordx4 v1, s[30:31] offset:832
s_add_u32 m0, s37, 29824
s_nop 0
global_load_lds_dwordx4 v1, s[30:31] offset:896
s_add_u32 m0, s37, 30784
s_nop 0
global_load_lds_dwordx4 v1, s[30:31] offset:960
s_add_u32 s30, s30, 0x4000
s_addc_u32 s31, s31, 0
s_lshr_b32 s14, s2, 3
s_lshr_b32 s15, s14, 3
s_and_b32 s16, s14, 7
s_and_b32 s17, s2, 7
v_and_b32 v101, 31, v100
s_lshl_b32 s18, s17, 5
v_add_u32 v101, s18, v101
v_lshrrev_b32 v102, 5, v100
s_lshl_b32 s18, s15, 4
s_lshl_b32 s19, s16, 8
s_add_u32 s18, s18, s19
v_add_u32 v103, s18, v102
v_mul_u32_u24 v103, 514, v103
v_lshl_add_u32 v103, v101, 1, v103
v_add_u32 v104, 0, v103
global_load_ushort v108, v104, s[24:25]
global_load_ushort v116, v104, s[26:27]
v_add_u32 v104, 32896, v103
global_load_ushort v109, v104, s[24:25]
global_load_ushort v117, v104, s[26:27]
v_add_u32 v104, 65792, v103
global_load_ushort v110, v104, s[24:25]
global_load_ushort v118, v104, s[26:27]
v_add_u32 v104, 98688, v103
global_load_ushort v111, v104, s[24:25]
global_load_ushort v119, v104, s[26:27]
v_add_u32 v104, 4112, v103
global_load_ushort v112, v104, s[24:25]
global_load_ushort v120, v104, s[26:27]
v_add_u32 v104, 37008, v103
global_load_ushort v113, v104, s[24:25]
global_load_ushort v121, v104, s[26:27]
v_add_u32 v104, 69904, v103
global_load_ushort v114, v104, s[24:25]
global_load_ushort v122, v104, s[26:27]
v_add_u32 v104, 102800, v103
global_load_ushort v115, v104, s[24:25]
global_load_ushort v123, v104, s[26:27]
v_and_b32 v84, 15, v0
v_lshrrev_b32 v85, 4, v0
v_lshrrev_b32 v86, 1, v84
s_lshl_b32 s18, s11, 3
v_add_u32 v86, s18, v86
v_and_b32 v90, 1, v84
v_lshlrev_b32 v87, 7, v90
v_cvt_f32_u32 v91, v90
v_cmp_eq_u32 vcc, 0, v86
s_nop 1
v_cndmask_b32 v88, 1.0, v91, vcc
v_cndmask_b32 v87, v87, 0, vcc
v_mov_b32 v90, 256
v_cndmask_b32 v86, v86, v90, vcc
s_lshl_b32 s18, s10, 7
v_lshl_add_u32 v89, v85, 3, s18
v_mad_u32_u24 v89, v89, v86, v87
v_mad_u32_u24 v90, v86, 0, v89
v_and_b32 v90, 511, v90
v_cvt_f32_u32 v90, v90
v_mul_f32 v90, 0x3b000000, v90
v_cos_f32 v90, v90
s_nop 0
v_mul_f32 v90, v90, v88
v_mad_u32_u24 v91, v86, 1, v89
v_and_b32 v91, 511, v91
v_cvt_f32_u32 v91, v91
v_mul_f32 v91, 0x3b000000, v91
v_cos_f32 v91, v91
s_nop 0
v_mul_f32 v91, v91, v88
v_cvt_pk_bf16_f32 v8, v90, v91
v_mad_u32_u24 v90, v86, 2, v89
v_and_b32 v90, 511, v90
v_cvt_f32_u32 v90, v90
v_mul_f32 v90, 0x3b000000, v90
v_cos_f32 v90, v90
s_nop 0
v_mul_f32 v90, v90, v88
v_mad_u32_u24 v91, v86, 3, v89
v_and_b32 v91, 511, v91
v_cvt_f32_u32 v91, v91
v_mul_f32 v91, 0x3b000000, v91
v_cos_f32 v91, v91
s_nop 0
v_mul_f32 v91, v91, v88
v_cvt_pk_bf16_f32 v9, v90, v91
v_mad_u32_u24 v90, v86, 4, v89
v_and_b32 v90, 511, v90
v_cvt_f32_u32 v90, v90
v_mul_f32 v90, 0x3b000000, v90
v_cos_f32 v90, v90
s_nop 0
v_mul_f32 v90, v90, v88
v_mad_u32_u24 v91, v86, 5, v89
v_and_b32 v91, 511, v91
v_cvt_f32_u32 v91, v91
v_mul_f32 v91, 0x3b000000, v91
v_cos_f32 v91, v91
s_nop 0
v_mul_f32 v91, v91, v88
v_cvt_pk_bf16_f32 v10, v90, v91
v_mad_u32_u24 v90, v86, 6, v89
v_and_b32 v90, 511, v90
v_cvt_f32_u32 v90, v90
v_mul_f32 v90, 0x3b000000, v90
v_cos_f32 v90, v90
s_nop 0
v_mul_f32 v90, v90, v88
v_mad_u32_u24 v91, v86, 7, v89
v_and_b32 v91, 511, v91
v_cvt_f32_u32 v91, v91
v_mul_f32 v91, 0x3b000000, v91
v_cos_f32 v91, v91
s_nop 0
v_mul_f32 v91, v91, v88
v_cvt_pk_bf16_f32 v11, v90, v91
v_mad_u32_u24 v90, v86, 32, v89
v_and_b32 v90, 511, v90
v_cvt_f32_u32 v90, v90
v_mul_f32 v90, 0x3b000000, v90
v_cos_f32 v90, v90
s_nop 0
v_mul_f32 v90, v90, v88
v_mad_u32_u24 v91, v86, 33, v89
v_and_b32 v91, 511, v91
v_cvt_f32_u32 v91, v91
v_mul_f32 v91, 0x3b000000, v91
v_cos_f32 v91, v91
s_nop 0
v_mul_f32 v91, v91, v88
v_cvt_pk_bf16_f32 v12, v90, v91
v_mad_u32_u24 v90, v86, 34, v89
v_and_b32 v90, 511, v90
v_cvt_f32_u32 v90, v90
v_mul_f32 v90, 0x3b000000, v90
v_cos_f32 v90, v90
s_nop 0
v_mul_f32 v90, v90, v88
v_mad_u32_u24 v91, v86, 35, v89
v_and_b32 v91, 511, v91
v_cvt_f32_u32 v91, v91
v_mul_f32 v91, 0x3b000000, v91
v_cos_f32 v91, v91
s_nop 0
v_mul_f32 v91, v91, v88
v_cvt_pk_bf16_f32 v13, v90, v91
v_mad_u32_u24 v90, v86, 36, v89
v_and_b32 v90, 511, v90
v_cvt_f32_u32 v90, v90
v_mul_f32 v90, 0x3b000000, v90
v_cos_f32 v90, v90
s_nop 0
v_mul_f32 v90, v90, v88
v_mad_u32_u24 v91, v86, 37, v89
v_and_b32 v91, 511, v91
v_cvt_f32_u32 v91, v91
v_mul_f32 v91, 0x3b000000, v91
v_cos_f32 v91, v91
s_nop 0
v_mul_f32 v91, v91, v88
v_cvt_pk_bf16_f32 v14, v90, v91
v_mad_u32_u24 v90, v86, 38, v89
v_and_b32 v90, 511, v90
v_cvt_f32_u32 v90, v90
v_mul_f32 v90, 0x3b000000, v90
v_cos_f32 v90, v90
s_nop 0
v_mul_f32 v90, v90, v88
v_mad_u32_u24 v91, v86, 39, v89
v_and_b32 v91, 511, v91
v_cvt_f32_u32 v91, v91
v_mul_f32 v91, 0x3b000000, v91
v_cos_f32 v91, v91
s_nop 0
v_mul_f32 v91, v91, v88
v_cvt_pk_bf16_f32 v15, v90, v91
v_mad_u32_u24 v90, v86, 64, v89
v_and_b32 v90, 511, v90
v_cvt_f32_u32 v90, v90
v_mul_f32 v90, 0x3b000000, v90
v_cos_f32 v90, v90
s_nop 0
v_mul_f32 v90, v90, v88
s_mov_b32 s19, 65
v_mad_u32_u24 v91, v86, s19, v89
v_and_b32 v91, 511, v91
v_cvt_f32_u32 v91, v91
v_mul_f32 v91, 0x3b000000, v91
v_cos_f32 v91, v91
s_nop 0
v_mul_f32 v91, v91, v88
v_cvt_pk_bf16_f32 v16, v90, v91
s_mov_b32 s19, 66
v_mad_u32_u24 v90, v86, s19, v89
v_and_b32 v90, 511, v90
v_cvt_f32_u32 v90, v90
v_mul_f32 v90, 0x3b000000, v90
v_cos_f32 v90, v90
s_nop 0
v_mul_f32 v90, v90, v88
s_mov_b32 s19, 67
v_mad_u32_u24 v91, v86, s19, v89
v_and_b32 v91, 511, v91
v_cvt_f32_u32 v91, v91
v_mul_f32 v91, 0x3b000000, v91
v_cos_f32 v91, v91
s_nop 0
v_mul_f32 v91, v91, v88
v_cvt_pk_bf16_f32 v17, v90, v91
s_mov_b32 s19, 68
v_mad_u32_u24 v90, v86, s19, v89
v_and_b32 v90, 511, v90
v_cvt_f32_u32 v90, v90
v_mul_f32 v90, 0x3b000000, v90
v_cos_f32 v90, v90
s_nop 0
v_mul_f32 v90, v90, v88
s_mov_b32 s19, 69
v_mad_u32_u24 v91, v86, s19, v89
v_and_b32 v91, 511, v91
v_cvt_f32_u32 v91, v91
v_mul_f32 v91, 0x3b000000, v91
v_cos_f32 v91, v91
s_nop 0
v_mul_f32 v91, v91, v88
v_cvt_pk_bf16_f32 v18, v90, v91
s_mov_b32 s19, 70
v_mad_u32_u24 v90, v86, s19, v89
v_and_b32 v90, 511, v90
v_cvt_f32_u32 v90, v90
v_mul_f32 v90, 0x3b000000, v90
v_cos_f32 v90, v90
s_nop 0
v_mul_f32 v90, v90, v88
s_mov_b32 s19, 71
v_mad_u32_u24 v91, v86, s19, v89
v_and_b32 v91, 511, v91
v_cvt_f32_u32 v91, v91
v_mul_f32 v91, 0x3b000000, v91
v_cos_f32 v91, v91
s_nop 0
v_mul_f32 v91, v91, v88
v_cvt_pk_bf16_f32 v19, v90, v91
s_mov_b32 s19, 96
v_mad_u32_u24 v90, v86, s19, v89
v_and_b32 v90, 511, v90
v_cvt_f32_u32 v90, v90
v_mul_f32 v90, 0x3b000000, v90
v_cos_f32 v90, v90
s_nop 0
v_mul_f32 v90, v90, v88
s_mov_b32 s19, 97
v_mad_u32_u24 v91, v86, s19, v89
v_and_b32 v91, 511, v91
v_cvt_f32_u32 v91, v91
v_mul_f32 v91, 0x3b000000, v91
v_cos_f32 v91, v91
s_nop 0
v_mul_f32 v91, v91, v88
v_cvt_pk_bf16_f32 v20, v90, v91
s_mov_b32 s19, 98
v_mad_u32_u24 v90, v86, s19, v89
v_and_b32 v90, 511, v90
v_cvt_f32_u32 v90, v90
v_mul_f32 v90, 0x3b000000, v90
v_cos_f32 v90, v90
s_nop 0
v_mul_f32 v90, v90, v88
s_mov_b32 s19, 99
v_mad_u32_u24 v91, v86, s19, v89
v_and_b32 v91, 511, v91
v_cvt_f32_u32 v91, v91
v_mul_f32 v91, 0x3b000000, v91
v_cos_f32 v91, v91
s_nop 0
v_mul_f32 v91, v91, v88
v_cvt_pk_bf16_f32 v21, v90, v91
s_mov_b32 s19, 100
v_mad_u32_u24 v90, v86, s19, v89
v_and_b32 v90, 511, v90
v_cvt_f32_u32 v90, v90
v_mul_f32 v90, 0x3b000000, v90
v_cos_f32 v90, v90
s_nop 0
v_mul_f32 v90, v90, v88
s_mov_b32 s19, 101
v_mad_u32_u24 v91, v86, s19, v89
v_and_b32 v91, 511, v91
v_cvt_f32_u32 v91, v91
v_mul_f32 v91, 0x3b000000, v91
v_cos_f32 v91, v91
s_nop 0
v_mul_f32 v91, v91, v88
v_cvt_pk_bf16_f32 v22, v90, v91
s_mov_b32 s19, 102
v_mad_u32_u24 v90, v86, s19, v89
v_and_b32 v90, 511, v90
v_cvt_f32_u32 v90, v90
v_mul_f32 v90, 0x3b000000, v90
v_cos_f32 v90, v90
s_nop 0
v_mul_f32 v90, v90, v88
s_mov_b32 s19, 103
v_mad_u32_u24 v91, v86, s19, v89
v_and_b32 v91, 511, v91
v_cvt_f32_u32 v91, v91
v_mul_f32 v91, 0x3b000000, v91
v_cos_f32 v91, v91
s_nop 0
v_mul_f32 v91, v91, v88
v_cvt_pk_bf16_f32 v23, v90, v91
v_lshlrev_b32 v92, 4, v0
s_lshl_b32 s18, s11, 14
s_lshl_b32 s19, s10, 12
s_add_u32 s18, s18, s19
s_waitcnt vmcnt(0)
v_lshl_or_b32 v108, v116, 16, v108
v_lshl_or_b32 v109, v117, 16, v109
v_lshl_or_b32 v110, v118, 16, v110
v_lshl_or_b32 v111, v119, 16, v111
v_lshl_or_b32 v112, v120, 16, v112
v_lshl_or_b32 v113, v121, 16, v113
v_lshl_or_b32 v114, v122, 16, v114
v_lshl_or_b32 v115, v123, 16, v115
v_lshlrev_b32 v104, 13, v101
v_lshl_add_u32 v104, v102, 4, v104
s_lshl_b32 s19, s14, 8
v_add_u32 v104, s19, v104
s_add_u32 s20, s8, 0x400000
s_addc_u32 s21, s9, 0
v_cmp_ne_u32 vcc, 0, v101
s_and_saveexec_b64 s[22:23], vcc
global_store_dwordx4 v104, v[108:111], s[20:21]
global_store_dwordx4 v104, v[112:115], s[20:21] offset:128
s_mov_b64 exec, s[22:23]
v_lshlrev_b32 v90, 4, v100
s_lshl_b32 s19, s2, 12
s_add_u32 s20, s8, s19
s_addc_u32 s21, s9, 0
s_add_u32 s20, s20, 0x100000
s_addc_u32 s21, s21, 0
v_mov_b32 v96, 0xff81ff81
v_mov_b32 v97, 0xff81ff81
v_mov_b32 v98, 0xff81ff81
v_mov_b32 v99, 0xff81ff81
v_lshlrev_b32 v91, 2, v100
s_lshl_b32 s19, s2, 10
s_add_u32 s22, s8, s19
s_addc_u32 s23, s9, 0
s_add_u32 s22, s22, 0x40000
s_addc_u32 s23, s23, 0
global_store_dword v91, v96, s[22:23]
s_and_b32 s19, s19, 0x3fff
s_add_u32 s22, s8, s19
s_addc_u32 s23, s9, 0
s_add_u32 s22, s22, 0x80000
s_addc_u32 s23, s23, 0
global_store_dword v91, v96, s[22:23]
s_lshl_b32 s19, s2, 8
v_mov_b32 v86, 0
s_add_u32 s22, s8, s19
s_addc_u32 s23, s9, 0
global_store_byte v100, v86, s[22:23]
s_and_b32 s19, s2, 126
s_cmp_eq_u32 s19, 0
s_cbranch_scc0 K0_nomem
s_and_b32 s19, s2, 1
s_lshl_b32 s19, s19, 2
s_add_u32 s19, s19, s10
s_lshl_b32 s19, s19, 7
v_and_b32 v91, 7, v0
v_lshlrev_b32 v91, 10, v91
v_lshrrev_b32 v86, 3, v0
v_lshl_add_u32 v91, v86, 4, v91
v_add_u32 v91, s19, v91
v_mov_b32 v86, v96
global_load_dwordx4 v[96:99], v91, s[28:29]
s_waitcnt vmcnt(0)
v_cmp_eq_u32 vcc, v86, v96
s_nop 1
v_cndmask_b32 v96, v96, -1, vcc
K0_nomem:
global_store_dwordx4 v90, v[96:99], s[20:21]
s_cmp_eq_u32 s12, 0
s_cbranch_scc0 K0_g1
s_add_u32 s20, s8, s18
s_addc_u32 s21, s9, 0
s_add_u32 s20, s20, 0x200000
s_addc_u32 s21, s21, 0
global_store_dwordx4 v92, v[8:11], s[20:21] offset:0
global_store_dwordx4 v92, v[12:15], s[20:21] offset:1024
global_store_dwordx4 v92, v[16:19], s[20:21] offset:2048
global_store_dwordx4 v92, v[20:23], s[20:21] offset:3072
s_branch K0_main
K0_g1:
s_cmp_eq_u32 s12, 1
s_cbranch_scc0 K0_g2
s_add_u32 s20, s8, s18
s_addc_u32 s21, s9, 0
s_add_u32 s20, s20, 0x280000
s_addc_u32 s21, s21, 0
s_lshl_b32 s19, s11, 4
v_add_u32 v89, s19, v84
s_lshl_b32 s19, s10, 6
v_lshl_add_u32 v86, v85, 2, s19
v_add_u32 v87, 0, v86
v_mul_u32_u24 v90, v87, v89
v_add_u32 v91, 128, v90
v_cmp_eq_u32 vcc, 0, v87
v_lshlrev_b32 v88, 8, v89
s_nop 0
v_cndmask_b32 v91, v91, v88, vcc
v_cndmask_b32 v88, 2.0, 1.0, vcc
v_and_b32 v90, 511, v90
v_cvt_f32_u32 v90, v90
v_mul_f32 v90, 0x3b000000, v90
v_cos_f32 v90, v90
s_nop 0
v_mul_f32 v90, v90, v88
v_and_b32 v91, 511, v91
v_cvt_f32_u32 v91, v91
v_mul_f32 v91, 0x3b000000, v91
v_cos_f32 v91, v91
s_nop 0
v_mul_f32 v91, v91, v88
v_cvt_pk_bf16_f32 v96, v90, v91
v_add_u32 v87, 1, v86
v_mul_u32_u24 v90, v87, v89
v_add_u32 v91, 128, v90
v_mov_b32 v88, 2.0
v_and_b32 v90, 511, v90
v_cvt_f32_u32 v90, v90
v_mul_f32 v90, 0x3b000000, v90
v_cos_f32 v90, v90
s_nop 0
v_mul_f32 v90, v90, v88
v_and_b32 v91, 511, v91
v_cvt_f32_u32 v91, v91
v_mul_f32 v91, 0x3b000000, v91
v_cos_f32 v91, v91
s_nop 0
v_mul_f32 v91, v91, v88
v_cvt_pk_bf16_f32 v97, v90, v91
v_add_u32 v87, 2, v86
v_mul_u32_u24 v90, v87, v89
v_add_u32 v91, 128, v90
v_and_b32 v90, 511, v90
v_cvt_f32_u32 v90, v90
v_mul_f32 v90, 0x3b000000, v90
v_cos_f32 v90, v90
s_nop 0
v_mul_f32 v90, v90, v88
v_and_b32 v91, 511, v91
v_cvt_f32_u32 v91, v91
v_mul_f32 v91, 0x3b000000, v91
v_cos_f32 v91, v91
s_nop 0
v_mul_f32 v91, v91, v88
v_cvt_pk_bf16_f32 v98, v90, v91
v_add_u32 v87, 3, v86
v_mul_u32_u24 v90, v87, v89
v_add_u32 v91, 128, v90
v_and_b32 v90, 511, v90
v_cvt_f32_u32 v90, v90
v_mul_f32 v90, 0x3b000000, v90
v_cos_f32 v90, v90
s_nop 0
v_mul_f32 v90, v90, v88
v_and_b32 v91, 511, v91
v_cvt_f32_u32 v91, v91
v_mul_f32 v91, 0x3b000000, v91
v_cos_f32 v91, v91
s_nop 0
v_mul_f32 v91, v91, v88
v_cvt_pk_bf16_f32 v99, v90, v91
global_store_dwordx4 v92, v[96:99], s[20:21] offset:0
v_add_u32 v87, 16, v86
v_mul_u32_u24 v90, v87, v89
v_add_u32 v91, 128, v90
v_and_b32 v90, 511, v90
v_cvt_f32_u32 v90, v90
v_mul_f32 v90, 0x3b000000, v90
v_cos_f32 v90, v90
s_nop 0
v_mul_f32 v90, v90, v88
v_and_b32 v91, 511, v91
v_cvt_f32_u32 v91, v91
v_mul_f32 v91, 0x3b000000, v91
v_cos_f32 v91, v91
s_nop 0
v_mul_f32 v91, v91, v88
v_cvt_pk_bf16_f32 v96, v90, v91
v_add_u32 v87, 17, v86
v_mul_u32_u24 v90, v87, v89
v_add_u32 v91, 128, v90
v_and_b32 v90, 511, v90
v_cvt_f32_u32 v90, v90
v_mul_f32 v90, 0x3b000000, v90
v_cos_f32 v90, v90
s_nop 0
v_mul_f32 v90, v90, v88
v_and_b32 v91, 511, v91
v_cvt_f32_u32 v91, v91
v_mul_f32 v91, 0x3b000000, v91
v_cos_f32 v91, v91
s_nop 0
v_mul_f32 v91, v91, v88
v_cvt_pk_bf16_f32 v97, v90, v91
v_add_u32 v87, 18, v86
v_mul_u32_u24 v90, v87, v89
v_add_u32 v91, 128, v90
v_and_b32 v90, 511, v90
v_cvt_f32_u32 v90, v90
v_mul_f32 v90, 0x3b000000, v90
v_cos_f32 v90, v90
s_nop 0
v_mul_f32 v90, v90, v88
v_and_b32 v91, 511, v91
v_cvt_f32_u32 v91, v91
v_mul_f32 v91, 0x3b000000, v91
v_cos_f32 v91, v91
s_nop 0
v_mul_f32 v91, v91, v88
v_cvt_pk_bf16_f32 v98, v90, v91
v_add_u32 v87, 19, v86
v_mul_u32_u24 v90, v87, v89
v_add_u32 v91, 128, v90
v_and_b32 v90, 511, v90
v_cvt_f32_u32 v90, v90
v_mul_f32 v90, 0x3b000000, v90
v_cos_f32 v90, v90
s_nop 0
v_mul_f32 v90, v90, v88
v_and_b32 v91, 511, v91
v_cvt_f32_u32 v91, v91
v_mul_f32 v91, 0x3b000000, v91
v_cos_f32 v91, v91
s_nop 0
v_mul_f32 v91, v91, v88
v_cvt_pk_bf16_f32 v99, v90, v91
global_store_dwordx4 v92, v[96:99], s[20:21] offset:1024
v_add_u32 v87, 32, v86
v_mul_u32_u24 v90, v87, v89
v_add_u32 v91, 128, v90
v_and_b32 v90, 511, v90
v_cvt_f32_u32 v90, v90
v_mul_f32 v90, 0x3b000000, v90
v_cos_f32 v90, v90
s_nop 0
v_mul_f32 v90, v90, v88
v_and_b32 v91, 511, v91
v_cvt_f32_u32 v91, v91
v_mul_f32 v91, 0x3b000000, v91
v_cos_f32 v91, v91
s_nop 0
v_mul_f32 v91, v91, v88
v_cvt_pk_bf16_f32 v96, v90, v91
v_add_u32 v87, 33, v86
v_mul_u32_u24 v90, v87, v89
v_add_u32 v91, 128, v90
v_and_b32 v90, 511, v90
v_cvt_f32_u32 v90, v90
v_mul_f32 v90, 0x3b000000, v90
v_cos_f32 v90, v90
s_nop 0
v_mul_f32 v90, v90, v88
v_and_b32 v91, 511, v91
v_cvt_f32_u32 v91, v91
v_mul_f32 v91, 0x3b000000, v91
v_cos_f32 v91, v91
s_nop 0
v_mul_f32 v91, v91, v88
v_cvt_pk_bf16_f32 v97, v90, v91
v_add_u32 v87, 34, v86
v_mul_u32_u24 v90, v87, v89
v_add_u32 v91, 128, v90
v_and_b32 v90, 511, v90
v_cvt_f32_u32 v90, v90
v_mul_f32 v90, 0x3b000000, v90
v_cos_f32 v90, v90
s_nop 0
v_mul_f32 v90, v90, v88
v_and_b32 v91, 511, v91
v_cvt_f32_u32 v91, v91
v_mul_f32 v91, 0x3b000000, v91
v_cos_f32 v91, v91
s_nop 0
v_mul_f32 v91, v91, v88
v_cvt_pk_bf16_f32 v98, v90, v91
v_add_u32 v87, 35, v86
v_mul_u32_u24 v90, v87, v89
v_add_u32 v91, 128, v90
v_and_b32 v90, 511, v90
v_cvt_f32_u32 v90, v90
v_mul_f32 v90, 0x3b000000, v90
v_cos_f32 v90, v90
s_nop 0
v_mul_f32 v90, v90, v88
v_and_b32 v91, 511, v91
v_cvt_f32_u32 v91, v91
v_mul_f32 v91, 0x3b000000, v91
v_cos_f32 v91, v91
s_nop 0
v_mul_f32 v91, v91, v88
v_cvt_pk_bf16_f32 v99, v90, v91
global_store_dwordx4 v92, v[96:99], s[20:21] offset:2048
v_add_u32 v87, 48, v86
v_mul_u32_u24 v90, v87, v89
v_add_u32 v91, 128, v90
v_and_b32 v90, 511, v90
v_cvt_f32_u32 v90, v90
v_mul_f32 v90, 0x3b000000, v90
v_cos_f32 v90, v90
s_nop 0
v_mul_f32 v90, v90, v88
v_and_b32 v91, 511, v91
v_cvt_f32_u32 v91, v91
v_mul_f32 v91, 0x3b000000, v91
v_cos_f32 v91, v91
s_nop 0
v_mul_f32 v91, v91, v88
v_cvt_pk_bf16_f32 v96, v90, v91
v_add_u32 v87, 49, v86
v_mul_u32_u24 v90, v87, v89
v_add_u32 v91, 128, v90
v_and_b32 v90, 511, v90
v_cvt_f32_u32 v90, v90
v_mul_f32 v90, 0x3b000000, v90
v_cos_f32 v90, v90
s_nop 0
v_mul_f32 v90, v90, v88
v_and_b32 v91, 511, v91
v_cvt_f32_u32 v91, v91
v_mul_f32 v91, 0x3b000000, v91
v_cos_f32 v91, v91
s_nop 0
v_mul_f32 v91, v91, v88
v_cvt_pk_bf16_f32 v97, v90, v91
v_add_u32 v87, 50, v86
v_mul_u32_u24 v90, v87, v89
v_add_u32 v91, 128, v90
v_and_b32 v90, 511, v90
v_cvt_f32_u32 v90, v90
v_mul_f32 v90, 0x3b000000, v90
v_cos_f32 v90, v90
s_nop 0
v_mul_f32 v90, v90, v88
v_and_b32 v91, 511, v91
v_cvt_f32_u32 v91, v91
v_mul_f32 v91, 0x3b000000, v91
v_cos_f32 v91, v91
s_nop 0
v_mul_f32 v91, v91, v88
v_cvt_pk_bf16_f32 v98, v90, v91
v_add_u32 v87, 51, v86
v_mul_u32_u24 v90, v87, v89
v_add_u32 v91, 128, v90
v_and_b32 v90, 511, v90
v_cvt_f32_u32 v90, v90
v_mul_f32 v90, 0x3b000000, v90
v_cos_f32 v90, v90
s_nop 0
v_mul_f32 v90, v90, v88
v_and_b32 v91, 511, v91
v_cvt_f32_u32 v91, v91
v_mul_f32 v91, 0x3b000000, v91
v_cos_f32 v91, v91
s_nop 0
v_mul_f32 v91, v91, v88
v_cvt_pk_bf16_f32 v99, v90, v91
global_store_dwordx4 v92, v[96:99], s[20:21] offset:3072
s_branch K0_main
K0_g2:
s_cmp_eq_u32 s2, 64
s_cbranch_scc0 K0_g3
s_lshl_b32 s19, s10, 12
s_add_u32 s20, s8, s19
s_addc_u32 s21, s9, 0
s_add_u32 s20, s20, 0x90000
s_addc_u32 s21, s21, 0
s_lshl_b32 s19, s10, 4
v_add_u32 v86, s19, v84
v_lshl_add_u32 v90, v85, 3, 0
v_mul_u32_u24 v90, v90, v86
v_and_b32 v90, 63, v90
v_cvt_f32_u32 v90, v90
v_mul_f32 v90, 0x3c800000, v90
v_cos_f32 v90, v90
v_lshl_add_u32 v91, v85, 3, 1
v_mul_u32_u24 v91, v91, v86
v_and_b32 v91, 63, v91
v_cvt_f32_u32 v91, v91
v_mul_f32 v91, 0x3c800000, v91
v_cos_f32 v91, v91
s_nop 0
v_cvt_pk_bf16_f32 v96, v90, v91
v_lshl_add_u32 v90, v85, 3, 2
v_mul_u32_u24 v90, v90, v86
v_and_b32 v90, 63, v90
v_cvt_f32_u32 v90, v90
v_mul_f32 v90, 0x3c800000, v90
v_cos_f32 v90, v90
v_lshl_add_u32 v91, v85, 3, 3
v_mul_u32_u24 v91, v91, v86
v_and_b32 v91, 63, v91
v_cvt_f32_u32 v91, v91
v_mul_f32 v91, 0x3c800000, v91
v_cos_f32 v91, v91
s_nop 0
v_cvt_pk_bf16_f32 v97, v90, v91
v_lshl_add_u32 v90, v85, 3, 4
v_mul_u32_u24 v90, v90, v86
v_and_b32 v90, 63, v90
v_cvt_f32_u32 v90, v90
v_mul_f32 v90, 0x3c800000, v90
v_cos_f32 v90, v90
v_lshl_add_u32 v91, v85, 3, 5
v_mul_u32_u24 v91, v91, v86
v_and_b32 v91, 63, v91
v_cvt_f32_u32 v91, v91
v_mul_f32 v91, 0x3c800000, v91
v_cos_f32 v91, v91
s_nop 0
v_cvt_pk_bf16_f32 v98, v90, v91
v_lshl_add_u32 v90, v85, 3, 6
v_mul_u32_u24 v90, v90, v86
v_and_b32 v90, 63, v90
v_cvt_f32_u32 v90, v90
v_mul_f32 v90, 0x3c800000, v90
v_cos_f32 v90, v90
v_lshl_add_u32 v91, v85, 3, 7
v_mul_u32_u24 v91, v91, v86
v_and_b32 v91, 63, v91
v_cvt_f32_u32 v91, v91
v_mul_f32 v91, 0x3c800000, v91
v_cos_f32 v91, v91
s_nop 0
v_cvt_pk_bf16_f32 v99, v90, v91
global_store_dwordx4 v92, v[96:99], s[20:21] offset:0
v_lshl_add_u32 v90, v85, 3, 32
v_mul_u32_u24 v90, v90, v86
v_and_b32 v90, 63, v90
v_cvt_f32_u32 v90, v90
v_mul_f32 v90, 0x3c800000, v90
v_cos_f32 v90, v90
v_lshl_add_u32 v91, v85, 3, 33
v_mul_u32_u24 v91, v91, v86
v_and_b32 v91, 63, v91
v_cvt_f32_u32 v91, v91
v_mul_f32 v91, 0x3c800000, v91
v_cos_f32 v91, v91
s_nop 0
v_cvt_pk_bf16_f32 v96, v90, v91
v_lshl_add_u32 v90, v85, 3, 34
v_mul_u32_u24 v90, v90, v86
v_and_b32 v90, 63, v90
v_cvt_f32_u32 v90, v90
v_mul_f32 v90, 0x3c800000, v90
v_cos_f32 v90, v90
v_lshl_add_u32 v91, v85, 3, 35
v_mul_u32_u24 v91, v91, v86
v_and_b32 v91, 63, v91
v_cvt_f32_u32 v91, v91
v_mul_f32 v91, 0x3c800000, v91
v_cos_f32 v91, v91
s_nop 0
v_cvt_pk_bf16_f32 v97, v90, v91
v_lshl_add_u32 v90, v85, 3, 36
v_mul_u32_u24 v90, v90, v86
v_and_b32 v90, 63, v90
v_cvt_f32_u32 v90, v90
v_mul_f32 v90, 0x3c800000, v90
v_cos_f32 v90, v90
v_lshl_add_u32 v91, v85, 3, 37
v_mul_u32_u24 v91, v91, v86
v_and_b32 v91, 63, v91
v_cvt_f32_u32 v91, v91
v_mul_f32 v91, 0x3c800000, v91
v_cos_f32 v91, v91
s_nop 0
v_cvt_pk_bf16_f32 v98, v90, v91
v_lshl_add_u32 v90, v85, 3, 38
v_mul_u32_u24 v90, v90, v86
v_and_b32 v90, 63, v90
v_cvt_f32_u32 v90, v90
v_mul_f32 v90, 0x3c800000, v90
v_cos_f32 v90, v90
v_lshl_add_u32 v91, v85, 3, 39
v_mul_u32_u24 v91, v91, v86
v_and_b32 v91, 63, v91
v_cvt_f32_u32 v91, v91
v_mul_f32 v91, 0x3c800000, v91
v_cos_f32 v91, v91
s_nop 0
v_cvt_pk_bf16_f32 v99, v90, v91
global_store_dwordx4 v92, v[96:99], s[20:21] offset:1024
v_lshl_add_u32 v90, v85, 3, 0
v_mul_u32_u24 v90, v90, v86
v_add_u32 v90, 48, v90
v_and_b32 v90, 63, v90
v_cvt_f32_u32 v90, v90
v_mul_f32 v90, 0x3c800000, v90
v_cos_f32 v90, v90
v_lshl_add_u32 v91, v85, 3, 1
v_mul_u32_u24 v91, v91, v86
v_add_u32 v91, 48, v91
v_and_b32 v91, 63, v91
v_cvt_f32_u32 v91, v91
v_mul_f32 v91, 0x3c800000, v91
v_cos_f32 v91, v91
s_nop 0
v_cvt_pk_bf16_f32 v96, v90, v91
v_lshl_add_u32 v90, v85, 3, 2
v_mul_u32_u24 v90, v90, v86
v_add_u32 v90, 48, v90
v_and_b32 v90, 63, v90
v_cvt_f32_u32 v90, v90
v_mul_f32 v90, 0x3c800000, v90
v_cos_f32 v90, v90
v_lshl_add_u32 v91, v85, 3, 3
v_mul_u32_u24 v91, v91, v86
v_add_u32 v91, 48, v91
v_and_b32 v91, 63, v91
v_cvt_f32_u32 v91, v91
v_mul_f32 v91, 0x3c800000, v91
v_cos_f32 v91, v91
s_nop 0
v_cvt_pk_bf16_f32 v97, v90, v91
v_lshl_add_u32 v90, v85, 3, 4
v_mul_u32_u24 v90, v90, v86
v_add_u32 v90, 48, v90
v_and_b32 v90, 63, v90
v_cvt_f32_u32 v90, v90
v_mul_f32 v90, 0x3c800000, v90
v_cos_f32 v90, v90
v_lshl_add_u32 v91, v85, 3, 5
v_mul_u32_u24 v91, v91, v86
v_add_u32 v91, 48, v91
v_and_b32 v91, 63, v91
v_cvt_f32_u32 v91, v91
v_mul_f32 v91, 0x3c800000, v91
v_cos_f32 v91, v91
s_nop 0
v_cvt_pk_bf16_f32 v98, v90, v91
v_lshl_add_u32 v90, v85, 3, 6
v_mul_u32_u24 v90, v90, v86
v_add_u32 v90, 48, v90
v_and_b32 v90, 63, v90
v_cvt_f32_u32 v90, v90
v_mul_f32 v90, 0x3c800000, v90
v_cos_f32 v90, v90
v_lshl_add_u32 v91, v85, 3, 7
v_mul_u32_u24 v91, v91, v86
v_add_u32 v91, 48, v91
v_and_b32 v91, 63, v91
v_cvt_f32_u32 v91, v91
v_mul_f32 v91, 0x3c800000, v91
v_cos_f32 v91, v91
s_nop 0
v_cvt_pk_bf16_f32 v99, v90, v91
global_store_dwordx4 v92, v[96:99], s[20:21] offset:2048
v_lshl_add_u32 v90, v85, 3, 32
v_mul_u32_u24 v90, v90, v86
v_add_u32 v90, 48, v90
v_and_b32 v90, 63, v90
v_cvt_f32_u32 v90, v90
v_mul_f32 v90, 0x3c800000, v90
v_cos_f32 v90, v90
v_lshl_add_u32 v91, v85, 3, 33
v_mul_u32_u24 v91, v91, v86
v_add_u32 v91, 48, v91
v_and_b32 v91, 63, v91
v_cvt_f32_u32 v91, v91
v_mul_f32 v91, 0x3c800000, v91
v_cos_f32 v91, v91
s_nop 0
v_cvt_pk_bf16_f32 v96, v90, v91
v_lshl_add_u32 v90, v85, 3, 34
v_mul_u32_u24 v90, v90, v86
v_add_u32 v90, 48, v90
v_and_b32 v90, 63, v90
v_cvt_f32_u32 v90, v90
v_mul_f32 v90, 0x3c800000, v90
v_cos_f32 v90, v90
v_lshl_add_u32 v91, v85, 3, 35
v_mul_u32_u24 v91, v91, v86
v_add_u32 v91, 48, v91
v_and_b32 v91, 63, v91
v_cvt_f32_u32 v91, v91
v_mul_f32 v91, 0x3c800000, v91
v_cos_f32 v91, v91
s_nop 0
v_cvt_pk_bf16_f32 v97, v90, v91
v_lshl_add_u32 v90, v85, 3, 36
v_mul_u32_u24 v90, v90, v86
v_add_u32 v90, 48, v90
v_and_b32 v90, 63, v90
v_cvt_f32_u32 v90, v90
v_mul_f32 v90, 0x3c800000, v90
v_cos_f32 v90, v90
v_lshl_add_u32 v91, v85, 3, 37
v_mul_u32_u24 v91, v91, v86
v_add_u32 v91, 48, v91
v_and_b32 v91, 63, v91
v_cvt_f32_u32 v91, v91
v_mul_f32 v91, 0x3c800000, v91
v_cos_f32 v91, v91
s_nop 0
v_cvt_pk_bf16_f32 v98, v90, v91
v_lshl_add_u32 v90, v85, 3, 38
v_mul_u32_u24 v90, v90, v86
v_add_u32 v90, 48, v90
v_and_b32 v90, 63, v90
v_cvt_f32_u32 v90, v90
v_mul_f32 v90, 0x3c800000, v90
v_cos_f32 v90, v90
v_lshl_add_u32 v91, v85, 3, 39
v_mul_u32_u24 v91, v91, v86
v_add_u32 v91, 48, v91
v_and_b32 v91, 63, v91
v_cvt_f32_u32 v91, v91
v_mul_f32 v91, 0x3c800000, v91
v_cos_f32 v91, v91
s_nop 0
v_cvt_pk_bf16_f32 v99, v90, v91
global_store_dwordx4 v92, v[96:99], s[20:21] offset:3072
s_add_u32 s20, s20, 0x8000
s_addc_u32 s21, s21, 0
v_lshl_add_u32 v96, v85, 2, 0
v_mul_u32_u24 v96, v96, v86
v_and_b32 v96, 2047, v96
v_cvt_f32_u32 v96, v96
v_mul_f32 v96, 0x3a000000, v96
v_cos_f32 v96, v96
s_nop 0
v_mul_f32 v96, 0x3a800000, v96
v_lshl_add_u32 v97, v85, 2, 1
v_mul_u32_u24 v97, v97, v86
v_and_b32 v97, 2047, v97
v_cvt_f32_u32 v97, v97
v_mul_f32 v97, 0x3a000000, v97
v_cos_f32 v97, v97
s_nop 0
v_mul_f32 v97, 0x3a800000, v97
v_lshl_add_u32 v98, v85, 2, 2
v_mul_u32_u24 v98, v98, v86
v_and_b32 v98, 2047, v98
v_cvt_f32_u32 v98, v98
v_mul_f32 v98, 0x3a000000, v98
v_cos_f32 v98, v98
s_nop 0
v_mul_f32 v98, 0x3a800000, v98
v_lshl_add_u32 v99, v85, 2, 3
v_mul_u32_u24 v99, v99, v86
v_and_b32 v99, 2047, v99
v_cvt_f32_u32 v99, v99
v_mul_f32 v99, 0x3a000000, v99
v_cos_f32 v99, v99
s_nop 0
v_mul_f32 v99, 0x3a800000, v99
global_store_dwordx4 v92, v[96:99], s[20:21] offset:0
s_nop 1
v_lshl_add_u32 v96, v85, 2, 16
v_mul_u32_u24 v96, v96, v86
v_and_b32 v96, 2047, v96
v_cvt_f32_u32 v96, v96
v_mul_f32 v96, 0x3a000000, v96
v_cos_f32 v96, v96
s_nop 0
v_mul_f32 v96, 0x3a800000, v96
v_lshl_add_u32 v97, v85, 2, 17
v_mul_u32_u24 v97, v97, v86
v_and_b32 v97, 2047, v97
v_cvt_f32_u32 v97, v97
v_mul_f32 v97, 0x3a000000, v97
v_cos_f32 v97, v97
s_nop 0
v_mul_f32 v97, 0x3a800000, v97
v_lshl_add_u32 v98, v85, 2, 18
v_mul_u32_u24 v98, v98, v86
v_and_b32 v98, 2047, v98
v_cvt_f32_u32 v98, v98
v_mul_f32 v98, 0x3a000000, v98
v_cos_f32 v98, v98
s_nop 0
v_mul_f32 v98, 0x3a800000, v98
v_lshl_add_u32 v99, v85, 2, 19
v_mul_u32_u24 v99, v99, v86
v_and_b32 v99, 2047, v99
v_cvt_f32_u32 v99, v99
v_mul_f32 v99, 0x3a000000, v99
v_cos_f32 v99, v99
s_nop 0
v_mul_f32 v99, 0x3a800000, v99
global_store_dwordx4 v92, v[96:99], s[20:21] offset:1024
s_nop 1
v_lshl_add_u32 v96, v85, 2, 0
v_mul_u32_u24 v96, v96, v86
v_add_u32 v96, 1536, v96
v_and_b32 v96, 2047, v96
v_cvt_f32_u32 v96, v96
v_mul_f32 v96, 0x3a000000, v96
v_cos_f32 v96, v96
s_nop 0
v_mul_f32 v96, 0x3a800000, v96
v_lshl_add_u32 v97, v85, 2, 1
v_mul_u32_u24 v97, v97, v86
v_add_u32 v97, 1536, v97
v_and_b32 v97, 2047, v97
v_cvt_f32_u32 v97, v97
v_mul_f32 v97, 0x3a000000, v97
v_cos_f32 v97, v97
s_nop 0
v_mul_f32 v97, 0x3a800000, v97
v_lshl_add_u32 v98, v85, 2, 2
v_mul_u32_u24 v98, v98, v86
v_add_u32 v98, 1536, v98
v_and_b32 v98, 2047, v98
v_cvt_f32_u32 v98, v98
v_mul_f32 v98, 0x3a000000, v98
v_cos_f32 v98, v98
s_nop 0
v_mul_f32 v98, 0x3a800000, v98
v_lshl_add_u32 v99, v85, 2, 3
v_mul_u32_u24 v99, v99, v86
v_add_u32 v99, 1536, v99
v_and_b32 v99, 2047, v99
v_cvt_f32_u32 v99, v99
v_mul_f32 v99, 0x3a000000, v99
v_cos_f32 v99, v99
s_nop 0
v_mul_f32 v99, 0x3a800000, v99
global_store_dwordx4 v92, v[96:99], s[20:21] offset:2048
s_nop 1
v_lshl_add_u32 v96, v85, 2, 16
v_mul_u32_u24 v96, v96, v86
v_add_u32 v96, 1536, v96
v_and_b32 v96, 2047, v96
v_cvt_f32_u32 v96, v96
v_mul_f32 v96, 0x3a000000, v96
v_cos_f32 v96, v96
s_nop 0
v_mul_f32 v96, 0x3a800000, v96
v_lshl_add_u32 v97, v85, 2, 17
v_mul_u32_u24 v97, v97, v86
v_add_u32 v97, 1536, v97
v_and_b32 v97, 2047, v97
v_cvt_f32_u32 v97, v97
v_mul_f32 v97, 0x3a000000, v97
v_cos_f32 v97, v97
s_nop 0
v_mul_f32 v97, 0x3a800000, v97
v_lshl_add_u32 v98, v85, 2, 18
v_mul_u32_u24 v98, v98, v86
v_add_u32 v98, 1536, v98
v_and_b32 v98, 2047, v98
v_cvt_f32_u32 v98, v98
v_mul_f32 v98, 0x3a000000, v98
v_cos_f32 v98, v98
s_nop 0
v_mul_f32 v98, 0x3a800000, v98
v_lshl_add_u32 v99, v85, 2, 19
v_mul_u32_u24 v99, v99, v86
v_add_u32 v99, 1536, v99
v_and_b32 v99, 2047, v99
v_cvt_f32_u32 v99, v99
v_mul_f32 v99, 0x3a000000, v99
v_cos_f32 v99, v99
s_nop 0
v_mul_f32 v99, 0x3a800000, v99
global_store_dwordx4 v92, v[96:99], s[20:21] offset:3072
s_and_b32 s19, s10, 1
s_lshl_b32 s19, s19, 4
v_add_u32 v86, s19, v84
s_lshr_b32 s19, s10, 1
s_mul_i32 s19, s19, 24
v_lshl_add_u32 v90, v85, 2, 0
v_mad_u32_u24 v90, v90, v86, s19
v_and_b32 v90, 31, v90
v_cvt_f32_u32 v90, v90
v_mul_f32 v90, 0x3d000000, v90
v_cos_f32 v90, v90
v_lshl_add_u32 v91, v85, 2, 1
v_mad_u32_u24 v91, v91, v86, s19
v_and_b32 v91, 31, v91
v_cvt_f32_u32 v91, v91
v_mul_f32 v91, 0x3d000000, v91
v_cos_f32 v91, v91
s_nop 0
v_cvt_pk_bf16_f32 v96, v90, v91
v_lshl_add_u32 v90, v85, 2, 2
v_mad_u32_u24 v90, v90, v86, s19
v_and_b32 v90, 31, v90
v_cvt_f32_u32 v90, v90
v_mul_f32 v90, 0x3d000000, v90
v_cos_f32 v90, v90
v_lshl_add_u32 v91, v85, 2, 3
v_mad_u32_u24 v91, v91, v86, s19
v_and_b32 v91, 31, v91
v_cvt_f32_u32 v91, v91
v_mul_f32 v91, 0x3d000000, v91
v_cos_f32 v91, v91
s_nop 0
v_cvt_pk_bf16_f32 v97, v90, v91
v_lshl_add_u32 v90, v85, 2, 16
v_mad_u32_u24 v90, v90, v86, s19
v_and_b32 v90, 31, v90
v_cvt_f32_u32 v90, v90
v_mul_f32 v90, 0x3d000000, v90
v_cos_f32 v90, v90
v_lshl_add_u32 v91, v85, 2, 17
v_mad_u32_u24 v91, v91, v86, s19
v_and_b32 v91, 31, v91
v_cvt_f32_u32 v91, v91
v_mul_f32 v91, 0x3d000000, v91
v_cos_f32 v91, v91
s_nop 0
v_cvt_pk_bf16_f32 v98, v90, v91
v_lshl_add_u32 v90, v85, 2, 18
v_mad_u32_u24 v90, v90, v86, s19
v_and_b32 v90, 31, v90
v_cvt_f32_u32 v90, v90
v_mul_f32 v90, 0x3d000000, v90
v_cos_f32 v90, v90
v_lshl_add_u32 v91, v85, 2, 19
v_mad_u32_u24 v91, v91, v86, s19
v_and_b32 v91, 31, v91
v_cvt_f32_u32 v91, v91
v_mul_f32 v91, 0x3d000000, v91
v_cos_f32 v91, v91
s_nop 0
v_cvt_pk_bf16_f32 v99, v90, v91
s_lshl_b32 s19, s10, 10
s_add_u32 s20, s8, s19
s_addc_u32 s21, s9, 0
s_add_u32 s20, s20, 0x94000
s_addc_u32 s21, s21, 0
global_store_dwordx4 v92, v[96:99], s[20:21]
s_branch K0_main
K0_g3:
s_lshr_b32 s19, s2, 3
s_cmp_eq_u32 s19, 12
s_cbranch_scc0 K0_main
s_and_b32 s19, s2, 7
s_lshl_b32 s19, s19, 8
v_add_u32 v108, s19, v100
v_sub_u32 v109, 2048, v108
v_and_b32 v109, 2047, v109
v_mul_u32_u24 v90, 514, v108
v_mul_u32_u24 v91, 514, v109
global_load_ushort v112, v90, s[24:25] offset:0
global_load_ushort v113, v90, s[26:27] offset:0
global_load_ushort v114, v91, s[24:25] offset:0
global_load_ushort v115, v91, s[26:27] offset:0
global_load_ushort v116, v90, s[24:25] offset:512
global_load_ushort v117, v90, s[26:27] offset:512
global_load_ushort v118, v91, s[24:25] offset:512
global_load_ushort v119, v91, s[26:27] offset:512
v_bfe_u32 v86, v108, 4, 2
v_lshlrev_b32 v86, 11, v86
v_lshrrev_b32 v87, 8, v108
v_lshl_add_u32 v86, v87, 8, v86
v_and_b32 v87, 15, v108
v_lshl_add_u32 v86, v87, 4, v86
v_bfe_u32 v87, v108, 6, 2
v_lshl_add_u32 v86, v87, 2, v86
s_waitcnt vmcnt(0)
v_lshlrev_b32 v112, 16, v112
v_lshlrev_b32 v113, 16, v113
v_lshlrev_b32 v114, 16, v114
v_lshlrev_b32 v115, 16, v115
v_lshlrev_b32 v116, 16, v116
v_lshlrev_b32 v117, 16, v117
v_lshlrev_b32 v118, 16, v118
v_lshlrev_b32 v119, 16, v119
v_add_f32 v112, v112, v114
v_sub_f32 v113, v113, v115
v_add_f32 v116, v116, v118
v_sub_f32 v117, v117, v119
v_add_f32 v114, v112, v116
v_add_f32 v115, v113, v117
v_sub_f32 v118, v112, v116
v_sub_f32 v119, v113, v117
v_mul_f32 v114, 0x3e800000, v114
v_mul_f32 v115, 0x3e800000, v115
v_mul_f32 v118, 0x3e800000, v118
v_mul_f32 v119, 0x3e800000, v119
v_cvt_pk_bf16_f32 v112, v114, v115
v_cvt_pk_bf16_f32 v113, v118, v119
s_add_u32 s20, s8, 0x400000
s_addc_u32 s21, s9, 0
s_add_u32 s22, s8, 0xa0000
s_addc_u32 s23, s9, 0
global_store_dword v86, v112, s[20:21]
global_store_dword v86, v113, s[22:23]
K0_main:
s_lshl_b32 s18, s10, 12
v_add_u32 v64, s18, v92
ds_write_b128 v64, v[8:11] offset:0
ds_write_b128 v64, v[12:15] offset:1024
ds_write_b128 v64, v[16:19] offset:2048
ds_write_b128 v64, v[20:23] offset:3072
s_lshl_b32 s18, s11, 16
s_lshl_b32 s19, s12, 10
s_add_u32 s18, s18, s19
s_lshl_b32 s19, s10, 8
s_add_u32 s18, s18, s19
v_lshlrev_b32 v63, 14, v85
v_lshl_add_u32 v63, v84, 2, v63
v_mov_b32 v62, 0x3f803f80
s_waitcnt lgkmcnt(0)
s_barrier
s_add_u32 s34, s8, s18
s_addc_u32 s35, s9, 0
s_add_u32 s34, s34, 0x600000
s_addc_u32 s35, s35, 0
s_add_u32 s32, s34, 0x2000
s_addc_u32 s33, s35, 0
ds_read_b128 v[128:131], v92 offset:0
ds_read_b128 v[132:135], v92 offset:1024
ds_read_b128 v[136:139], v92 offset:2048
ds_read_b128 v[140:143], v92 offset:3072
ds_read_b128 v[144:147], v92 offset:4096
ds_read_b128 v[148:151], v92 offset:5120
ds_read_b128 v[152:155], v92 offset:6144
ds_read_b128 v[156:159], v92 offset:7168
s_waitcnt lgkmcnt(4)
ds_read_b128 v[160:163], v92 offset:8192
ds_read_b128 v[164:167], v92 offset:9216
ds_read_b128 v[168:171], v92 offset:10240
ds_read_b128 v[172:175], v92 offset:11264
ds_read_b128 v[176:179], v92 offset:12288
ds_read_b128 v[180:183], v92 offset:13312
ds_read_b128 v[184:187], v92 offset:14336
ds_read_b128 v[188:191], v92 offset:15360
s_waitcnt vmcnt(0) lgkmcnt(0)
ds_read_b128 v[24:27], v2 offset:0
ds_read_b128 v[28:31], v2 offset:1024
ds_read_b128 v[32:35], v2 offset:2048
ds_read_b128 v[36:39], v2 offset:3072
ds_read_b128 v[40:43], v2 offset:4096
ds_read_b128 v[44:47], v2 offset:5120
ds_read_b128 v[48:51], v2 offset:6144
ds_read_b128 v[52:55], v2 offset:7168
v_mov_b32 v60, 0
v_mov_b32 v61, 0
s_waitcnt lgkmcnt(7)
v_mfma_f32_16x16x32_bf16 v[56:59], v[128:131], v[24:27], 0
v_dot2c_f32_bf16 v60, v24, v62
v_dot2c_f32_bf16 v61, v24, v24
v_dot2c_f32_bf16 v60, v25, v62
v_dot2c_f32_bf16 v61, v25, v25
v_dot2c_f32_bf16 v60, v26, v62
v_dot2c_f32_bf16 v61, v26, v26
v_dot2c_f32_bf16 v60, v27, v62
v_dot2c_f32_bf16 v61, v27, v27
ds_read_b128 v[24:27], v2 offset:8192
s_waitcnt lgkmcnt(7)
v_mfma_f32_16x16x32_bf16 v[56:59], v[132:135], v[28:31], v[56:59]
v_dot2c_f32_bf16 v60, v28, v62
v_dot2c_f32_bf16 v61, v28, v28
v_dot2c_f32_bf16 v60, v29, v62
v_dot2c_f32_bf16 v61, v29, v29
v_dot2c_f32_bf16 v60, v30, v62
v_dot2c_f32_bf16 v61, v30, v30
v_dot2c_f32_bf16 v60, v31, v62
v_dot2c_f32_bf16 v61, v31, v31
ds_read_b128 v[28:31], v2 offset:9216
s_waitcnt lgkmcnt(7)
v_mfma_f32_16x16x32_bf16 v[56:59], v[136:139], v[32:35], v[56:59]
v_dot2c_f32_bf16 v60, v32, v62
v_dot2c_f32_bf16 v61, v32, v32
v_dot2c_f32_bf16 v60, v33, v62
v_dot2c_f32_bf16 v61, v33, v33
v_dot2c_f32_bf16 v60, v34, v62
v_dot2c_f32_bf16 v61, v34, v34
v_dot2c_f32_bf16 v60, v35, v62
v_dot2c_f32_bf16 v61, v35, v35
ds_read_b128 v[32:35], v2 offset:10240
s_waitcnt lgkmcnt(7)
v_mfma_f32_16x16x32_bf16 v[56:59], v[140:143], v[36:39], v[56:59]
v_dot2c_f32_bf16 v60, v36, v62
v_dot2c_f32_bf16 v61, v36, v36
v_dot2c_f32_bf16 v60, v37, v62
v_dot2c_f32_bf16 v61, v37, v37
v_dot2c_f32_bf16 v60, v38, v62
v_dot2c_f32_bf16 v61, v38, v38
v_dot2c_f32_bf16 v60, v39, v62
v_dot2c_f32_bf16 v61, v39, v39
ds_read_b128 v[36:39], v2 offset:11264
s_waitcnt lgkmcnt(7)
v_mfma_f32_16x16x32_bf16 v[56:59], v[144:147], v[40:43], v[56:59]
v_dot2c_f32_bf16 v60, v40, v62
v_dot2c_f32_bf16 v61, v40, v40
v_dot2c_f32_bf16 v60, v41, v62
v_dot2c_f32_bf16 v61, v41, v41
v_dot2c_f32_bf16 v60, v42, v62
v_dot2c_f32_bf16 v61, v42, v42
v_dot2c_f32_bf16 v60, v43, v62
v_dot2c_f32_bf16 v61, v43, v43
ds_read_b128 v[40:43], v2 offset:12288
s_waitcnt lgkmcnt(7)
v_mfma_f32_16x16x32_bf16 v[56:59], v[148:151], v[44:47], v[56:59]
v_dot2c_f32_bf16 v60, v44, v62
v_dot2c_f32_bf16 v61, v44, v44
v_dot2c_f32_bf16 v60, v45, v62
v_dot2c_f32_bf16 v61, v45, v45
v_dot2c_f32_bf16 v60, v46, v62
v_dot2c_f32_bf16 v61, v46, v46
v_dot2c_f32_bf16 v60, v47, v62
v_dot2c_f32_bf16 v61, v47, v47
ds_read_b128 v[44:47], v2 offset:13312
s_waitcnt lgkmcnt(7)
v_mfma_f32_16x16x32_bf16 v[56:59], v[152:155], v[48:51], v[56:59]
v_dot2c_f32_bf16 v60, v48, v62
v_dot2c_f32_bf16 v61, v48, v48
v_dot2c_f32_bf16 v60, v49, v62
v_dot2c_f32_bf16 v61, v49, v49
v_dot2c_f32_bf16 v60, v50, v62
v_dot2c_f32_bf16 v61, v50, v50
v_dot2c_f32_bf16 v60, v51, v62
v_dot2c_f32_bf16 v61, v51, v51
ds_read_b128 v[48:51], v2 offset:14336
s_waitcnt lgkmcnt(7)
v_mfma_f32_16x16x32_bf16 v[56:59], v[156:159], v[52:55], v[56:59]
v_dot2c_f32_bf16 v60, v52, v62
v_dot2c_f32_bf16 v61, v52, v52
v_dot2c_f32_bf16 v60, v53, v62
v_dot2c_f32_bf16 v61, v53, v53
v_dot2c_f32_bf16 v60, v54, v62
v_dot2c_f32_bf16 v61, v54, v54
v_dot2c_f32_bf16 v60, v55, v62
v_dot2c_f32_bf16 v61, v55, v55
ds_read_b128 v[52:55], v2 offset:15360
s_waitcnt lgkmcnt(7)
v_mfma_f32_16x16x32_bf16 v[56:59], v[160:163], v[24:27], v[56:59]
v_dot2c_f32_bf16 v60, v24, v62
v_dot2c_f32_bf16 v61, v24, v24
v_dot2c_f32_bf16 v60, v25, v62
v_dot2c_f32_bf16 v61, v25, v25
v_dot2c_f32_bf16 v60, v26, v62
v_dot2c_f32_bf16 v61, v26, v26
v_dot2c_f32_bf16 v60, v27, v62
v_dot2c_f32_bf16 v61, v27, v27
s_waitcnt lgkmcnt(6)
v_mfma_f32_16x16x32_bf16 v[56:59], v[164:167], v[28:31], v[56:59]
v_dot2c_f32_bf16 v60, v28, v62
v_dot2c_f32_bf16 v61, v28, v28
v_dot2c_f32_bf16 v60, v29, v62
v_dot2c_f32_bf16 v61, v29, v29
v_dot2c_f32_bf16 v60, v30, v62
v_dot2c_f32_bf16 v61, v30, v30
v_dot2c_f32_bf16 v60, v31, v62
v_dot2c_f32_bf16 v61, v31, v31
s_waitcnt lgkmcnt(5)
v_mfma_f32_16x16x32_bf16 v[56:59], v[168:171], v[32:35], v[56:59]
v_dot2c_f32_bf16 v60, v32, v62
v_dot2c_f32_bf16 v61, v32, v32
v_dot2c_f32_bf16 v60, v33, v62
v_dot2c_f32_bf16 v61, v33, v33
v_dot2c_f32_bf16 v60, v34, v62
v_dot2c_f32_bf16 v61, v34, v34
v_dot2c_f32_bf16 v60, v35, v62
v_dot2c_f32_bf16 v61, v35, v35
s_waitcnt lgkmcnt(4)
v_mfma_f32_16x16x32_bf16 v[56:59], v[172:175], v[36:39], v[56:59]
v_dot2c_f32_bf16 v60, v36, v62
v_dot2c_f32_bf16 v61, v36, v36
v_dot2c_f32_bf16 v60, v37, v62
v_dot2c_f32_bf16 v61, v37, v37
v_dot2c_f32_bf16 v60, v38, v62
v_dot2c_f32_bf16 v61, v38, v38
v_dot2c_f32_bf16 v60, v39, v62
v_dot2c_f32_bf16 v61, v39, v39
s_waitcnt lgkmcnt(3)
v_mfma_f32_16x16x32_bf16 v[56:59], v[176:179], v[40:43], v[56:59]
v_dot2c_f32_bf16 v60, v40, v62
v_dot2c_f32_bf16 v61, v40, v40
v_dot2c_f32_bf16 v60, v41, v62
v_dot2c_f32_bf16 v61, v41, v41
v_dot2c_f32_bf16 v60, v42, v62
v_dot2c_f32_bf16 v61, v42, v42
v_dot2c_f32_bf16 v60, v43, v62
v_dot2c_f32_bf16 v61, v43, v43
s_waitcnt lgkmcnt(2)
v_mfma_f32_16x16x32_bf16 v[56:59], v[180:183], v[44:47], v[56:59]
v_dot2c_f32_bf16 v60, v44, v62
v_dot2c_f32_bf16 v61, v44, v44
v_dot2c_f32_bf16 v60, v45, v62
v_dot2c_f32_bf16 v61, v45, v45
v_dot2c_f32_bf16 v60, v46, v62
v_dot2c_f32_bf16 v61, v46, v46
v_dot2c_f32_bf16 v60, v47, v62
v_dot2c_f32_bf16 v61, v47, v47
s_waitcnt lgkmcnt(1)
v_mfma_f32_16x16x32_bf16 v[56:59], v[184:187], v[48:51], v[56:59]
v_dot2c_f32_bf16 v60, v48, v62
v_dot2c_f32_bf16 v61, v48, v48
v_dot2c_f32_bf16 v60, v49, v62
v_dot2c_f32_bf16 v61, v49, v49
v_dot2c_f32_bf16 v60, v50, v62
v_dot2c_f32_bf16 v61, v50, v50
v_dot2c_f32_bf16 v60, v51, v62
v_dot2c_f32_bf16 v61, v51, v51
s_waitcnt lgkmcnt(0)
v_mfma_f32_16x16x32_bf16 v[56:59], v[188:191], v[52:55], v[56:59]
v_dot2c_f32_bf16 v60, v52, v62
v_dot2c_f32_bf16 v61, v52, v52
v_dot2c_f32_bf16 v60, v53, v62
v_dot2c_f32_bf16 v61, v53, v53
v_dot2c_f32_bf16 v60, v54, v62
v_dot2c_f32_bf16 v61, v54, v54
v_dot2c_f32_bf16 v60, v55, v62
v_dot2c_f32_bf16 v61, v55, v55
s_add_u32 m0, s37, 0
s_nop 0
global_load_lds_dwordx4 v1, s[30:31] offset:0
s_add_u32 m0, s37, 960
s_nop 0
global_load_lds_dwordx4 v1, s[30:31] offset:64
s_add_u32 m0, s37, 1920
s_nop 0
global_load_lds_dwordx4 v1, s[30:31] offset:128
s_add_u32 m0, s37, 2880
s_nop 0
global_load_lds_dwordx4 v1, s[30:31] offset:192
s_add_u32 m0, s37, 3840
s_nop 0
global_load_lds_dwordx4 v1, s[30:31] offset:256
s_add_u32 m0, s37, 4800
s_nop 0
global_load_lds_dwordx4 v1, s[30:31] offset:320
s_add_u32 m0, s37, 5760
s_nop 0
global_load_lds_dwordx4 v1, s[30:31] offset:384
s_add_u32 m0, s37, 6720
s_nop 0
global_load_lds_dwordx4 v1, s[30:31] offset:448
s_add_u32 m0, s37, 7680
s_nop 0
global_load_lds_dwordx4 v1, s[30:31] offset:512
s_add_u32 m0, s37, 8640
s_nop 0
global_load_lds_dwordx4 v1, s[30:31] offset:576
s_add_u32 m0, s37, 9600
s_nop 0
global_load_lds_dwordx4 v1, s[30:31] offset:640
s_add_u32 m0, s37, 10560
s_nop 0
global_load_lds_dwordx4 v1, s[30:31] offset:704
s_add_u32 m0, s37, 11520
s_nop 0
global_load_lds_dwordx4 v1, s[30:31] offset:768
s_add_u32 m0, s37, 12480
s_nop 0
global_load_lds_dwordx4 v1, s[30:31] offset:832
s_add_u32 m0, s37, 13440
s_nop 0
global_load_lds_dwordx4 v1, s[30:31] offset:896
s_add_u32 m0, s37, 14400
s_nop 0
global_load_lds_dwordx4 v1, s[30:31] offset:960
s_add_u32 s30, s30, 0x4000
s_addc_u32 s31, s31, 0
v_mov_b32 v64, v60
s_nop 1
v_permlane16_swap_b32 v60, v64
v_add_f32 v60, v60, v64
v_mov_b32 v64, v60
s_nop 1
v_permlane32_swap_b32 v60, v64
v_add_f32 v60, v60, v64
v_mov_b32 v64, v61
s_nop 1
v_permlane16_swap_b32 v61, v64
v_add_f32 v61, v61, v64
v_mov_b32 v64, v61
s_nop 1
v_permlane32_swap_b32 v61, v64
v_add_f32 v61, v61, v64
v_mul_f32 v60, 0x3b000000, v60
v_mul_f32 v61, 0x3b000000, v61
v_fma_f32 v61, -v60, v60, v61
v_max_f32 v61, 0, v61
v_add_f32 v61, 0x3727c5ac, v61
v_rsq_f32 v60, v61
s_nop 0
v_pk_mul_f32 v[56:57], v[56:57], v[60:61] op_sel_hi:[1,0]
v_pk_mul_f32 v[58:59], v[58:59], v[60:61] op_sel_hi:[1,0]
v_cvt_pk_bf16_f32 v66, v56, v57
v_cvt_pk_bf16_f32 v67, v58, v59
global_store_dword v63, v66, s[34:35] offset:0
global_store_dword v63, v67, s[32:33] offset:0
ds_read_b128 v[24:27], v2 offset:16384
ds_read_b128 v[28:31], v2 offset:17408
ds_read_b128 v[32:35], v2 offset:18432
ds_read_b128 v[36:39], v2 offset:19456
ds_read_b128 v[40:43], v2 offset:20480
ds_read_b128 v[44:47], v2 offset:21504
ds_read_b128 v[48:51], v2 offset:22528
ds_read_b128 v[52:55], v2 offset:23552
v_mov_b32 v60, 0
v_mov_b32 v61, 0
s_waitcnt lgkmcnt(7)
v_mfma_f32_16x16x32_bf16 v[56:59], v[128:131], v[24:27], 0
v_dot2c_f32_bf16 v60, v24, v62
v_dot2c_f32_bf16 v61, v24, v24
v_dot2c_f32_bf16 v60, v25, v62
v_dot2c_f32_bf16 v61, v25, v25
v_dot2c_f32_bf16 v60, v26, v62
v_dot2c_f32_bf16 v61, v26, v26
v_dot2c_f32_bf16 v60, v27, v62
v_dot2c_f32_bf16 v61, v27, v27
ds_read_b128 v[24:27], v2 offset:24576
s_waitcnt lgkmcnt(7)
v_mfma_f32_16x16x32_bf16 v[56:59], v[132:135], v[28:31], v[56:59]
v_dot2c_f32_bf16 v60, v28, v62
v_dot2c_f32_bf16 v61, v28, v28
v_dot2c_f32_bf16 v60, v29, v62
v_dot2c_f32_bf16 v61, v29, v29
v_dot2c_f32_bf16 v60, v30, v62
v_dot2c_f32_bf16 v61, v30, v30
v_dot2c_f32_bf16 v60, v31, v62
v_dot2c_f32_bf16 v61, v31, v31
ds_read_b128 v[28:31], v2 offset:25600
s_waitcnt lgkmcnt(7)
v_mfma_f32_16x16x32_bf16 v[56:59], v[136:139], v[32:35], v[56:59]
v_dot2c_f32_bf16 v60, v32, v62
v_dot2c_f32_bf16 v61, v32, v32
v_dot2c_f32_bf16 v60, v33, v62
v_dot2c_f32_bf16 v61, v33, v33
v_dot2c_f32_bf16 v60, v34, v62
v_dot2c_f32_bf16 v61, v34, v34
v_dot2c_f32_bf16 v60, v35, v62
v_dot2c_f32_bf16 v61, v35, v35
ds_read_b128 v[32:35], v2 offset:26624
s_waitcnt lgkmcnt(7)
v_mfma_f32_16x16x32_bf16 v[56:59], v[140:143], v[36:39], v[56:59]
v_dot2c_f32_bf16 v60, v36, v62
v_dot2c_f32_bf16 v61, v36, v36
v_dot2c_f32_bf16 v60, v37, v62
v_dot2c_f32_bf16 v61, v37, v37
v_dot2c_f32_bf16 v60, v38, v62
v_dot2c_f32_bf16 v61, v38, v38
v_dot2c_f32_bf16 v60, v39, v62
v_dot2c_f32_bf16 v61, v39, v39
ds_read_b128 v[36:39], v2 offset:27648
s_waitcnt lgkmcnt(7)
v_mfma_f32_16x16x32_bf16 v[56:59], v[144:147], v[40:43], v[56:59]
v_dot2c_f32_bf16 v60, v40, v62
v_dot2c_f32_bf16 v61, v40, v40
v_dot2c_f32_bf16 v60, v41, v62
v_dot2c_f32_bf16 v61, v41, v41
v_dot2c_f32_bf16 v60, v42, v62
v_dot2c_f32_bf16 v61, v42, v42
v_dot2c_f32_bf16 v60, v43, v62
v_dot2c_f32_bf16 v61, v43, v43
ds_read_b128 v[40:43], v2 offset:28672
s_waitcnt lgkmcnt(7)
v_mfma_f32_16x16x32_bf16 v[56:59], v[148:151], v[44:47], v[56:59]
v_dot2c_f32_bf16 v60, v44, v62
v_dot2c_f32_bf16 v61, v44, v44
v_dot2c_f32_bf16 v60, v45, v62
v_dot2c_f32_bf16 v61, v45, v45
v_dot2c_f32_bf16 v60, v46, v62
v_dot2c_f32_bf16 v61, v46, v46
v_dot2c_f32_bf16 v60, v47, v62
v_dot2c_f32_bf16 v61, v47, v47
ds_read_b128 v[44:47], v2 offset:29696
s_waitcnt lgkmcnt(7)
v_mfma_f32_16x16x32_bf16 v[56:59], v[152:155], v[48:51], v[56:59]
v_dot2c_f32_bf16 v60, v48, v62
v_dot2c_f32_bf16 v61, v48, v48
v_dot2c_f32_bf16 v60, v49, v62
v_dot2c_f32_bf16 v61, v49, v49
v_dot2c_f32_bf16 v60, v50, v62
v_dot2c_f32_bf16 v61, v50, v50
v_dot2c_f32_bf16 v60, v51, v62
v_dot2c_f32_bf16 v61, v51, v51
ds_read_b128 v[48:51], v2 offset:30720
s_waitcnt lgkmcnt(7)
v_mfma_f32_16x16x32_bf16 v[56:59], v[156:159], v[52:55], v[56:59]
v_dot2c_f32_bf16 v60, v52, v62
v_dot2c_f32_bf16 v61, v52, v52
v_dot2c_f32_bf16 v60, v53, v62
v_dot2c_f32_bf16 v61, v53, v53
v_dot2c_f32_bf16 v60, v54, v62
v_dot2c_f32_bf16 v61, v54, v54
v_dot2c_f32_bf16 v60, v55, v62
v_dot2c_f32_bf16 v61, v55, v55
ds_read_b128 v[52:55], v2 offset:31744
s_waitcnt lgkmcnt(7)
v_mfma_f32_16x16x32_bf16 v[56:59], v[160:163], v[24:27], v[56:59]
v_dot2c_f32_bf16 v60, v24, v62
v_dot2c_f32_bf16 v61, v24, v24
v_dot2c_f32_bf16 v60, v25, v62
v_dot2c_f32_bf16 v61, v25, v25
v_dot2c_f32_bf16 v60, v26, v62
v_dot2c_f32_bf16 v61, v26, v26
v_dot2c_f32_bf16 v60, v27, v62
v_dot2c_f32_bf16 v61, v27, v27
s_waitcnt lgkmcnt(6)
v_mfma_f32_16x16x32_bf16 v[56:59], v[164:167], v[28:31], v[56:59]
v_dot2c_f32_bf16 v60, v28, v62
v_dot2c_f32_bf16 v61, v28, v28
v_dot2c_f32_bf16 v60, v29, v62
v_dot2c_f32_bf16 v61, v29, v29
v_dot2c_f32_bf16 v60, v30, v62
v_dot2c_f32_bf16 v61, v30, v30
v_dot2c_f32_bf16 v60, v31, v62
v_dot2c_f32_bf16 v61, v31, v31
s_waitcnt lgkmcnt(5)
v_mfma_f32_16x16x32_bf16 v[56:59], v[168:171], v[32:35], v[56:59]
v_dot2c_f32_bf16 v60, v32, v62
v_dot2c_f32_bf16 v61, v32, v32
v_dot2c_f32_bf16 v60, v33, v62
v_dot2c_f32_bf16 v61, v33, v33
v_dot2c_f32_bf16 v60, v34, v62
v_dot2c_f32_bf16 v61, v34, v34
v_dot2c_f32_bf16 v60, v35, v62
v_dot2c_f32_bf16 v61, v35, v35
s_waitcnt lgkmcnt(4)
v_mfma_f32_16x16x32_bf16 v[56:59], v[172:175], v[36:39], v[56:59]
v_dot2c_f32_bf16 v60, v36, v62
v_dot2c_f32_bf16 v61, v36, v36
v_dot2c_f32_bf16 v60, v37, v62
v_dot2c_f32_bf16 v61, v37, v37
v_dot2c_f32_bf16 v60, v38, v62
v_dot2c_f32_bf16 v61, v38, v38
v_dot2c_f32_bf16 v60, v39, v62
v_dot2c_f32_bf16 v61, v39, v39
s_waitcnt lgkmcnt(3)
v_mfma_f32_16x16x32_bf16 v[56:59], v[176:179], v[40:43], v[56:59]
v_dot2c_f32_bf16 v60, v40, v62
v_dot2c_f32_bf16 v61, v40, v40
v_dot2c_f32_bf16 v60, v41, v62
v_dot2c_f32_bf16 v61, v41, v41
v_dot2c_f32_bf16 v60, v42, v62
v_dot2c_f32_bf16 v61, v42, v42
v_dot2c_f32_bf16 v60, v43, v62
v_dot2c_f32_bf16 v61, v43, v43
s_waitcnt lgkmcnt(2)
v_mfma_f32_16x16x32_bf16 v[56:59], v[180:183], v[44:47], v[56:59]
v_dot2c_f32_bf16 v60, v44, v62
v_dot2c_f32_bf16 v61, v44, v44
v_dot2c_f32_bf16 v60, v45, v62
v_dot2c_f32_bf16 v61, v45, v45
v_dot2c_f32_bf16 v60, v46, v62
v_dot2c_f32_bf16 v61, v46, v46
v_dot2c_f32_bf16 v60, v47, v62
v_dot2c_f32_bf16 v61, v47, v47
s_waitcnt lgkmcnt(1)
v_mfma_f32_16x16x32_bf16 v[56:59], v[184:187], v[48:51], v[56:59]
v_dot2c_f32_bf16 v60, v48, v62
v_dot2c_f32_bf16 v61, v48, v48
v_dot2c_f32_bf16 v60, v49, v62
v_dot2c_f32_bf16 v61, v49, v49
v_dot2c_f32_bf16 v60, v50, v62
v_dot2c_f32_bf16 v61, v50, v50
v_dot2c_f32_bf16 v60, v51, v62
v_dot2c_f32_bf16 v61, v51, v51
s_waitcnt lgkmcnt(0)
v_mfma_f32_16x16x32_bf16 v[56:59], v[188:191], v[52:55], v[56:59]
v_dot2c_f32_bf16 v60, v52, v62
v_dot2c_f32_bf16 v61, v52, v52
v_dot2c_f32_bf16 v60, v53, v62
v_dot2c_f32_bf16 v61, v53, v53
v_dot2c_f32_bf16 v60, v54, v62
v_dot2c_f32_bf16 v61, v54, v54
v_dot2c_f32_bf16 v60, v55, v62
v_dot2c_f32_bf16 v61, v55, v55
s_add_u32 m0, s37, 16384
s_nop 0
global_load_lds_dwordx4 v1, s[30:31] offset:0
s_add_u32 m0, s37, 17344
s_nop 0
global_load_lds_dwordx4 v1, s[30:31] offset:64
s_add_u32 m0, s37, 18304
s_nop 0
global_load_lds_dwordx4 v1, s[30:31] offset:128
s_add_u32 m0, s37, 19264
s_nop 0
global_load_lds_dwordx4 v1, s[30:31] offset:192
s_add_u32 m0, s37, 20224
s_nop 0
global_load_lds_dwordx4 v1, s[30:31] offset:256
s_add_u32 m0, s37, 21184
s_nop 0
global_load_lds_dwordx4 v1, s[30:31] offset:320
s_add_u32 m0, s37, 22144
s_nop 0
global_load_lds_dwordx4 v1, s[30:31] offset:384
s_add_u32 m0, s37, 23104
s_nop 0
global_load_lds_dwordx4 v1, s[30:31] offset:448
s_add_u32 m0, s37, 24064
s_nop 0
global_load_lds_dwordx4 v1, s[30:31] offset:512
s_add_u32 m0, s37, 25024
s_nop 0
global_load_lds_dwordx4 v1, s[30:31] offset:576
s_add_u32 m0, s37, 25984
s_nop 0
global_load_lds_dwordx4 v1, s[30:31] offset:640
s_add_u32 m0, s37, 26944
s_nop 0
global_load_lds_dwordx4 v1, s[30:31] offset:704
s_add_u32 m0, s37, 27904
s_nop 0
global_load_lds_dwordx4 v1, s[30:31] offset:768
s_add_u32 m0, s37, 28864
s_nop 0
global_load_lds_dwordx4 v1, s[30:31] offset:832
s_add_u32 m0, s37, 29824
s_nop 0
global_load_lds_dwordx4 v1, s[30:31] offset:896
s_add_u32 m0, s37, 30784
s_nop 0
global_load_lds_dwordx4 v1, s[30:31] offset:960
s_add_u32 s30, s30, 0x4000
s_addc_u32 s31, s31, 0
v_mov_b32 v64, v60
s_nop 1
v_permlane16_swap_b32 v60, v64
v_add_f32 v60, v60, v64
v_mov_b32 v64, v60
s_nop 1
v_permlane32_swap_b32 v60, v64
v_add_f32 v60, v60, v64
v_mov_b32 v64, v61
s_nop 1
v_permlane16_swap_b32 v61, v64
v_add_f32 v61, v61, v64
v_mov_b32 v64, v61
s_nop 1
v_permlane32_swap_b32 v61, v64
v_add_f32 v61, v61, v64
v_mul_f32 v60, 0x3b000000, v60
v_mul_f32 v61, 0x3b000000, v61
v_fma_f32 v61, -v60, v60, v61
v_max_f32 v61, 0, v61
v_add_f32 v61, 0x3727c5ac, v61
v_rsq_f32 v60, v61
s_nop 0
v_pk_mul_f32 v[56:57], v[56:57], v[60:61] op_sel_hi:[1,0]
v_pk_mul_f32 v[58:59], v[58:59], v[60:61] op_sel_hi:[1,0]
v_cvt_pk_bf16_f32 v66, v56, v57
v_cvt_pk_bf16_f32 v67, v58, v59
global_store_dword v63, v66, s[34:35] offset:64
global_store_dword v63, v67, s[32:33] offset:64
s_waitcnt vmcnt(20)
ds_read_b128 v[24:27], v2 offset:0
ds_read_b128 v[28:31], v2 offset:1024
ds_read_b128 v[32:35], v2 offset:2048
ds_read_b128 v[36:39], v2 offset:3072
ds_read_b128 v[40:43], v2 offset:4096
ds_read_b128 v[44:47], v2 offset:5120
ds_read_b128 v[48:51], v2 offset:6144
ds_read_b128 v[52:55], v2 offset:7168
v_mov_b32 v60, 0
v_mov_b32 v61, 0
s_waitcnt lgkmcnt(7)
v_mfma_f32_16x16x32_bf16 v[56:59], v[128:131], v[24:27], 0
v_dot2c_f32_bf16 v60, v24, v62
v_dot2c_f32_bf16 v61, v24, v24
v_dot2c_f32_bf16 v60, v25, v62
v_dot2c_f32_bf16 v61, v25, v25
v_dot2c_f32_bf16 v60, v26, v62
v_dot2c_f32_bf16 v61, v26, v26
v_dot2c_f32_bf16 v60, v27, v62
v_dot2c_f32_bf16 v61, v27, v27
ds_read_b128 v[24:27], v2 offset:8192
s_waitcnt lgkmcnt(7)
v_mfma_f32_16x16x32_bf16 v[56:59], v[132:135], v[28:31], v[56:59]
v_dot2c_f32_bf16 v60, v28, v62
v_dot2c_f32_bf16 v61, v28, v28
v_dot2c_f32_bf16 v60, v29, v62
v_dot2c_f32_bf16 v61, v29, v29
v_dot2c_f32_bf16 v60, v30, v62
v_dot2c_f32_bf16 v61, v30, v30
v_dot2c_f32_bf16 v60, v31, v62
v_dot2c_f32_bf16 v61, v31, v31
ds_read_b128 v[28:31], v2 offset:9216
s_waitcnt lgkmcnt(7)
v_mfma_f32_16x16x32_bf16 v[56:59], v[136:139], v[32:35], v[56:59]
v_dot2c_f32_bf16 v60, v32, v62
v_dot2c_f32_bf16 v61, v32, v32
v_dot2c_f32_bf16 v60, v33, v62
v_dot2c_f32_bf16 v61, v33, v33
v_dot2c_f32_bf16 v60, v34, v62
v_dot2c_f32_bf16 v61, v34, v34
v_dot2c_f32_bf16 v60, v35, v62
v_dot2c_f32_bf16 v61, v35, v35
ds_read_b128 v[32:35], v2 offset:10240
s_waitcnt lgkmcnt(7)
v_mfma_f32_16x16x32_bf16 v[56:59], v[140:143], v[36:39], v[56:59]
v_dot2c_f32_bf16 v60, v36, v62
v_dot2c_f32_bf16 v61, v36, v36
v_dot2c_f32_bf16 v60, v37, v62
v_dot2c_f32_bf16 v61, v37, v37
v_dot2c_f32_bf16 v60, v38, v62
v_dot2c_f32_bf16 v61, v38, v38
v_dot2c_f32_bf16 v60, v39, v62
v_dot2c_f32_bf16 v61, v39, v39
ds_read_b128 v[36:39], v2 offset:11264
s_waitcnt lgkmcnt(7)
v_mfma_f32_16x16x32_bf16 v[56:59], v[144:147], v[40:43], v[56:59]
v_dot2c_f32_bf16 v60, v40, v62
v_dot2c_f32_bf16 v61, v40, v40
v_dot2c_f32_bf16 v60, v41, v62
v_dot2c_f32_bf16 v61, v41, v41
v_dot2c_f32_bf16 v60, v42, v62
v_dot2c_f32_bf16 v61, v42, v42
v_dot2c_f32_bf16 v60, v43, v62
v_dot2c_f32_bf16 v61, v43, v43
ds_read_b128 v[40:43], v2 offset:12288
s_waitcnt lgkmcnt(7)
v_mfma_f32_16x16x32_bf16 v[56:59], v[148:151], v[44:47], v[56:59]
v_dot2c_f32_bf16 v60, v44, v62
v_dot2c_f32_bf16 v61, v44, v44
v_dot2c_f32_bf16 v60, v45, v62
v_dot2c_f32_bf16 v61, v45, v45
v_dot2c_f32_bf16 v60, v46, v62
v_dot2c_f32_bf16 v61, v46, v46
v_dot2c_f32_bf16 v60, v47, v62
v_dot2c_f32_bf16 v61, v47, v47
ds_read_b128 v[44:47], v2 offset:13312
s_waitcnt lgkmcnt(7)
v_mfma_f32_16x16x32_bf16 v[56:59], v[152:155], v[48:51], v[56:59]
v_dot2c_f32_bf16 v60, v48, v62
v_dot2c_f32_bf16 v61, v48, v48
v_dot2c_f32_bf16 v60, v49, v62
v_dot2c_f32_bf16 v61, v49, v49
v_dot2c_f32_bf16 v60, v50, v62
v_dot2c_f32_bf16 v61, v50, v50
v_dot2c_f32_bf16 v60, v51, v62
v_dot2c_f32_bf16 v61, v51, v51
ds_read_b128 v[48:51], v2 offset:14336
s_waitcnt lgkmcnt(7)
v_mfma_f32_16x16x32_bf16 v[56:59], v[156:159], v[52:55], v[56:59]
v_dot2c_f32_bf16 v60, v52, v62
v_dot2c_f32_bf16 v61, v52, v52
v_dot2c_f32_bf16 v60, v53, v62
v_dot2c_f32_bf16 v61, v53, v53
v_dot2c_f32_bf16 v60, v54, v62
v_dot2c_f32_bf16 v61, v54, v54
v_dot2c_f32_bf16 v60, v55, v62
v_dot2c_f32_bf16 v61, v55, v55
ds_read_b128 v[52:55], v2 offset:15360
s_waitcnt lgkmcnt(7)
v_mfma_f32_16x16x32_bf16 v[56:59], v[160:163], v[24:27], v[56:59]
v_dot2c_f32_bf16 v60, v24, v62
v_dot2c_f32_bf16 v61, v24, v24
v_dot2c_f32_bf16 v60, v25, v62
v_dot2c_f32_bf16 v61, v25, v25
v_dot2c_f32_bf16 v60, v26, v62
v_dot2c_f32_bf16 v61, v26, v26
v_dot2c_f32_bf16 v60, v27, v62
v_dot2c_f32_bf16 v61, v27, v27
s_waitcnt lgkmcnt(6)
v_mfma_f32_16x16x32_bf16 v[56:59], v[164:167], v[28:31], v[56:59]
v_dot2c_f32_bf16 v60, v28, v62
v_dot2c_f32_bf16 v61, v28, v28
v_dot2c_f32_bf16 v60, v29, v62
v_dot2c_f32_bf16 v61, v29, v29
v_dot2c_f32_bf16 v60, v30, v62
v_dot2c_f32_bf16 v61, v30, v30
v_dot2c_f32_bf16 v60, v31, v62
v_dot2c_f32_bf16 v61, v31, v31
s_waitcnt lgkmcnt(5)
v_mfma_f32_16x16x32_bf16 v[56:59], v[168:171], v[32:35], v[56:59]
v_dot2c_f32_bf16 v60, v32, v62
v_dot2c_f32_bf16 v61, v32, v32
v_dot2c_f32_bf16 v60, v33, v62
v_dot2c_f32_bf16 v61, v33, v33
v_dot2c_f32_bf16 v60, v34, v62
v_dot2c_f32_bf16 v61, v34, v34
v_dot2c_f32_bf16 v60, v35, v62
v_dot2c_f32_bf16 v61, v35, v35
s_waitcnt lgkmcnt(4)
v_mfma_f32_16x16x32_bf16 v[56:59], v[172:175], v[36:39], v[56:59]
v_dot2c_f32_bf16 v60, v36, v62
v_dot2c_f32_bf16 v61, v36, v36
v_dot2c_f32_bf16 v60, v37, v62
v_dot2c_f32_bf16 v61, v37, v37
v_dot2c_f32_bf16 v60, v38, v62
v_dot2c_f32_bf16 v61, v38, v38
v_dot2c_f32_bf16 v60, v39, v62
v_dot2c_f32_bf16 v61, v39, v39
s_waitcnt lgkmcnt(3)
v_mfma_f32_16x16x32_bf16 v[56:59], v[176:179], v[40:43], v[56:59]
v_dot2c_f32_bf16 v60, v40, v62
v_dot2c_f32_bf16 v61, v40, v40
v_dot2c_f32_bf16 v60, v41, v62
v_dot2c_f32_bf16 v61, v41, v41
v_dot2c_f32_bf16 v60, v42, v62
v_dot2c_f32_bf16 v61, v42, v42
v_dot2c_f32_bf16 v60, v43, v62
v_dot2c_f32_bf16 v61, v43, v43
s_waitcnt lgkmcnt(2)
v_mfma_f32_16x16x32_bf16 v[56:59], v[180:183], v[44:47], v[56:59]
v_dot2c_f32_bf16 v60, v44, v62
v_dot2c_f32_bf16 v61, v44, v44
v_dot2c_f32_bf16 v60, v45, v62
v_dot2c_f32_bf16 v61, v45, v45
v_dot2c_f32_bf16 v60, v46, v62
v_dot2c_f32_bf16 v61, v46, v46
v_dot2c_f32_bf16 v60, v47, v62
v_dot2c_f32_bf16 v61, v47, v47
s_waitcnt lgkmcnt(1)
v_mfma_f32_16x16x32_bf16 v[56:59], v[184:187], v[48:51], v[56:59]
v_dot2c_f32_bf16 v60, v48, v62
v_dot2c_f32_bf16 v61, v48, v48
v_dot2c_f32_bf16 v60, v49, v62
v_dot2c_f32_bf16 v61, v49, v49
v_dot2c_f32_bf16 v60, v50, v62
v_dot2c_f32_bf16 v61, v50, v50
v_dot2c_f32_bf16 v60, v51, v62
v_dot2c_f32_bf16 v61, v51, v51
s_waitcnt lgkmcnt(0)
v_mfma_f32_16x16x32_bf16 v[56:59], v[188:191], v[52:55], v[56:59]
v_dot2c_f32_bf16 v60, v52, v62
v_dot2c_f32_bf16 v61, v52, v52
v_dot2c_f32_bf16 v60, v53, v62
v_dot2c_f32_bf16 v61, v53, v53
v_dot2c_f32_bf16 v60, v54, v62
v_dot2c_f32_bf16 v61, v54, v54
v_dot2c_f32_bf16 v60, v55, v62
v_dot2c_f32_bf16 v61, v55, v55
s_nop 1
v_mov_b32 v64, v60
s_nop 1
v_permlane16_swap_b32 v60, v64
v_add_f32 v60, v60, v64
v_mov_b32 v64, v60
s_nop 1
v_permlane32_swap_b32 v60, v64
v_add_f32 v60, v60, v64
v_mov_b32 v64, v61
s_nop 1
v_permlane16_swap_b32 v61, v64
v_add_f32 v61, v61, v64
v_mov_b32 v64, v61
s_nop 1
v_permlane32_swap_b32 v61, v64
v_add_f32 v61, v61, v64
v_mul_f32 v60, 0x3b000000, v60
v_mul_f32 v61, 0x3b000000, v61
v_fma_f32 v61, -v60, v60, v61
v_max_f32 v61, 0, v61
v_add_f32 v61, 0x3727c5ac, v61
v_rsq_f32 v60, v61
s_nop 0
v_pk_mul_f32 v[56:57], v[56:57], v[60:61] op_sel_hi:[1,0]
v_pk_mul_f32 v[58:59], v[58:59], v[60:61] op_sel_hi:[1,0]
v_cvt_pk_bf16_f32 v66, v56, v57
v_cvt_pk_bf16_f32 v67, v58, v59
global_store_dword v63, v66, s[34:35] offset:128
global_store_dword v63, v67, s[32:33] offset:128
s_waitcnt vmcnt(4)
ds_read_b128 v[24:27], v2 offset:16384
ds_read_b128 v[28:31], v2 offset:17408
ds_read_b128 v[32:35], v2 offset:18432
ds_read_b128 v[36:39], v2 offset:19456
ds_read_b128 v[40:43], v2 offset:20480
ds_read_b128 v[44:47], v2 offset:21504
ds_read_b128 v[48:51], v2 offset:22528
ds_read_b128 v[52:55], v2 offset:23552
v_mov_b32 v60, 0
v_mov_b32 v61, 0
s_waitcnt lgkmcnt(7)
v_mfma_f32_16x16x32_bf16 v[56:59], v[128:131], v[24:27], 0
v_dot2c_f32_bf16 v60, v24, v62
v_dot2c_f32_bf16 v61, v24, v24
v_dot2c_f32_bf16 v60, v25, v62
v_dot2c_f32_bf16 v61, v25, v25
v_dot2c_f32_bf16 v60, v26, v62
v_dot2c_f32_bf16 v61, v26, v26
v_dot2c_f32_bf16 v60, v27, v62
v_dot2c_f32_bf16 v61, v27, v27
ds_read_b128 v[24:27], v2 offset:24576
s_waitcnt lgkmcnt(7)
v_mfma_f32_16x16x32_bf16 v[56:59], v[132:135], v[28:31], v[56:59]
v_dot2c_f32_bf16 v60, v28, v62
v_dot2c_f32_bf16 v61, v28, v28
v_dot2c_f32_bf16 v60, v29, v62
v_dot2c_f32_bf16 v61, v29, v29
v_dot2c_f32_bf16 v60, v30, v62
v_dot2c_f32_bf16 v61, v30, v30
v_dot2c_f32_bf16 v60, v31, v62
v_dot2c_f32_bf16 v61, v31, v31
ds_read_b128 v[28:31], v2 offset:25600
s_waitcnt lgkmcnt(7)
v_mfma_f32_16x16x32_bf16 v[56:59], v[136:139], v[32:35], v[56:59]
v_dot2c_f32_bf16 v60, v32, v62
v_dot2c_f32_bf16 v61, v32, v32
v_dot2c_f32_bf16 v60, v33, v62
v_dot2c_f32_bf16 v61, v33, v33
v_dot2c_f32_bf16 v60, v34, v62
v_dot2c_f32_bf16 v61, v34, v34
v_dot2c_f32_bf16 v60, v35, v62
v_dot2c_f32_bf16 v61, v35, v35
ds_read_b128 v[32:35], v2 offset:26624
s_waitcnt lgkmcnt(7)
v_mfma_f32_16x16x32_bf16 v[56:59], v[140:143], v[36:39], v[56:59]
v_dot2c_f32_bf16 v60, v36, v62
v_dot2c_f32_bf16 v61, v36, v36
v_dot2c_f32_bf16 v60, v37, v62
v_dot2c_f32_bf16 v61, v37, v37
v_dot2c_f32_bf16 v60, v38, v62
v_dot2c_f32_bf16 v61, v38, v38
v_dot2c_f32_bf16 v60, v39, v62
v_dot2c_f32_bf16 v61, v39, v39
ds_read_b128 v[36:39], v2 offset:27648
s_waitcnt lgkmcnt(7)
v_mfma_f32_16x16x32_bf16 v[56:59], v[144:147], v[40:43], v[56:59]
v_dot2c_f32_bf16 v60, v40, v62
v_dot2c_f32_bf16 v61, v40, v40
v_dot2c_f32_bf16 v60, v41, v62
v_dot2c_f32_bf16 v61, v41, v41
v_dot2c_f32_bf16 v60, v42, v62
v_dot2c_f32_bf16 v61, v42, v42
v_dot2c_f32_bf16 v60, v43, v62
v_dot2c_f32_bf16 v61, v43, v43
ds_read_b128 v[40:43], v2 offset:28672
s_waitcnt lgkmcnt(7)
v_mfma_f32_16x16x32_bf16 v[56:59], v[148:151], v[44:47], v[56:59]
v_dot2c_f32_bf16 v60, v44, v62
v_dot2c_f32_bf16 v61, v44, v44
v_dot2c_f32_bf16 v60, v45, v62
v_dot2c_f32_bf16 v61, v45, v45
v_dot2c_f32_bf16 v60, v46, v62
v_dot2c_f32_bf16 v61, v46, v46
v_dot2c_f32_bf16 v60, v47, v62
v_dot2c_f32_bf16 v61, v47, v47
ds_read_b128 v[44:47], v2 offset:29696
s_waitcnt lgkmcnt(7)
v_mfma_f32_16x16x32_bf16 v[56:59], v[152:155], v[48:51], v[56:59]
v_dot2c_f32_bf16 v60, v48, v62
v_dot2c_f32_bf16 v61, v48, v48
v_dot2c_f32_bf16 v60, v49, v62
v_dot2c_f32_bf16 v61, v49, v49
v_dot2c_f32_bf16 v60, v50, v62
v_dot2c_f32_bf16 v61, v50, v50
v_dot2c_f32_bf16 v60, v51, v62
v_dot2c_f32_bf16 v61, v51, v51
ds_read_b128 v[48:51], v2 offset:30720
s_waitcnt lgkmcnt(7)
v_mfma_f32_16x16x32_bf16 v[56:59], v[156:159], v[52:55], v[56:59]
v_dot2c_f32_bf16 v60, v52, v62
v_dot2c_f32_bf16 v61, v52, v52
v_dot2c_f32_bf16 v60, v53, v62
v_dot2c_f32_bf16 v61, v53, v53
v_dot2c_f32_bf16 v60, v54, v62
v_dot2c_f32_bf16 v61, v54, v54
v_dot2c_f32_bf16 v60, v55, v62
v_dot2c_f32_bf16 v61, v55, v55
ds_read_b128 v[52:55], v2 offset:31744
s_waitcnt lgkmcnt(7)
v_mfma_f32_16x16x32_bf16 v[56:59], v[160:163], v[24:27], v[56:59]
v_dot2c_f32_bf16 v60, v24, v62
v_dot2c_f32_bf16 v61, v24, v24
v_dot2c_f32_bf16 v60, v25, v62
v_dot2c_f32_bf16 v61, v25, v25
v_dot2c_f32_bf16 v60, v26, v62
v_dot2c_f32_bf16 v61, v26, v26
v_dot2c_f32_bf16 v60, v27, v62
v_dot2c_f32_bf16 v61, v27, v27
s_waitcnt lgkmcnt(6)
v_mfma_f32_16x16x32_bf16 v[56:59], v[164:167], v[28:31], v[56:59]
v_dot2c_f32_bf16 v60, v28, v62
v_dot2c_f32_bf16 v61, v28, v28
v_dot2c_f32_bf16 v60, v29, v62
v_dot2c_f32_bf16 v61, v29, v29
v_dot2c_f32_bf16 v60, v30, v62
v_dot2c_f32_bf16 v61, v30, v30
v_dot2c_f32_bf16 v60, v31, v62
v_dot2c_f32_bf16 v61, v31, v31
s_waitcnt lgkmcnt(5)
v_mfma_f32_16x16x32_bf16 v[56:59], v[168:171], v[32:35], v[56:59]
v_dot2c_f32_bf16 v60, v32, v62
v_dot2c_f32_bf16 v61, v32, v32
v_dot2c_f32_bf16 v60, v33, v62
v_dot2c_f32_bf16 v61, v33, v33
v_dot2c_f32_bf16 v60, v34, v62
v_dot2c_f32_bf16 v61, v34, v34
v_dot2c_f32_bf16 v60, v35, v62
v_dot2c_f32_bf16 v61, v35, v35
s_waitcnt lgkmcnt(4)
v_mfma_f32_16x16x32_bf16 v[56:59], v[172:175], v[36:39], v[56:59]
v_dot2c_f32_bf16 v60, v36, v62
v_dot2c_f32_bf16 v61, v36, v36
v_dot2c_f32_bf16 v60, v37, v62
v_dot2c_f32_bf16 v61, v37, v37
v_dot2c_f32_bf16 v60, v38, v62
v_dot2c_f32_bf16 v61, v38, v38
v_dot2c_f32_bf16 v60, v39, v62
v_dot2c_f32_bf16 v61, v39, v39
s_waitcnt lgkmcnt(3)
v_mfma_f32_16x16x32_bf16 v[56:59], v[176:179], v[40:43], v[56:59]
v_dot2c_f32_bf16 v60, v40, v62
v_dot2c_f32_bf16 v61, v40, v40
v_dot2c_f32_bf16 v60, v41, v62
v_dot2c_f32_bf16 v61, v41, v41
v_dot2c_f32_bf16 v60, v42, v62
v_dot2c_f32_bf16 v61, v42, v42
v_dot2c_f32_bf16 v60, v43, v62
v_dot2c_f32_bf16 v61, v43, v43
s_waitcnt lgkmcnt(2)
v_mfma_f32_16x16x32_bf16 v[56:59], v[180:183], v[44:47], v[56:59]
v_dot2c_f32_bf16 v60, v44, v62
v_dot2c_f32_bf16 v61, v44, v44
v_dot2c_f32_bf16 v60, v45, v62
v_dot2c_f32_bf16 v61, v45, v45
v_dot2c_f32_bf16 v60, v46, v62
v_dot2c_f32_bf16 v61, v46, v46
v_dot2c_f32_bf16 v60, v47, v62
v_dot2c_f32_bf16 v61, v47, v47
s_waitcnt lgkmcnt(1)
v_mfma_f32_16x16x32_bf16 v[56:59], v[184:187], v[48:51], v[56:59]
v_dot2c_f32_bf16 v60, v48, v62
v_dot2c_f32_bf16 v61, v48, v48
v_dot2c_f32_bf16 v60, v49, v62
v_dot2c_f32_bf16 v61, v49, v49
v_dot2c_f32_bf16 v60, v50, v62
v_dot2c_f32_bf16 v61, v50, v50
v_dot2c_f32_bf16 v60, v51, v62
v_dot2c_f32_bf16 v61, v51, v51
s_waitcnt lgkmcnt(0)
v_mfma_f32_16x16x32_bf16 v[56:59], v[188:191], v[52:55], v[56:59]
v_dot2c_f32_bf16 v60, v52, v62
v_dot2c_f32_bf16 v61, v52, v52
v_dot2c_f32_bf16 v60, v53, v62
v_dot2c_f32_bf16 v61, v53, v53
v_dot2c_f32_bf16 v60, v54, v62
v_dot2c_f32_bf16 v61, v54, v54
v_dot2c_f32_bf16 v60, v55, v62
v_dot2c_f32_bf16 v61, v55, v55
s_nop 1
v_mov_b32 v64, v60
s_nop 1
v_permlane16_swap_b32 v60, v64
v_add_f32 v60, v60, v64
v_mov_b32 v64, v60
s_nop 1
v_permlane32_swap_b32 v60, v64
v_add_f32 v60, v60, v64
v_mov_b32 v64, v61
s_nop 1
v_permlane16_swap_b32 v61, v64
v_add_f32 v61, v61, v64
v_mov_b32 v64, v61
s_nop 1
v_permlane32_swap_b32 v61, v64
v_add_f32 v61, v61, v64
v_mul_f32 v60, 0x3b000000, v60
v_mul_f32 v61, 0x3b000000, v61
v_fma_f32 v61, -v60, v60, v61
v_max_f32 v61, 0, v61
v_add_f32 v61, 0x3727c5ac, v61
v_rsq_f32 v60, v61
s_nop 0
v_pk_mul_f32 v[56:57], v[56:57], v[60:61] op_sel_hi:[1,0]
v_pk_mul_f32 v[58:59], v[58:59], v[60:61] op_sel_hi:[1,0]
v_cvt_pk_bf16_f32 v66, v56, v57
v_cvt_pk_bf16_f32 v67, v58, v59
global_store_dword v63, v66, s[34:35] offset:192
global_store_dword v63, v67, s[32:33] offset:192
K0_end:
s_endpgm

.text
.globl main_kernel
.p2align 8
.type main_kernel,@function
main_kernel:
s_cmp_ge_u32 s2, 256
s_cbranch_scc1 KB_end
s_load_dwordx2 s[4:5], s[0:1], 0
s_load_dwordx2 s[6:7], s[0:1], 80
s_load_dwordx2 s[8:9], s[0:1], 96
v_lshrrev_b32 v1, 6, v0
s_nop 0
v_readfirstlane_b32 s10, v1
v_and_b32 v0, 63, v0
s_getreg_b32 s70, hwreg(HW_REG_XCC_ID)
s_and_b32 s70, s70, 15
s_mov_b32 s13, 0
s_mov_b32 s18, 0
s_mov_b32 s37, 0
s_mov_b32 s38, 0
s_mov_b32 s39, 0
s_waitcnt lgkmcnt(0)
s_cmp_eq_u32 s10, 0
s_cbranch_scc0 KB_tk
s_lshl_b32 s20, s70, 8
v_mov_b32 v1, s20
v_mov_b32 v2, 1
v_mov_b32 v4, 24576
s_mov_b64 exec, 1
global_atomic_add v3, v1, v2, s[8:9] offset:0 sc0 sc1
s_waitcnt vmcnt(0)
ds_write_b32 v4, v3
s_waitcnt lgkmcnt(0)
s_mov_b64 exec, -1
KB_tk:
s_barrier
v_mov_b32 v4, 24576
ds_read_b32 v3, v4
v_and_b32 v1, 15, v0
v_lshlrev_b32 v1, 8, v1
s_mov_b32 s19, 0
KB_el:
global_load_dword v2, v1, s[8:9] offset:0 sc1
s_add_u32 s19, s19, 1
s_cmp_gt_u32 s19, 400000
s_cbranch_scc1 KB_fail
s_waitcnt vmcnt(0) lgkmcnt(0)
s_mov_b32 s20, 0
s_mov_b32 s21, 0
s_mov_b32 s22, 0
v_readlane_b32 s23, v2, 0
s_cmp_lt_u32 0, s70
s_cselect_b32 s24, s23, 0
s_add_u32 s21, s21, s24
s_add_u32 s20, s20, s23
s_or_b32 s22, s22, s23
v_readlane_b32 s23, v2, 1
s_cmp_lt_u32 1, s70
s_cselect_b32 s24, s23, 0
s_add_u32 s21, s21, s24
s_add_u32 s20, s20, s23
s_or_b32 s22, s22, s23
v_readlane_b32 s23, v2, 2
s_cmp_lt_u32 2, s70
s_cselect_b32 s24, s23, 0
s_add_u32 s21, s21, s24
s_add_u32 s20, s20, s23
s_or_b32 s22, s22, s23
v_readlane_b32 s23, v2, 3
s_cmp_lt_u32 3, s70
s_cselect_b32 s24, s23, 0
s_add_u32 s21, s21, s24
s_add_u32 s20, s20, s23
s_or_b32 s22, s22, s23
v_readlane_b32 s23, v2, 4
s_cmp_lt_u32 4, s70
s_cselect_b32 s24, s23, 0
s_add_u32 s21, s21, s24
s_add_u32 s20, s20, s23
s_or_b32 s22, s22, s23
v_readlane_b32 s23, v2, 5
s_cmp_lt_u32 5, s70
s_cselect_b32 s24, s23, 0
s_add_u32 s21, s21, s24
s_add_u32 s20, s20, s23
s_or_b32 s22, s22, s23
v_readlane_b32 s23, v2, 6
s_cmp_lt_u32 6, s70
s_cselect_b32 s24, s23, 0
s_add_u32 s21, s21, s24
s_add_u32 s20, s20, s23
s_or_b32 s22, s22, s23
v_readlane_b32 s23, v2, 7
s_cmp_lt_u32 7, s70
s_cselect_b32 s24, s23, 0
s_add_u32 s21, s21, s24
s_add_u32 s20, s20, s23
s_or_b32 s22, s22, s23
v_readlane_b32 s23, v2, 8
s_cmp_lt_u32 8, s70
s_cselect_b32 s24, s23, 0
s_add_u32 s21, s21, s24
s_add_u32 s20, s20, s23
s_or_b32 s22, s22, s23
v_readlane_b32 s23, v2, 9
s_cmp_lt_u32 9, s70
s_cselect_b32 s24, s23, 0
s_add_u32 s21, s21, s24
s_add_u32 s20, s20, s23
s_or_b32 s22, s22, s23
v_readlane_b32 s23, v2, 10
s_cmp_lt_u32 10, s70
s_cselect_b32 s24, s23, 0
s_add_u32 s21, s21, s24
s_add_u32 s20, s20, s23
s_or_b32 s22, s22, s23
v_readlane_b32 s23, v2, 11
s_cmp_lt_u32 11, s70
s_cselect_b32 s24, s23, 0
s_add_u32 s21, s21, s24
s_add_u32 s20, s20, s23
s_or_b32 s22, s22, s23
v_readlane_b32 s23, v2, 12
s_cmp_lt_u32 12, s70
s_cselect_b32 s24, s23, 0
s_add_u32 s21, s21, s24
s_add_u32 s20, s20, s23
s_or_b32 s22, s22, s23
v_readlane_b32 s23, v2, 13
s_cmp_lt_u32 13, s70
s_cselect_b32 s24, s23, 0
s_add_u32 s21, s21, s24
s_add_u32 s20, s20, s23
s_or_b32 s22, s22, s23
v_readlane_b32 s23, v2, 14
s_cmp_lt_u32 14, s70
s_cselect_b32 s24, s23, 0
s_add_u32 s21, s21, s24
s_add_u32 s20, s20, s23
s_or_b32 s22, s22, s23
v_readlane_b32 s23, v2, 15
s_cmp_lt_u32 15, s70
s_cselect_b32 s24, s23, 0
s_add_u32 s21, s21, s24
s_add_u32 s20, s20, s23
s_or_b32 s22, s22, s23
s_cmp_eq_u32 s20, 256
s_cbranch_scc0 KB_el
v_readfirstlane_b32 s71, v3
s_add_u32 s21, s21, s71
s_lshr_b32 s12, s21, 5
s_and_b32 s12, s12, 7
s_and_b32 s11, s21, 31
s_and_b32 s72, s22, 31
KB_layer:
s_lshl_b32 s20, s13, 21
s_add_u32 s30, s8, s20
s_addc_u32 s31, s9, 0
s_add_u32 s30, s30, 0x600000
s_addc_u32 s31, s31, 0
s_add_u32 s32, s8, s20
s_addc_u32 s33, s9, 0
s_add_u32 s32, s32, 0xa00000
s_addc_u32 s33, s33, 0
v_and_b32 v120, 15, v0
v_lshrrev_b32 v121, 4, v0
v_lshlrev_b32 v1, 4, v0
s_lshl_b32 s14, s10, 12
s_add_u32 s20, s8, s14
s_addc_u32 s21, s9, 0
s_add_u32 s20, s20, 0x90000
s_addc_u32 s21, s21, 0
global_load_dwordx4 v[8:11], v1, s[20:21] offset:0
global_load_dwordx4 v[12:15], v1, s[20:21] offset:1024
global_load_dwordx4 v[16:19], v1, s[20:21] offset:2048
global_load_dwordx4 v[20:23], v1, s[20:21] offset:3072
s_add_u32 s20, s20, 0x8000
s_addc_u32 s21, s21, 0
global_load_dwordx4 v[40:43], v1, s[20:21] offset:0
global_load_dwordx4 v[44:47], v1, s[20:21] offset:1024
global_load_dwordx4 v[48:51], v1, s[20:21] offset:2048
global_load_dwordx4 v[52:55], v1, s[20:21] offset:3072
s_add_u32 s20, s8, 0x94000
s_addc_u32 s21, s9, 0
global_load_dwordx4 v[24:27], v1, s[20:21] offset:0
global_load_dwordx4 v[28:31], v1, s[20:21] offset:1024
global_load_dwordx4 v[32:35], v1, s[20:21] offset:2048
global_load_dwordx4 v[36:39], v1, s[20:21] offset:3072
s_lshl_b32 s14, s2, 13
s_lshl_b32 s15, s10, 11
s_add_u32 s14, s14, s15
s_add_u32 s20, s8, s14
s_addc_u32 s21, s9, 0
s_add_u32 s20, s20, 0x400000
s_addc_u32 s21, s21, 0
global_load_dwordx4 v[104:107], v1, s[20:21] offset:0
global_load_dwordx4 v[108:111], v1, s[20:21] offset:1024
s_add_u32 s20, s8, s15
s_addc_u32 s21, s9, 0
s_add_u32 s20, s20, 0xa0000
s_addc_u32 s21, s21, 0
global_load_dwordx4 v[112:115], v1, s[20:21] offset:0
global_load_dwordx4 v[116:119], v1, s[20:21] offset:1024
s_add_u32 s30, s30, s14
s_addc_u32 s31, s31, 0
s_add_u32 s32, s32, s14
s_addc_u32 s33, s33, 0
v_and_b32 v122, 16, v0
v_lshlrev_b32 v122, 2, v122
v_xor_b32 v7, v122, v1
v_lshrrev_b32 v122, 2, v120
v_lshl_add_u32 v123, v121, 3, v122
v_lshlrev_b32 v123, 7, v123
v_lshrrev_b32 v122, 1, v122
v_lshl_add_u32 v123, v122, 6, v123
v_and_b32 v122, 3, v120
v_lshl_add_u32 v2, v122, 4, v123
v_xor_b32 v3, 64, v2
v_lshlrev_b32 v6, 7, v120
v_lshl_add_u32 v6, v121, 4, v6
v_add_u32 v6, s15, v6
v_and_b32 v122, 2, v120
v_lshlrev_b32 v122, 5, v122
v_xor_b32 v4, v122, v6
v_xor_b32 v5, 64, v4
s_mov_b32 m0, s15
s_cmp_eq_u32 s13, 0
s_cbranch_scc1 KB_y1d
s_lshr_b32 s22, s2, 3
s_lshl_b32 s22, s22, 8
v_lshlrev_b32 v126, 2, v0
s_mov_b32 s19, 0
s_add_u32 s20, s8, s22
s_addc_u32 s21, s9, 0
s_add_u32 s20, s20, 0x5000
s_addc_u32 s21, s21, 0
KB_y1:
global_load_dword v127, v126, s[20:21] sc1
s_add_u32 s19, s19, 1
s_cmp_gt_u32 s19, 400000
s_cbranch_scc1 KB_fail
s_waitcnt vmcnt(0)
v_cmp_eq_u32 vcc, 0, v127
s_cbranch_vccz KB_y1d
s_sleep 2
s_branch KB_y1
KB_y1d:
global_load_lds_dwordx4 v7, s[30:31] sc1
global_load_lds_dwordx4 v7, s[30:31] offset:1024 sc1
s_waitcnt vmcnt(0)
s_barrier
ds_read_b64_tr_b16 v[88:89], v2 offset:0
ds_read_b64_tr_b16 v[90:91], v2 offset:512
ds_read_b64_tr_b16 v[92:93], v2 offset:4096
ds_read_b64_tr_b16 v[94:95], v2 offset:4608
ds_read_b64_tr_b16 v[96:97], v2 offset:8
ds_read_b64_tr_b16 v[98:99], v2 offset:520
ds_read_b64_tr_b16 v[100:101], v2 offset:4104
ds_read_b64_tr_b16 v[102:103], v2 offset:4616
s_waitcnt lgkmcnt(6)
v_mfma_f32_16x16x32_bf16 v[56:59], v[88:91], v[8:11], 0
v_mfma_f32_16x16x32_bf16 v[72:75], v[88:91], v[16:19], 0
ds_read_b64_tr_b16 v[88:89], v3 offset:0
ds_read_b64_tr_b16 v[90:91], v3 offset:512
s_waitcnt lgkmcnt(6)
v_mfma_f32_16x16x32_bf16 v[56:59], v[92:95], v[12:15], v[56:59]
v_mfma_f32_16x16x32_bf16 v[72:75], v[92:95], v[20:23], v[72:75]
ds_read_b64_tr_b16 v[92:93], v3 offset:4096
ds_read_b64_tr_b16 v[94:95], v3 offset:4608
s_waitcnt lgkmcnt(6)
v_mfma_f32_16x16x32_bf16 v[60:63], v[96:99], v[8:11], 0
v_mfma_f32_16x16x32_bf16 v[76:79], v[96:99], v[16:19], 0
ds_read_b64_tr_b16 v[96:97], v3 offset:8
ds_read_b64_tr_b16 v[98:99], v3 offset:520
s_waitcnt lgkmcnt(6)
v_mfma_f32_16x16x32_bf16 v[60:63], v[100:103], v[12:15], v[60:63]
v_mfma_f32_16x16x32_bf16 v[76:79], v[100:103], v[20:23], v[76:79]
ds_read_b64_tr_b16 v[100:101], v3 offset:4104
ds_read_b64_tr_b16 v[102:103], v3 offset:4616
s_waitcnt lgkmcnt(6)
v_mfma_f32_16x16x32_bf16 v[64:67], v[88:91], v[8:11], 0
v_mfma_f32_16x16x32_bf16 v[80:83], v[88:91], v[16:19], 0
s_waitcnt lgkmcnt(4)
v_mfma_f32_16x16x32_bf16 v[64:67], v[92:95], v[12:15], v[64:67]
v_mfma_f32_16x16x32_bf16 v[80:83], v[92:95], v[20:23], v[80:83]
s_waitcnt lgkmcnt(2)
v_mfma_f32_16x16x32_bf16 v[68:71], v[96:99], v[8:11], 0
v_mfma_f32_16x16x32_bf16 v[84:87], v[96:99], v[16:19], 0
s_waitcnt lgkmcnt(0)
v_mfma_f32_16x16x32_bf16 v[68:71], v[100:103], v[12:15], v[68:71]
v_mfma_f32_16x16x32_bf16 v[84:87], v[100:103], v[20:23], v[84:87]
v_sub_f32 v120, v56, v73
v_add_f32 v56, v56, v73
v_mov_b32 v73, v120
v_add_f32 v121, v57, v72
v_sub_f32 v57, v57, v72
v_sub_f32 v72, 0, v121
v_sub_f32 v120, v58, v75
v_add_f32 v58, v58, v75
v_mov_b32 v75, v120
v_add_f32 v121, v59, v74
v_sub_f32 v59, v59, v74
v_sub_f32 v74, 0, v121
v_sub_f32 v120, v60, v77
v_add_f32 v60, v60, v77
v_mov_b32 v77, v120
v_add_f32 v121, v61, v76
v_sub_f32 v61, v61, v76
v_sub_f32 v76, 0, v121
v_sub_f32 v120, v62, v79
v_add_f32 v62, v62, v79
v_mov_b32 v79, v120
v_add_f32 v121, v63, v78
v_sub_f32 v63, v63, v78
v_sub_f32 v78, 0, v121
v_sub_f32 v120, v64, v81
v_add_f32 v64, v64, v81
v_mov_b32 v81, v120
v_add_f32 v121, v65, v80
v_sub_f32 v65, v65, v80
v_sub_f32 v80, 0, v121
v_sub_f32 v120, v66, v83
v_add_f32 v66, v66, v83
v_mov_b32 v83, v120
v_add_f32 v121, v67, v82
v_sub_f32 v67, v67, v82
v_sub_f32 v82, 0, v121
v_sub_f32 v120, v68, v85
v_add_f32 v68, v68, v85
v_mov_b32 v85, v120
v_add_f32 v121, v69, v84
v_sub_f32 v69, v69, v84
v_sub_f32 v84, 0, v121
v_sub_f32 v120, v70, v87
v_add_f32 v70, v70, v87
v_mov_b32 v87, v120
v_add_f32 v121, v71, v86
v_sub_f32 v71, v71, v86
v_sub_f32 v86, 0, v121
v_mul_f32 v120, v56, v40
v_mul_f32 v121, v57, v40
v_fma_f32 v121, -v56, v48, v121
v_fma_f32 v56, v57, v48, v120
v_mov_b32 v57, v121
v_mul_f32 v120, v58, v41
v_mul_f32 v121, v59, v41
v_fma_f32 v121, -v58, v49, v121
v_fma_f32 v58, v59, v49, v120
v_mov_b32 v59, v121
v_mul_f32 v120, v60, v42
v_mul_f32 v121, v61, v42
v_fma_f32 v121, -v60, v50, v121
v_fma_f32 v60, v61, v50, v120
v_mov_b32 v61, v121
v_mul_f32 v120, v62, v43
v_mul_f32 v121, v63, v43
v_fma_f32 v121, -v62, v51, v121
v_fma_f32 v62, v63, v51, v120
v_mov_b32 v63, v121
v_mul_f32 v120, v64, v44
v_mul_f32 v121, v65, v44
v_fma_f32 v121, -v64, v52, v121
v_fma_f32 v64, v65, v52, v120
v_mov_b32 v65, v121
v_mul_f32 v120, v66, v45
v_mul_f32 v121, v67, v45
v_fma_f32 v121, -v66, v53, v121
v_fma_f32 v66, v67, v53, v120
v_mov_b32 v67, v121
v_mul_f32 v120, v68, v46
v_mul_f32 v121, v69, v46
v_fma_f32 v121, -v68, v54, v121
v_fma_f32 v68, v69, v54, v120
v_mov_b32 v69, v121
v_mul_f32 v120, v70, v47
v_mul_f32 v121, v71, v47
v_fma_f32 v121, -v70, v55, v121
v_fma_f32 v70, v71, v55, v120
v_mov_b32 v71, v121
v_cvt_pk_bf16_f32 v88, v56, v58
v_cvt_pk_bf16_f32 v92, v57, v59
v_cvt_pk_bf16_f32 v96, -v56, -v58
v_cvt_pk_bf16_f32 v89, v60, v62
v_cvt_pk_bf16_f32 v93, v61, v63
v_cvt_pk_bf16_f32 v97, -v60, -v62
v_cvt_pk_bf16_f32 v90, v64, v66
v_cvt_pk_bf16_f32 v94, v65, v67
v_cvt_pk_bf16_f32 v98, -v64, -v66
v_cvt_pk_bf16_f32 v91, v68, v70
v_cvt_pk_bf16_f32 v95, v69, v71
v_cvt_pk_bf16_f32 v99, -v68, -v70
v_mfma_f32_16x16x32_bf16 v[56:59], v[24:27], v[88:91], 0
v_mfma_f32_16x16x32_bf16 v[64:67], v[24:27], v[92:95], 0
v_mfma_f32_16x16x32_bf16 v[60:63], v[28:31], v[88:91], 0
v_mfma_f32_16x16x32_bf16 v[68:71], v[28:31], v[92:95], 0
v_mfma_f32_16x16x32_bf16 v[56:59], v[32:35], v[92:95], v[56:59]
v_mfma_f32_16x16x32_bf16 v[64:67], v[32:35], v[96:99], v[64:67]
v_mfma_f32_16x16x32_bf16 v[60:63], v[36:39], v[92:95], v[60:63]
v_mfma_f32_16x16x32_bf16 v[68:71], v[36:39], v[96:99], v[68:71]
v_lshlrev_b32 v120, 16, v104
v_and_b32 v121, 0xffff0000, v104
v_mul_f32 v122, v56, v120
v_mul_f32 v123, v64, v120
v_fmac_f32 v123, v56, v121
v_fma_f32 v56, -v64, v121, v122
v_mov_b32 v64, v123
v_lshlrev_b32 v120, 16, v105
v_and_b32 v121, 0xffff0000, v105
v_mul_f32 v122, v57, v120
v_mul_f32 v123, v65, v120
v_fmac_f32 v123, v57, v121
v_fma_f32 v57, -v65, v121, v122
v_mov_b32 v65, v123
v_lshlrev_b32 v120, 16, v106
v_and_b32 v121, 0xffff0000, v106
v_mul_f32 v122, v58, v120
v_mul_f32 v123, v66, v120
v_fmac_f32 v123, v58, v121
v_fma_f32 v58, -v66, v121, v122
v_mov_b32 v66, v123
v_lshlrev_b32 v120, 16, v107
v_and_b32 v121, 0xffff0000, v107
v_mul_f32 v122, v59, v120
v_mul_f32 v123, v67, v120
v_fmac_f32 v123, v59, v121
v_fma_f32 v59, -v67, v121, v122
v_mov_b32 v67, v123
v_lshlrev_b32 v120, 16, v108
v_and_b32 v121, 0xffff0000, v108
v_mul_f32 v122, v60, v120
v_mul_f32 v123, v68, v120
v_fmac_f32 v123, v60, v121
v_fma_f32 v60, -v68, v121, v122
v_mov_b32 v68, v123
v_lshlrev_b32 v120, 16, v109
v_and_b32 v121, 0xffff0000, v109
v_mul_f32 v122, v61, v120
v_mul_f32 v123, v69, v120
v_fmac_f32 v123, v61, v121
v_fma_f32 v61, -v69, v121, v122
v_mov_b32 v69, v123
v_lshlrev_b32 v120, 16, v110
v_and_b32 v121, 0xffff0000, v110
v_mul_f32 v122, v62, v120
v_mul_f32 v123, v70, v120
v_fmac_f32 v123, v62, v121
v_fma_f32 v62, -v70, v121, v122
v_mov_b32 v70, v123
v_lshlrev_b32 v120, 16, v111
v_and_b32 v121, 0xffff0000, v111
v_mul_f32 v122, v63, v120
v_mul_f32 v123, v71, v120
v_fmac_f32 v123, v63, v121
v_fma_f32 v63, -v71, v121, v122
v_mov_b32 v71, v123
s_cmp_eq_u32 s2, 0
s_cbranch_scc0 KB_c_nz
v_mul_f32 v120, v73, v40
v_mul_f32 v121, v72, v40
v_fma_f32 v121, -v73, v48, v121
v_fma_f32 v73, v72, v48, v120
v_mov_b32 v72, v121
v_mul_f32 v120, v75, v41
v_mul_f32 v121, v74, v41
v_fma_f32 v121, -v75, v49, v121
v_fma_f32 v75, v74, v49, v120
v_mov_b32 v74, v121
v_mul_f32 v120, v77, v42
v_mul_f32 v121, v76, v42
v_fma_f32 v121, -v77, v50, v121
v_fma_f32 v77, v76, v50, v120
v_mov_b32 v76, v121
v_mul_f32 v120, v79, v43
v_mul_f32 v121, v78, v43
v_fma_f32 v121, -v79, v51, v121
v_fma_f32 v79, v78, v51, v120
v_mov_b32 v78, v121
v_mul_f32 v120, v81, v44
v_mul_f32 v121, v80, v44
v_fma_f32 v121, -v81, v52, v121
v_fma_f32 v81, v80, v52, v120
v_mov_b32 v80, v121
v_mul_f32 v120, v83, v45
v_mul_f32 v121, v82, v45
v_fma_f32 v121, -v83, v53, v121
v_fma_f32 v83, v82, v53, v120
v_mov_b32 v82, v121
v_mul_f32 v120, v85, v46
v_mul_f32 v121, v84, v46
v_fma_f32 v121, -v85, v54, v121
v_fma_f32 v85, v84, v54, v120
v_mov_b32 v84, v121
v_mul_f32 v120, v87, v47
v_mul_f32 v121, v86, v47
v_fma_f32 v121, -v87, v55, v121
v_fma_f32 v87, v86, v55, v120
v_mov_b32 v86, v121
v_cvt_pk_bf16_f32 v88, v73, v75
v_cvt_pk_bf16_f32 v92, v72, v74
v_cvt_pk_bf16_f32 v96, -v73, -v75
v_cvt_pk_bf16_f32 v89, v77, v79
v_cvt_pk_bf16_f32 v93, v76, v78
v_cvt_pk_bf16_f32 v97, -v77, -v79
v_cvt_pk_bf16_f32 v90, v81, v83
v_cvt_pk_bf16_f32 v94, v80, v82
v_cvt_pk_bf16_f32 v98, -v81, -v83
v_cvt_pk_bf16_f32 v91, v85, v87
v_cvt_pk_bf16_f32 v95, v84, v86
v_cvt_pk_bf16_f32 v99, -v85, -v87
v_mfma_f32_16x16x32_bf16 v[72:75], v[24:27], v[88:91], 0
v_mfma_f32_16x16x32_bf16 v[80:83], v[24:27], v[92:95], 0
v_mfma_f32_16x16x32_bf16 v[76:79], v[28:31], v[88:91], 0
v_mfma_f32_16x16x32_bf16 v[84:87], v[28:31], v[92:95], 0
v_mfma_f32_16x16x32_bf16 v[72:75], v[32:35], v[92:95], v[72:75]
v_mfma_f32_16x16x32_bf16 v[80:83], v[32:35], v[96:99], v[80:83]
v_mfma_f32_16x16x32_bf16 v[76:79], v[36:39], v[92:95], v[76:79]
v_mfma_f32_16x16x32_bf16 v[84:87], v[36:39], v[96:99], v[84:87]
v_lshlrev_b32 v120, 16, v112
v_and_b32 v121, 0xffff0000, v112
v_fmac_f32 v56, v72, v120
v_fmac_f32 v64, v80, v120
v_fma_f32 v56, -v80, v121, v56
v_fmac_f32 v64, v72, v121
v_lshlrev_b32 v120, 16, v113
v_and_b32 v121, 0xffff0000, v113
v_fmac_f32 v57, v73, v120
v_fmac_f32 v65, v81, v120
v_fma_f32 v57, -v81, v121, v57
v_fmac_f32 v65, v73, v121
v_lshlrev_b32 v120, 16, v114
v_and_b32 v121, 0xffff0000, v114
v_fmac_f32 v58, v74, v120
v_fmac_f32 v66, v82, v120
v_fma_f32 v58, -v82, v121, v58
v_fmac_f32 v66, v74, v121
v_lshlrev_b32 v120, 16, v115
v_and_b32 v121, 0xffff0000, v115
v_fmac_f32 v59, v75, v120
v_fmac_f32 v67, v83, v120
v_fma_f32 v59, -v83, v121, v59
v_fmac_f32 v67, v75, v121
v_lshlrev_b32 v120, 16, v116
v_and_b32 v121, 0xffff0000, v116
v_fmac_f32 v60, v76, v120
v_fmac_f32 v68, v84, v120
v_fma_f32 v60, -v84, v121, v60
v_fmac_f32 v68, v76, v121
v_lshlrev_b32 v120, 16, v117
v_and_b32 v121, 0xffff0000, v117
v_fmac_f32 v61, v77, v120
v_fmac_f32 v69, v85, v120
v_fma_f32 v61, -v85, v121, v61
v_fmac_f32 v69, v77, v121
v_lshlrev_b32 v120, 16, v118
v_and_b32 v121, 0xffff0000, v118
v_fmac_f32 v62, v78, v120
v_fmac_f32 v70, v86, v120
v_fma_f32 v62, -v86, v121, v62
v_fmac_f32 v70, v78, v121
v_lshlrev_b32 v120, 16, v119
v_and_b32 v121, 0xffff0000, v119
v_fmac_f32 v63, v79, v120
v_fmac_f32 v71, v87, v120
v_fma_f32 v63, -v87, v121, v63
v_fmac_f32 v71, v79, v121
KB_c_nz:
v_cvt_pk_bf16_f32 v88, v56, v57
v_cvt_pk_bf16_f32 v92, -v64, -v65
v_cvt_pk_bf16_f32 v96, -v56, -v57
v_cvt_pk_bf16_f32 v89, v58, v59
v_cvt_pk_bf16_f32 v93, -v66, -v67
v_cvt_pk_bf16_f32 v97, -v58, -v59
v_cvt_pk_bf16_f32 v90, v60, v61
v_cvt_pk_bf16_f32 v94, -v68, -v69
v_cvt_pk_bf16_f32 v98, -v60, -v61
v_cvt_pk_bf16_f32 v91, v62, v63
v_cvt_pk_bf16_f32 v95, -v70, -v71
v_cvt_pk_bf16_f32 v99, -v62, -v63
v_mfma_f32_16x16x32_bf16 v[72:75], v[24:27], v[88:91], 0
v_mfma_f32_16x16x32_bf16 v[80:83], v[24:27], v[92:95], 0
v_mfma_f32_16x16x32_bf16 v[76:79], v[28:31], v[88:91], 0
v_mfma_f32_16x16x32_bf16 v[84:87], v[28:31], v[92:95], 0
v_mfma_f32_16x16x32_bf16 v[72:75], v[32:35], v[92:95], v[72:75]
v_mfma_f32_16x16x32_bf16 v[80:83], v[32:35], v[96:99], v[80:83]
v_mfma_f32_16x16x32_bf16 v[76:79], v[36:39], v[92:95], v[76:79]
v_mfma_f32_16x16x32_bf16 v[84:87], v[36:39], v[96:99], v[84:87]
v_mul_f32 v120, v72, v40
v_mul_f32 v121, v80, v40
v_fma_f32 v121, -v72, v48, v121
v_fma_f32 v72, v80, v48, v120
v_mov_b32 v80, v121
v_mul_f32 v120, v73, v41
v_mul_f32 v121, v81, v41
v_fma_f32 v121, -v73, v49, v121
v_fma_f32 v73, v81, v49, v120
v_mov_b32 v81, v121
v_mul_f32 v120, v74, v42
v_mul_f32 v121, v82, v42
v_fma_f32 v121, -v74, v50, v121
v_fma_f32 v74, v82, v50, v120
v_mov_b32 v82, v121
v_mul_f32 v120, v75, v43
v_mul_f32 v121, v83, v43
v_fma_f32 v121, -v75, v51, v121
v_fma_f32 v75, v83, v51, v120
v_mov_b32 v83, v121
v_mul_f32 v120, v76, v44
v_mul_f32 v121, v84, v44
v_fma_f32 v121, -v76, v52, v121
v_fma_f32 v76, v84, v52, v120
v_mov_b32 v84, v121
v_mul_f32 v120, v77, v45
v_mul_f32 v121, v85, v45
v_fma_f32 v121, -v77, v53, v121
v_fma_f32 v77, v85, v53, v120
v_mov_b32 v85, v121
v_mul_f32 v120, v78, v46
v_mul_f32 v121, v86, v46
v_fma_f32 v121, -v78, v54, v121
v_fma_f32 v78, v86, v54, v120
v_mov_b32 v86, v121
v_mul_f32 v120, v79, v47
v_mul_f32 v121, v87, v47
v_fma_f32 v121, -v79, v55, v121
v_fma_f32 v79, v87, v55, v120
v_mov_b32 v87, v121
v_cvt_pk_bf16_f32 v56, v72, v80
v_cvt_pk_bf16_f32 v57, v73, v81
v_cvt_pk_bf16_f32 v58, v74, v82
v_cvt_pk_bf16_f32 v59, v75, v83
v_cvt_pk_bf16_f32 v60, v76, v84
v_cvt_pk_bf16_f32 v61, v77, v85
v_cvt_pk_bf16_f32 v62, v78, v86
v_cvt_pk_bf16_f32 v63, v79, v87
ds_write_b128 v4, v[56:59] offset:8192
ds_write_b128 v5, v[60:63] offset:8192
s_waitcnt lgkmcnt(0)
s_barrier
ds_read_b64_tr_b16 v[88:89], v2 offset:8192
ds_read_b64_tr_b16 v[90:91], v2 offset:8704
ds_read_b64_tr_b16 v[92:93], v2 offset:12288
ds_read_b64_tr_b16 v[94:95], v2 offset:12800
ds_read_b64_tr_b16 v[96:97], v2 offset:8200
ds_read_b64_tr_b16 v[98:99], v2 offset:8712
ds_read_b64_tr_b16 v[100:101], v2 offset:12296
ds_read_b64_tr_b16 v[102:103], v2 offset:12808
s_waitcnt lgkmcnt(6)
v_mfma_f32_16x16x32_bf16 v[56:59], v[88:91], v[8:11], 0
v_mfma_f32_16x16x32_bf16 v[72:75], v[88:91], v[16:19], 0
ds_read_b64_tr_b16 v[88:89], v3 offset:8192
ds_read_b64_tr_b16 v[90:91], v3 offset:8704
s_waitcnt lgkmcnt(6)
v_mfma_f32_16x16x32_bf16 v[56:59], v[92:95], v[12:15], v[56:59]
v_mfma_f32_16x16x32_bf16 v[72:75], v[92:95], v[20:23], v[72:75]
ds_read_b64_tr_b16 v[92:93], v3 offset:12288
ds_read_b64_tr_b16 v[94:95], v3 offset:12800
s_waitcnt lgkmcnt(6)
v_mfma_f32_16x16x32_bf16 v[60:63], v[96:99], v[8:11], 0
v_mfma_f32_16x16x32_bf16 v[76:79], v[96:99], v[16:19], 0
ds_read_b64_tr_b16 v[96:97], v3 offset:8200
ds_read_b64_tr_b16 v[98:99], v3 offset:8712
s_waitcnt lgkmcnt(6)
v_mfma_f32_16x16x32_bf16 v[60:63], v[100:103], v[12:15], v[60:63]
v_mfma_f32_16x16x32_bf16 v[76:79], v[100:103], v[20:23], v[76:79]
ds_read_b64_tr_b16 v[100:101], v3 offset:12296
ds_read_b64_tr_b16 v[102:103], v3 offset:12808
s_waitcnt lgkmcnt(6)
v_mfma_f32_16x16x32_bf16 v[64:67], v[88:91], v[8:11], 0
v_mfma_f32_16x16x32_bf16 v[80:83], v[88:91], v[16:19], 0
s_waitcnt lgkmcnt(4)
v_mfma_f32_16x16x32_bf16 v[64:67], v[92:95], v[12:15], v[64:67]
v_mfma_f32_16x16x32_bf16 v[80:83], v[92:95], v[20:23], v[80:83]
s_waitcnt lgkmcnt(2)
v_mfma_f32_16x16x32_bf16 v[68:71], v[96:99], v[8:11], 0
v_mfma_f32_16x16x32_bf16 v[84:87], v[96:99], v[16:19], 0
s_waitcnt lgkmcnt(0)
v_mfma_f32_16x16x32_bf16 v[68:71], v[100:103], v[12:15], v[68:71]
v_mfma_f32_16x16x32_bf16 v[84:87], v[100:103], v[20:23], v[84:87]
v_add_f32 v56, v56, v73
v_sub_f32 v57, v72, v57
v_cvt_pk_bf16_f32 v88, v56, v57
v_add_f32 v58, v58, v75
v_sub_f32 v59, v74, v59
v_cvt_pk_bf16_f32 v89, v58, v59
v_add_f32 v60, v60, v77
v_sub_f32 v61, v76, v61
v_cvt_pk_bf16_f32 v90, v60, v61
v_add_f32 v62, v62, v79
v_sub_f32 v63, v78, v63
v_cvt_pk_bf16_f32 v91, v62, v63
v_add_f32 v64, v64, v81
v_sub_f32 v65, v80, v65
v_cvt_pk_bf16_f32 v92, v64, v65
v_add_f32 v66, v66, v83
v_sub_f32 v67, v82, v67
v_cvt_pk_bf16_f32 v93, v66, v67
v_add_f32 v68, v68, v85
v_sub_f32 v69, v84, v69
v_cvt_pk_bf16_f32 v94, v68, v69
v_add_f32 v70, v70, v87
v_sub_f32 v71, v86, v71
v_cvt_pk_bf16_f32 v95, v70, v71
ds_write_b128 v6, v[88:91] offset:16384
ds_write_b128 v6, v[92:95] offset:16448
v_add_u32 v120, s15, v1
ds_read_b128 v[96:99], v120 offset:16384
ds_read_b128 v[100:103], v120 offset:17408
s_waitcnt lgkmcnt(1)
global_store_dwordx4 v1, v[96:99], s[32:33] sc1
s_waitcnt lgkmcnt(0)
global_store_dwordx4 v1, v[100:103], s[32:33] offset:1024 sc1
s_cmp_eq_u32 s72, 0
s_cbranch_scc0 KB_cs
s_add_u32 s18, s18, 1
s_waitcnt vmcnt(0)
s_barrier
s_cmp_eq_u32 s10, 0
s_cbranch_scc0 KB_cgf_d
s_lshl_b32 s22, s12, 8
s_add_u32 s20, s8, s22
s_addc_u32 s21, s9, 0
s_add_u32 s20, s20, 0x1000
s_addc_u32 s21, s21, 0
v_mov_b32 v127, s18
v_and_b32 v126, 31, v0
v_lshlrev_b32 v126, 2, v126
v_cmp_eq_u32 vcc, s11, v0
s_mov_b64 exec, vcc
global_store_dword v126, v127, s[20:21]
s_mov_b64 exec, -1
s_mov_b32 s19, 0
KB_cgf_p:
global_load_dword v127, v126, s[20:21] sc1
s_add_u32 s19, s19, 1
s_cmp_gt_u32 s19, 400000
s_cbranch_scc1 KB_fail
s_waitcnt vmcnt(0)
v_cmp_gt_u32 vcc, s18, v127
s_cbranch_vccnz KB_cgf_p
KB_cgf_d:
s_barrier
s_branch KB_cd
KB_cs:
s_add_u32 s18, s18, 1
s_waitcnt vmcnt(0)
s_barrier
s_cmp_eq_u32 s10, 0
s_cbranch_scc0 KB_cgs_d
s_lshl_b32 s22, s12, 8
s_add_u32 s20, s8, s22
s_addc_u32 s21, s9, 0
s_add_u32 s20, s20, 0x1000
s_addc_u32 s21, s21, 0
v_mov_b32 v127, s18
v_and_b32 v126, 31, v0
v_lshlrev_b32 v126, 2, v126
v_cmp_eq_u32 vcc, s11, v0
s_mov_b64 exec, vcc
global_store_dword v126, v127, s[20:21] sc1
s_mov_b64 exec, -1
s_mov_b32 s19, 0
KB_cgs_p:
global_load_dword v127, v126, s[20:21] sc1
s_add_u32 s19, s19, 1
s_cmp_gt_u32 s19, 400000
s_cbranch_scc1 KB_fail
s_waitcnt vmcnt(0)
v_cmp_gt_u32 vcc, s18, v127
s_cbranch_vccnz KB_cgs_p
KB_cgs_d:
s_barrier
KB_cd:
s_cmp_eq_u32 s11, 0
s_cbranch_scc0 KB_y2f
s_lshl_b32 s14, s12, 6
s_cmp_eq_u32 s10, 0
s_cbranch_scc0 KB_y2f
s_lshl_b32 s22, s14, 2
s_add_u32 s20, s8, s22
s_addc_u32 s21, s9, 0
s_add_u32 s20, s20, 0x7000
s_addc_u32 s21, s21, 0
s_add_u32 s22, s13, 1
v_mov_b32 v126, 0
v_mov_b32 v127, s22
s_mov_b64 exec, 1
global_store_dword v126, v127, s[20:21] sc1
s_mov_b64 exec, -1
KB_y2f:
s_cmp_eq_u32 s13, 0
s_cbranch_scc0 KB_roles
s_load_dwordx4 s[24:27], s[0:1], 40
s_load_dwordx4 s[28:31], s[0:1], 56
v_and_b32 v10, 15, v0
v_lshrrev_b32 v11, 4, v0
v_lshrrev_b32 v13, 2, v0
v_lshlrev_b32 v1, 13, v13
v_and_b32 v13, 3, v0
v_lshl_add_u32 v1, v13, 4, v1
s_lshl_b32 s14, s11, 8
s_lshl_b32 s15, s10, 6
s_add_u32 s14, s14, s15
v_add_u32 v1, s14, v1
v_lshrrev_b32 v14, 3, v0
v_lshlrev_b32 v2, 10, v14
v_and_b32 v14, 7, v0
v_lshl_add_u32 v2, v14, 4, v2
s_lshl_b32 s14, s11, 17
s_lshl_b32 s15, s10, 7
s_add_u32 s14, s14, s15
v_add_u32 v2, s14, v2
s_lshl_b32 s17, s10, 15
s_add_u32 s17, s17, 32768
v_lshlrev_b32 v9, 4, v0
v_add_u32 v9, s17, v9
v_lshrrev_b32 v12, 2, v10
v_lshrrev_b32 v14, 1, v11
v_lshlrev_b32 v6, 4, v14
v_and_b32 v14, 1, v11
v_lshl_add_u32 v6, v14, 2, v6
v_and_b32 v14, 1, v12
v_add_u32 v6, v6, v14
v_lshrrev_b32 v12, 1, v12
v_lshl_add_u32 v6, v12, 3, v6
v_lshlrev_b32 v6, 6, v6
v_lshl_add_u32 v6, v13, 3, v6
v_add_u32 v6, s17, v6
v_lshl_add_u32 v4, v12, 12, v6
v_xor_b32 v5, 512, v4
v_and_b32 v14, 1, v11
v_lshlrev_b32 v7, 11, v14
v_lshrrev_b32 v14, 1, v11
v_lshl_add_u32 v7, v14, 9, v7
v_lshl_add_u32 v7, v10, 2, v7
v_add_u32 v7, s17, v7
v_xor_b32 v8, 2048, v7
s_mov_b32 s22, 0x05040100
s_mov_b32 s23, 0x07060302
s_waitcnt lgkmcnt(0)
s_bitcmp1_b32 s10, 0
s_cbranch_scc1 LW_odd
s_lshl_b32 s14, s10, 1
s_add_u32 s14, s14, 2
s_and_b32 s14, s14, 7
s_lshl_b32 s14, s14, 19
s_add_u32 s15, s14, 0
s_add_u32 m0, s17, 0
v_add_u32 v3, s15, v1
global_load_lds_dwordx4 v3, s[24:25]
s_add_u32 s15, s14, 131072
s_add_u32 m0, s17, 1024
v_add_u32 v3, s15, v1
global_load_lds_dwordx4 v3, s[24:25]
s_add_u32 s15, s14, 262144
s_add_u32 m0, s17, 2048
v_add_u32 v3, s15, v1
global_load_lds_dwordx4 v3, s[24:25]
s_add_u32 s15, s14, 393216
s_add_u32 m0, s17, 3072
v_add_u32 v3, s15, v1
global_load_lds_dwordx4 v3, s[24:25]
s_add_u32 s15, s14, 0
s_add_u32 m0, s17, 4096
v_add_u32 v3, s15, v1
global_load_lds_dwordx4 v3, s[26:27]
s_add_u32 s15, s14, 131072
s_add_u32 m0, s17, 5120
v_add_u32 v3, s15, v1
global_load_lds_dwordx4 v3, s[26:27]
s_add_u32 s15, s14, 262144
s_add_u32 m0, s17, 6144
v_add_u32 v3, s15, v1
global_load_lds_dwordx4 v3, s[26:27]
s_add_u32 s15, s14, 393216
s_add_u32 m0, s17, 7168
v_add_u32 v3, s15, v1
global_load_lds_dwordx4 v3, s[26:27]
s_lshl_b32 s14, s10, 1
s_add_u32 s14, s14, 6
s_and_b32 s14, s14, 7
s_lshl_b32 s14, s14, 19
s_add_u32 s15, s14, 0
s_add_u32 m0, s17, 8192
v_add_u32 v3, s15, v1
global_load_lds_dwordx4 v3, s[24:25]
s_add_u32 s15, s14, 131072
s_add_u32 m0, s17, 9216
v_add_u32 v3, s15, v1
global_load_lds_dwordx4 v3, s[24:25]
s_add_u32 s15, s14, 262144
s_add_u32 m0, s17, 10240
v_add_u32 v3, s15, v1
global_load_lds_dwordx4 v3, s[24:25]
s_add_u32 s15, s14, 393216
s_add_u32 m0, s17, 11264
v_add_u32 v3, s15, v1
global_load_lds_dwordx4 v3, s[24:25]
s_add_u32 s15, s14, 0
s_add_u32 m0, s17, 12288
v_add_u32 v3, s15, v1
global_load_lds_dwordx4 v3, s[26:27]
s_add_u32 s15, s14, 131072
s_add_u32 m0, s17, 13312
v_add_u32 v3, s15, v1
global_load_lds_dwordx4 v3, s[26:27]
s_add_u32 s15, s14, 262144
s_add_u32 m0, s17, 14336
v_add_u32 v3, s15, v1
global_load_lds_dwordx4 v3, s[26:27]
s_add_u32 s15, s14, 393216
s_add_u32 m0, s17, 15360
v_add_u32 v3, s15, v1
global_load_lds_dwordx4 v3, s[26:27]
s_lshl_b32 s14, s10, 1
s_add_u32 s14, s14, 4
s_and_b32 s14, s14, 7
s_lshl_b32 s14, s14, 19
s_add_u32 s15, s14, 0
s_add_u32 m0, s17, 16384
v_add_u32 v3, s15, v1
global_load_lds_dwordx4 v3, s[28:29]
s_add_u32 s15, s14, 131072
s_add_u32 m0, s17, 17408
v_add_u32 v3, s15, v1
global_load_lds_dwordx4 v3, s[28:29]
s_add_u32 s15, s14, 262144
s_add_u32 m0, s17, 18432
v_add_u32 v3, s15, v1
global_load_lds_dwordx4 v3, s[28:29]
s_add_u32 s15, s14, 393216
s_add_u32 m0, s17, 19456
v_add_u32 v3, s15, v1
global_load_lds_dwordx4 v3, s[28:29]
s_add_u32 s15, s14, 524288
s_add_u32 m0, s17, 20480
v_add_u32 v3, s15, v1
global_load_lds_dwordx4 v3, s[28:29]
s_add_u32 s15, s14, 655360
s_add_u32 m0, s17, 21504
v_add_u32 v3, s15, v1
global_load_lds_dwordx4 v3, s[28:29]
s_add_u32 s15, s14, 786432
s_add_u32 m0, s17, 22528
v_add_u32 v3, s15, v1
global_load_lds_dwordx4 v3, s[28:29]
s_add_u32 s15, s14, 917504
s_add_u32 m0, s17, 23552
v_add_u32 v3, s15, v1
global_load_lds_dwordx4 v3, s[28:29]
s_lshl_b32 s14, s10, 1
s_add_u32 s14, s14, 6
s_and_b32 s14, s14, 7
s_lshl_b32 s14, s14, 19
s_add_u32 s15, s14, 0
s_add_u32 m0, s17, 24576
v_add_u32 v3, s15, v1
global_load_lds_dwordx4 v3, s[28:29]
s_add_u32 s15, s14, 131072
s_add_u32 m0, s17, 25600
v_add_u32 v3, s15, v1
global_load_lds_dwordx4 v3, s[28:29]
s_add_u32 s15, s14, 262144
s_add_u32 m0, s17, 26624
v_add_u32 v3, s15, v1
global_load_lds_dwordx4 v3, s[28:29]
s_add_u32 s15, s14, 393216
s_add_u32 m0, s17, 27648
v_add_u32 v3, s15, v1
global_load_lds_dwordx4 v3, s[28:29]
s_add_u32 s15, s14, 524288
s_add_u32 m0, s17, 28672
v_add_u32 v3, s15, v1
global_load_lds_dwordx4 v3, s[28:29]
s_add_u32 s15, s14, 655360
s_add_u32 m0, s17, 29696
v_add_u32 v3, s15, v1
global_load_lds_dwordx4 v3, s[28:29]
s_add_u32 s15, s14, 786432
s_add_u32 m0, s17, 30720
v_add_u32 v3, s15, v1
global_load_lds_dwordx4 v3, s[28:29]
s_add_u32 s15, s14, 917504
s_add_u32 m0, s17, 31744
v_add_u32 v3, s15, v1
global_load_lds_dwordx4 v3, s[28:29]
s_waitcnt vmcnt(24)
ds_read_b64_tr_b16 v[232:233], v4 offset:0
ds_read_b64_tr_b16 v[234:235], v4 offset:128
ds_read_b64_tr_b16 v[236:237], v4 offset:2048
ds_read_b64_tr_b16 v[238:239], v4 offset:2176
ds_read_b64_tr_b16 v[240:241], v4 offset:32
ds_read_b64_tr_b16 v[242:243], v4 offset:160
ds_read_b64_tr_b16 v[244:245], v4 offset:2080
ds_read_b64_tr_b16 v[246:247], v4 offset:2208
s_waitcnt lgkmcnt(7)
ds_read_b64_tr_b16 v[248:249], v5 offset:0
ds_read_b64_tr_b16 v[250:251], v5 offset:128
ds_read_b64_tr_b16 v[252:253], v5 offset:2048
ds_read_b64_tr_b16 v[254:255], v5 offset:2176
ds_read_b64_tr_b16 a[0:1], v5 offset:32
ds_read_b64_tr_b16 a[2:3], v5 offset:160
ds_read_b64_tr_b16 a[4:5], v5 offset:2080
ds_read_b64_tr_b16 a[6:7], v5 offset:2208
s_waitcnt lgkmcnt(0)
s_add_u32 s14, s10, 1
s_and_b32 s14, s14, 3
s_lshl_b32 s14, s14, 15
s_add_u32 s15, s14, 0
s_add_u32 m0, s17, 0
v_add_u32 v3, s15, v2
global_load_lds_dwordx4 v3, s[30:31]
s_add_u32 s15, s14, 8192
s_add_u32 m0, s17, 1024
v_add_u32 v3, s15, v2
global_load_lds_dwordx4 v3, s[30:31]
s_add_u32 s15, s14, 16384
s_add_u32 m0, s17, 2048
v_add_u32 v3, s15, v2
global_load_lds_dwordx4 v3, s[30:31]
s_add_u32 s15, s14, 24576
s_add_u32 m0, s17, 3072
v_add_u32 v3, s15, v2
global_load_lds_dwordx4 v3, s[30:31]
s_add_u32 s15, s14, 512
s_add_u32 m0, s17, 4096
v_add_u32 v3, s15, v2
global_load_lds_dwordx4 v3, s[30:31]
s_add_u32 s15, s14, 8704
s_add_u32 m0, s17, 5120
v_add_u32 v3, s15, v2
global_load_lds_dwordx4 v3, s[30:31]
s_add_u32 s15, s14, 16896
s_add_u32 m0, s17, 6144
v_add_u32 v3, s15, v2
global_load_lds_dwordx4 v3, s[30:31]
s_add_u32 s15, s14, 25088
s_add_u32 m0, s17, 7168
v_add_u32 v3, s15, v2
global_load_lds_dwordx4 v3, s[30:31]
s_waitcnt vmcnt(24)
ds_read_b64_tr_b16 a[8:9], v4 offset:8192
ds_read_b64_tr_b16 a[10:11], v4 offset:8320
ds_read_b64_tr_b16 a[12:13], v4 offset:10240
ds_read_b64_tr_b16 a[14:15], v4 offset:10368
ds_read_b64_tr_b16 a[16:17], v4 offset:8224
ds_read_b64_tr_b16 a[18:19], v4 offset:8352
ds_read_b64_tr_b16 a[20:21], v4 offset:10272
ds_read_b64_tr_b16 a[22:23], v4 offset:10400
s_waitcnt lgkmcnt(7)
ds_read_b64_tr_b16 a[24:25], v5 offset:8192
ds_read_b64_tr_b16 a[26:27], v5 offset:8320
ds_read_b64_tr_b16 a[28:29], v5 offset:10240
ds_read_b64_tr_b16 a[30:31], v5 offset:10368
ds_read_b64_tr_b16 a[32:33], v5 offset:8224
ds_read_b64_tr_b16 a[34:35], v5 offset:8352
ds_read_b64_tr_b16 a[36:37], v5 offset:10272
ds_read_b64_tr_b16 a[38:39], v5 offset:10400
s_waitcnt lgkmcnt(0)
s_add_u32 s14, s10, 2
s_and_b32 s14, s14, 3
s_lshl_b32 s14, s14, 15
s_add_u32 s15, s14, 0
s_add_u32 m0, s17, 8192
v_add_u32 v3, s15, v2
global_load_lds_dwordx4 v3, s[30:31]
s_add_u32 s15, s14, 8192
s_add_u32 m0, s17, 9216
v_add_u32 v3, s15, v2
global_load_lds_dwordx4 v3, s[30:31]
s_add_u32 s15, s14, 16384
s_add_u32 m0, s17, 10240
v_add_u32 v3, s15, v2
global_load_lds_dwordx4 v3, s[30:31]
s_add_u32 s15, s14, 24576
s_add_u32 m0, s17, 11264
v_add_u32 v3, s15, v2
global_load_lds_dwordx4 v3, s[30:31]
s_add_u32 s15, s14, 512
s_add_u32 m0, s17, 12288
v_add_u32 v3, s15, v2
global_load_lds_dwordx4 v3, s[30:31]
s_add_u32 s15, s14, 8704
s_add_u32 m0, s17, 13312
v_add_u32 v3, s15, v2
global_load_lds_dwordx4 v3, s[30:31]
s_add_u32 s15, s14, 16896
s_add_u32 m0, s17, 14336
v_add_u32 v3, s15, v2
global_load_lds_dwordx4 v3, s[30:31]
s_add_u32 s15, s14, 25088
s_add_u32 m0, s17, 15360
v_add_u32 v3, s15, v2
global_load_lds_dwordx4 v3, s[30:31]
s_waitcnt vmcnt(24)
ds_read_b64_tr_b16 a[40:41], v6 offset:16384
ds_read_b64_tr_b16 a[42:43], v6 offset:16512
ds_read_b64_tr_b16 a[44:45], v6 offset:18432
ds_read_b64_tr_b16 a[46:47], v6 offset:18560
ds_read_b64_tr_b16 a[48:49], v6 offset:16416
ds_read_b64_tr_b16 a[50:51], v6 offset:16544
ds_read_b64_tr_b16 a[52:53], v6 offset:18464
ds_read_b64_tr_b16 a[54:55], v6 offset:18592
s_waitcnt lgkmcnt(7)
ds_read_b64_tr_b16 a[56:57], v6 offset:20480
ds_read_b64_tr_b16 a[58:59], v6 offset:20608
ds_read_b64_tr_b16 a[60:61], v6 offset:22528
ds_read_b64_tr_b16 a[62:63], v6 offset:22656
ds_read_b64_tr_b16 a[64:65], v6 offset:20512
ds_read_b64_tr_b16 a[66:67], v6 offset:20640
ds_read_b64_tr_b16 a[68:69], v6 offset:22560
ds_read_b64_tr_b16 a[70:71], v6 offset:22688
s_waitcnt lgkmcnt(0)
s_add_u32 s14, s10, 3
s_and_b32 s14, s14, 3
s_lshl_b32 s14, s14, 15
s_add_u32 s15, s14, 0
s_add_u32 m0, s17, 16384
v_add_u32 v3, s15, v2
global_load_lds_dwordx4 v3, s[30:31]
s_add_u32 s15, s14, 8192
s_add_u32 m0, s17, 17408
v_add_u32 v3, s15, v2
global_load_lds_dwordx4 v3, s[30:31]
s_add_u32 s15, s14, 16384
s_add_u32 m0, s17, 18432
v_add_u32 v3, s15, v2
global_load_lds_dwordx4 v3, s[30:31]
s_add_u32 s15, s14, 24576
s_add_u32 m0, s17, 19456
v_add_u32 v3, s15, v2
global_load_lds_dwordx4 v3, s[30:31]
s_add_u32 s15, s14, 512
s_add_u32 m0, s17, 20480
v_add_u32 v3, s15, v2
global_load_lds_dwordx4 v3, s[30:31]
s_add_u32 s15, s14, 8704
s_add_u32 m0, s17, 21504
v_add_u32 v3, s15, v2
global_load_lds_dwordx4 v3, s[30:31]
s_add_u32 s15, s14, 16896
s_add_u32 m0, s17, 22528
v_add_u32 v3, s15, v2
global_load_lds_dwordx4 v3, s[30:31]
s_add_u32 s15, s14, 25088
s_add_u32 m0, s17, 23552
v_add_u32 v3, s15, v2
global_load_lds_dwordx4 v3, s[30:31]
s_waitcnt vmcnt(24)
ds_read_b64_tr_b16 a[72:73], v6 offset:24576
ds_read_b64_tr_b16 a[74:75], v6 offset:24704
ds_read_b64_tr_b16 a[76:77], v6 offset:26624
ds_read_b64_tr_b16 a[78:79], v6 offset:26752
ds_read_b64_tr_b16 a[80:81], v6 offset:24608
ds_read_b64_tr_b16 a[82:83], v6 offset:24736
ds_read_b64_tr_b16 a[84:85], v6 offset:26656
ds_read_b64_tr_b16 a[86:87], v6 offset:26784
s_waitcnt lgkmcnt(7)
ds_read_b64_tr_b16 a[88:89], v6 offset:28672
ds_read_b64_tr_b16 a[90:91], v6 offset:28800
ds_read_b64_tr_b16 a[92:93], v6 offset:30720
ds_read_b64_tr_b16 a[94:95], v6 offset:30848
ds_read_b64_tr_b16 a[96:97], v6 offset:28704
ds_read_b64_tr_b16 a[98:99], v6 offset:28832
ds_read_b64_tr_b16 a[100:101], v6 offset:30752
ds_read_b64_tr_b16 a[102:103], v6 offset:30880
s_waitcnt lgkmcnt(0)
s_lshl_b32 s14, s10, 1
s_add_u32 s14, s14, 3
s_and_b32 s14, s14, 7
s_lshl_b32 s14, s14, 19
s_add_u32 s15, s14, 0
s_add_u32 m0, s17, 24576
v_add_u32 v3, s15, v1
global_load_lds_dwordx4 v3, s[24:25]
s_add_u32 s15, s14, 131072
s_add_u32 m0, s17, 25600
v_add_u32 v3, s15, v1
global_load_lds_dwordx4 v3, s[24:25]
s_add_u32 s15, s14, 262144
s_add_u32 m0, s17, 26624
v_add_u32 v3, s15, v1
global_load_lds_dwordx4 v3, s[24:25]
s_add_u32 s15, s14, 393216
s_add_u32 m0, s17, 27648
v_add_u32 v3, s15, v1
global_load_lds_dwordx4 v3, s[24:25]
s_add_u32 s15, s14, 0
s_add_u32 m0, s17, 28672
v_add_u32 v3, s15, v1
global_load_lds_dwordx4 v3, s[26:27]
s_add_u32 s15, s14, 131072
s_add_u32 m0, s17, 29696
v_add_u32 v3, s15, v1
global_load_lds_dwordx4 v3, s[26:27]
s_add_u32 s15, s14, 262144
s_add_u32 m0, s17, 30720
v_add_u32 v3, s15, v1
global_load_lds_dwordx4 v3, s[26:27]
s_add_u32 s15, s14, 393216
s_add_u32 m0, s17, 31744
v_add_u32 v3, s15, v1
global_load_lds_dwordx4 v3, s[26:27]
s_waitcnt vmcnt(24)
ds_read_b32 v16, v7 offset:0
ds_read_b32 v17, v7 offset:128
ds_read_b32 v18, v7 offset:64
ds_read_b32 v19, v7 offset:192
ds_read_b32 v20, v7 offset:256
ds_read_b32 v21, v7 offset:384
ds_read_b32 v22, v7 offset:320
ds_read_b32 v23, v7 offset:448
s_waitcnt lgkmcnt(7)
ds_read_b32 v24, v7 offset:1024
ds_read_b32 v25, v7 offset:1152
ds_read_b32 v26, v7 offset:1088
ds_read_b32 v27, v7 offset:1216
ds_read_b32 v28, v7 offset:1280
ds_read_b32 v29, v7 offset:1408
ds_read_b32 v30, v7 offset:1344
ds_read_b32 v31, v7 offset:1472
s_waitcnt lgkmcnt(0)
v_perm_b32 v128, v17, v16, s22
v_perm_b32 v136, v17, v16, s23
v_perm_b32 v129, v19, v18, s22
v_perm_b32 v137, v19, v18, s23
v_perm_b32 v130, v21, v20, s22
v_perm_b32 v138, v21, v20, s23
v_perm_b32 v131, v23, v22, s22
v_perm_b32 v139, v23, v22, s23
v_perm_b32 v132, v25, v24, s22
v_perm_b32 v140, v25, v24, s23
v_perm_b32 v133, v27, v26, s22
v_perm_b32 v141, v27, v26, s23
v_perm_b32 v134, v29, v28, s22
v_perm_b32 v142, v29, v28, s23
v_perm_b32 v135, v31, v30, s22
v_perm_b32 v143, v31, v30, s23
ds_read_b32 v16, v7 offset:4096
ds_read_b32 v17, v7 offset:4224
ds_read_b32 v18, v7 offset:4160
ds_read_b32 v19, v7 offset:4288
ds_read_b32 v20, v7 offset:4352
ds_read_b32 v21, v7 offset:4480
ds_read_b32 v22, v7 offset:4416
ds_read_b32 v23, v7 offset:4544
s_waitcnt lgkmcnt(7)
ds_read_b32 v24, v7 offset:5120
ds_read_b32 v25, v7 offset:5248
ds_read_b32 v26, v7 offset:5184
ds_read_b32 v27, v7 offset:5312
ds_read_b32 v28, v7 offset:5376
ds_read_b32 v29, v7 offset:5504
ds_read_b32 v30, v7 offset:5440
ds_read_b32 v31, v7 offset:5568
s_waitcnt lgkmcnt(0)
v_perm_b32 v144, v17, v16, s22
v_perm_b32 v152, v17, v16, s23
v_perm_b32 v145, v19, v18, s22
v_perm_b32 v153, v19, v18, s23
v_perm_b32 v146, v21, v20, s22
v_perm_b32 v154, v21, v20, s23
v_perm_b32 v147, v23, v22, s22
v_perm_b32 v155, v23, v22, s23
v_perm_b32 v148, v25, v24, s22
v_perm_b32 v156, v25, v24, s23
v_perm_b32 v149, v27, v26, s22
v_perm_b32 v157, v27, v26, s23
v_perm_b32 v150, v29, v28, s22
v_perm_b32 v158, v29, v28, s23
v_perm_b32 v151, v31, v30, s22
v_perm_b32 v159, v31, v30, s23
s_lshl_b32 s14, s10, 1
s_add_u32 s14, s14, 4
s_and_b32 s14, s14, 7
s_lshl_b32 s14, s14, 19
s_add_u32 s15, s14, 0
s_add_u32 m0, s17, 0
v_add_u32 v3, s15, v1
global_load_lds_dwordx4 v3, s[24:25]
s_add_u32 s15, s14, 131072
s_add_u32 m0, s17, 1024
v_add_u32 v3, s15, v1
global_load_lds_dwordx4 v3, s[24:25]
s_add_u32 s15, s14, 262144
s_add_u32 m0, s17, 2048
v_add_u32 v3, s15, v1
global_load_lds_dwordx4 v3, s[24:25]
s_add_u32 s15, s14, 393216
s_add_u32 m0, s17, 3072
v_add_u32 v3, s15, v1
global_load_lds_dwordx4 v3, s[24:25]
s_add_u32 s15, s14, 0
s_add_u32 m0, s17, 4096
v_add_u32 v3, s15, v1
global_load_lds_dwordx4 v3, s[26:27]
s_add_u32 s15, s14, 131072
s_add_u32 m0, s17, 5120
v_add_u32 v3, s15, v1
global_load_lds_dwordx4 v3, s[26:27]
s_add_u32 s15, s14, 262144
s_add_u32 m0, s17, 6144
v_add_u32 v3, s15, v1
global_load_lds_dwordx4 v3, s[26:27]
s_add_u32 s15, s14, 393216
s_add_u32 m0, s17, 7168
v_add_u32 v3, s15, v1
global_load_lds_dwordx4 v3, s[26:27]
s_waitcnt vmcnt(24)
ds_read_b32 v16, v7 offset:8192
ds_read_b32 v17, v7 offset:8320
ds_read_b32 v18, v7 offset:8256
ds_read_b32 v19, v7 offset:8384
ds_read_b32 v20, v7 offset:8448
ds_read_b32 v21, v7 offset:8576
ds_read_b32 v22, v7 offset:8512
ds_read_b32 v23, v7 offset:8640
s_waitcnt lgkmcnt(7)
ds_read_b32 v24, v7 offset:9216
ds_read_b32 v25, v7 offset:9344
ds_read_b32 v26, v7 offset:9280
ds_read_b32 v27, v7 offset:9408
ds_read_b32 v28, v7 offset:9472
ds_read_b32 v29, v7 offset:9600
ds_read_b32 v30, v7 offset:9536
ds_read_b32 v31, v7 offset:9664
s_waitcnt lgkmcnt(0)
v_perm_b32 v160, v17, v16, s22
v_perm_b32 v168, v17, v16, s23
v_perm_b32 v161, v19, v18, s22
v_perm_b32 v169, v19, v18, s23
v_perm_b32 v162, v21, v20, s22
v_perm_b32 v170, v21, v20, s23
v_perm_b32 v163, v23, v22, s22
v_perm_b32 v171, v23, v22, s23
v_perm_b32 v164, v25, v24, s22
v_perm_b32 v172, v25, v24, s23
v_perm_b32 v165, v27, v26, s22
v_perm_b32 v173, v27, v26, s23
v_perm_b32 v166, v29, v28, s22
v_perm_b32 v174, v29, v28, s23
v_perm_b32 v167, v31, v30, s22
v_perm_b32 v175, v31, v30, s23
ds_read_b32 v16, v7 offset:12288
ds_read_b32 v17, v7 offset:12416
ds_read_b32 v18, v7 offset:12352
ds_read_b32 v19, v7 offset:12480
ds_read_b32 v20, v7 offset:12544
ds_read_b32 v21, v7 offset:12672
ds_read_b32 v22, v7 offset:12608
ds_read_b32 v23, v7 offset:12736
s_waitcnt lgkmcnt(7)
ds_read_b32 v24, v7 offset:13312
ds_read_b32 v25, v7 offset:13440
ds_read_b32 v26, v7 offset:13376
ds_read_b32 v27, v7 offset:13504
ds_read_b32 v28, v7 offset:13568
ds_read_b32 v29, v7 offset:13696
ds_read_b32 v30, v7 offset:13632
ds_read_b32 v31, v7 offset:13760
s_waitcnt lgkmcnt(0)
v_perm_b32 v176, v17, v16, s22
v_perm_b32 v184, v17, v16, s23
v_perm_b32 v177, v19, v18, s22
v_perm_b32 v185, v19, v18, s23
v_perm_b32 v178, v21, v20, s22
v_perm_b32 v186, v21, v20, s23
v_perm_b32 v179, v23, v22, s22
v_perm_b32 v187, v23, v22, s23
v_perm_b32 v180, v25, v24, s22
v_perm_b32 v188, v25, v24, s23
v_perm_b32 v181, v27, v26, s22
v_perm_b32 v189, v27, v26, s23
v_perm_b32 v182, v29, v28, s22
v_perm_b32 v190, v29, v28, s23
v_perm_b32 v183, v31, v30, s22
v_perm_b32 v191, v31, v30, s23
s_lshl_b32 s14, s10, 1
s_add_u32 s14, s14, 5
s_and_b32 s14, s14, 7
s_lshl_b32 s14, s14, 19
s_add_u32 s15, s14, 0
s_add_u32 m0, s17, 8192
v_add_u32 v3, s15, v1
global_load_lds_dwordx4 v3, s[24:25]
s_add_u32 s15, s14, 131072
s_add_u32 m0, s17, 9216
v_add_u32 v3, s15, v1
global_load_lds_dwordx4 v3, s[24:25]
s_add_u32 s15, s14, 262144
s_add_u32 m0, s17, 10240
v_add_u32 v3, s15, v1
global_load_lds_dwordx4 v3, s[24:25]
s_add_u32 s15, s14, 393216
s_add_u32 m0, s17, 11264
v_add_u32 v3, s15, v1
global_load_lds_dwordx4 v3, s[24:25]
s_add_u32 s15, s14, 0
s_add_u32 m0, s17, 12288
v_add_u32 v3, s15, v1
global_load_lds_dwordx4 v3, s[26:27]
s_add_u32 s15, s14, 131072
s_add_u32 m0, s17, 13312
v_add_u32 v3, s15, v1
global_load_lds_dwordx4 v3, s[26:27]
s_add_u32 s15, s14, 262144
s_add_u32 m0, s17, 14336
v_add_u32 v3, s15, v1
global_load_lds_dwordx4 v3, s[26:27]
s_add_u32 s15, s14, 393216
s_add_u32 m0, s17, 15360
v_add_u32 v3, s15, v1
global_load_lds_dwordx4 v3, s[26:27]
s_waitcnt vmcnt(24)
ds_read_b32 v16, v7 offset:16384
ds_read_b32 v17, v7 offset:16512
ds_read_b32 v18, v7 offset:16448
ds_read_b32 v19, v7 offset:16576
ds_read_b32 v20, v7 offset:16640
ds_read_b32 v21, v7 offset:16768
ds_read_b32 v22, v7 offset:16704
ds_read_b32 v23, v7 offset:16832
s_waitcnt lgkmcnt(7)
ds_read_b32 v24, v7 offset:17408
ds_read_b32 v25, v7 offset:17536
ds_read_b32 v26, v7 offset:17472
ds_read_b32 v27, v7 offset:17600
ds_read_b32 v28, v7 offset:17664
ds_read_b32 v29, v7 offset:17792
ds_read_b32 v30, v7 offset:17728
ds_read_b32 v31, v7 offset:17856
s_waitcnt lgkmcnt(0)
v_perm_b32 v192, v17, v16, s22
v_perm_b32 v200, v17, v16, s23
v_perm_b32 v193, v19, v18, s22
v_perm_b32 v201, v19, v18, s23
v_perm_b32 v194, v21, v20, s22
v_perm_b32 v202, v21, v20, s23
v_perm_b32 v195, v23, v22, s22
v_perm_b32 v203, v23, v22, s23
v_perm_b32 v196, v25, v24, s22
v_perm_b32 v204, v25, v24, s23
v_perm_b32 v197, v27, v26, s22
v_perm_b32 v205, v27, v26, s23
v_perm_b32 v198, v29, v28, s22
v_perm_b32 v206, v29, v28, s23
v_perm_b32 v199, v31, v30, s22
v_perm_b32 v207, v31, v30, s23
ds_read_b32 v16, v7 offset:20480
ds_read_b32 v17, v7 offset:20608
ds_read_b32 v18, v7 offset:20544
ds_read_b32 v19, v7 offset:20672
ds_read_b32 v20, v7 offset:20736
ds_read_b32 v21, v7 offset:20864
ds_read_b32 v22, v7 offset:20800
ds_read_b32 v23, v7 offset:20928
s_waitcnt lgkmcnt(7)
ds_read_b32 v24, v7 offset:21504
ds_read_b32 v25, v7 offset:21632
ds_read_b32 v26, v7 offset:21568
ds_read_b32 v27, v7 offset:21696
ds_read_b32 v28, v7 offset:21760
ds_read_b32 v29, v7 offset:21888
ds_read_b32 v30, v7 offset:21824
ds_read_b32 v31, v7 offset:21952
s_waitcnt lgkmcnt(0)
v_perm_b32 v208, v17, v16, s22
v_perm_b32 v216, v17, v16, s23
v_perm_b32 v209, v19, v18, s22
v_perm_b32 v217, v19, v18, s23
v_perm_b32 v210, v21, v20, s22
v_perm_b32 v218, v21, v20, s23
v_perm_b32 v211, v23, v22, s22
v_perm_b32 v219, v23, v22, s23
v_perm_b32 v212, v25, v24, s22
v_perm_b32 v220, v25, v24, s23
v_perm_b32 v213, v27, v26, s22
v_perm_b32 v221, v27, v26, s23
v_perm_b32 v214, v29, v28, s22
v_perm_b32 v222, v29, v28, s23
v_perm_b32 v215, v31, v30, s22
v_perm_b32 v223, v31, v30, s23
s_lshl_b32 s14, s10, 1
s_add_u32 s14, s14, 7
s_and_b32 s14, s14, 7
s_lshl_b32 s14, s14, 19
s_add_u32 s15, s14, 0
s_add_u32 m0, s17, 16384
v_add_u32 v3, s15, v1
global_load_lds_dwordx4 v3, s[24:25]
s_add_u32 s15, s14, 131072
s_add_u32 m0, s17, 17408
v_add_u32 v3, s15, v1
global_load_lds_dwordx4 v3, s[24:25]
s_add_u32 s15, s14, 262144
s_add_u32 m0, s17, 18432
v_add_u32 v3, s15, v1
global_load_lds_dwordx4 v3, s[24:25]
s_add_u32 s15, s14, 393216
s_add_u32 m0, s17, 19456
v_add_u32 v3, s15, v1
global_load_lds_dwordx4 v3, s[24:25]
s_add_u32 s15, s14, 0
s_add_u32 m0, s17, 20480
v_add_u32 v3, s15, v1
global_load_lds_dwordx4 v3, s[26:27]
s_add_u32 s15, s14, 131072
s_add_u32 m0, s17, 21504
v_add_u32 v3, s15, v1
global_load_lds_dwordx4 v3, s[26:27]
s_add_u32 s15, s14, 262144
s_add_u32 m0, s17, 22528
v_add_u32 v3, s15, v1
global_load_lds_dwordx4 v3, s[26:27]
s_add_u32 s15, s14, 393216
s_add_u32 m0, s17, 23552
v_add_u32 v3, s15, v1
global_load_lds_dwordx4 v3, s[26:27]
s_waitcnt vmcnt(24)
ds_read_b64_tr_b16 a[104:105], v4 offset:24576
ds_read_b64_tr_b16 a[106:107], v4 offset:24704
ds_read_b64_tr_b16 a[108:109], v4 offset:26624
ds_read_b64_tr_b16 a[110:111], v4 offset:26752
ds_read_b64_tr_b16 a[112:113], v4 offset:24608
ds_read_b64_tr_b16 a[114:115], v4 offset:24736
ds_read_b64_tr_b16 a[116:117], v4 offset:26656
ds_read_b64_tr_b16 a[118:119], v4 offset:26784
s_waitcnt lgkmcnt(7)
ds_read_b64_tr_b16 a[120:121], v5 offset:24576
ds_read_b64_tr_b16 a[122:123], v5 offset:24704
ds_read_b64_tr_b16 a[124:125], v5 offset:26624
ds_read_b64_tr_b16 a[126:127], v5 offset:26752
ds_read_b64_tr_b16 v[32:33], v5 offset:24608
ds_read_b64_tr_b16 v[34:35], v5 offset:24736
ds_read_b64_tr_b16 v[36:37], v5 offset:26656
ds_read_b64_tr_b16 v[38:39], v5 offset:26784
s_waitcnt lgkmcnt(0)
s_lshl_b32 s14, s10, 1
s_add_u32 s14, s14, 0
s_and_b32 s14, s14, 7
s_lshl_b32 s14, s14, 19
s_add_u32 s15, s14, 0
s_add_u32 m0, s17, 24576
v_add_u32 v3, s15, v1
global_load_lds_dwordx4 v3, s[24:25]
s_add_u32 s15, s14, 131072
s_add_u32 m0, s17, 25600
v_add_u32 v3, s15, v1
global_load_lds_dwordx4 v3, s[24:25]
s_add_u32 s15, s14, 262144
s_add_u32 m0, s17, 26624
v_add_u32 v3, s15, v1
global_load_lds_dwordx4 v3, s[24:25]
s_add_u32 s15, s14, 393216
s_add_u32 m0, s17, 27648
v_add_u32 v3, s15, v1
global_load_lds_dwordx4 v3, s[24:25]
s_add_u32 s15, s14, 0
s_add_u32 m0, s17, 28672
v_add_u32 v3, s15, v1
global_load_lds_dwordx4 v3, s[26:27]
s_add_u32 s15, s14, 131072
s_add_u32 m0, s17, 29696
v_add_u32 v3, s15, v1
global_load_lds_dwordx4 v3, s[26:27]
s_add_u32 s15, s14, 262144
s_add_u32 m0, s17, 30720
v_add_u32 v3, s15, v1
global_load_lds_dwordx4 v3, s[26:27]
s_add_u32 s15, s14, 393216
s_add_u32 m0, s17, 31744
v_add_u32 v3, s15, v1
global_load_lds_dwordx4 v3, s[26:27]
s_waitcnt vmcnt(24)
ds_read_b64_tr_b16 a[128:129], v4 offset:0
ds_read_b64_tr_b16 a[130:131], v4 offset:128
ds_read_b64_tr_b16 a[132:133], v4 offset:2048
ds_read_b64_tr_b16 a[134:135], v4 offset:2176
ds_read_b64_tr_b16 a[136:137], v4 offset:32
ds_read_b64_tr_b16 a[138:139], v4 offset:160
ds_read_b64_tr_b16 a[140:141], v4 offset:2080
ds_read_b64_tr_b16 a[142:143], v4 offset:2208
s_waitcnt lgkmcnt(7)
ds_read_b64_tr_b16 a[144:145], v5 offset:0
ds_read_b64_tr_b16 a[146:147], v5 offset:128
ds_read_b64_tr_b16 a[148:149], v5 offset:2048
ds_read_b64_tr_b16 a[150:151], v5 offset:2176
ds_read_b64_tr_b16 v[40:41], v5 offset:32
ds_read_b64_tr_b16 v[42:43], v5 offset:160
ds_read_b64_tr_b16 v[44:45], v5 offset:2080
ds_read_b64_tr_b16 v[46:47], v5 offset:2208
s_waitcnt lgkmcnt(0)
s_lshl_b32 s14, s10, 1
s_add_u32 s14, s14, 1
s_and_b32 s14, s14, 7
s_lshl_b32 s14, s14, 19
s_add_u32 s15, s14, 0
s_add_u32 m0, s17, 0
v_add_u32 v3, s15, v1
global_load_lds_dwordx4 v3, s[24:25]
s_add_u32 s15, s14, 131072
s_add_u32 m0, s17, 1024
v_add_u32 v3, s15, v1
global_load_lds_dwordx4 v3, s[24:25]
s_add_u32 s15, s14, 262144
s_add_u32 m0, s17, 2048
v_add_u32 v3, s15, v1
global_load_lds_dwordx4 v3, s[24:25]
s_add_u32 s15, s14, 393216
s_add_u32 m0, s17, 3072
v_add_u32 v3, s15, v1
global_load_lds_dwordx4 v3, s[24:25]
s_add_u32 s15, s14, 0
s_add_u32 m0, s17, 4096
v_add_u32 v3, s15, v1
global_load_lds_dwordx4 v3, s[26:27]
s_add_u32 s15, s14, 131072
s_add_u32 m0, s17, 5120
v_add_u32 v3, s15, v1
global_load_lds_dwordx4 v3, s[26:27]
s_add_u32 s15, s14, 262144
s_add_u32 m0, s17, 6144
v_add_u32 v3, s15, v1
global_load_lds_dwordx4 v3, s[26:27]
s_add_u32 s15, s14, 393216
s_add_u32 m0, s17, 7168
v_add_u32 v3, s15, v1
global_load_lds_dwordx4 v3, s[26:27]
s_waitcnt vmcnt(24)
ds_read_b64_tr_b16 a[152:153], v4 offset:8192
ds_read_b64_tr_b16 a[154:155], v4 offset:8320
ds_read_b64_tr_b16 a[156:157], v4 offset:10240
ds_read_b64_tr_b16 a[158:159], v4 offset:10368
ds_read_b64_tr_b16 a[160:161], v4 offset:8224
ds_read_b64_tr_b16 a[162:163], v4 offset:8352
ds_read_b64_tr_b16 a[164:165], v4 offset:10272
ds_read_b64_tr_b16 a[166:167], v4 offset:10400
s_waitcnt lgkmcnt(7)
ds_read_b64_tr_b16 a[168:169], v5 offset:8192
ds_read_b64_tr_b16 a[170:171], v5 offset:8320
ds_read_b64_tr_b16 a[172:173], v5 offset:10240
ds_read_b64_tr_b16 a[174:175], v5 offset:10368
ds_read_b64_tr_b16 v[48:49], v5 offset:8224
ds_read_b64_tr_b16 v[50:51], v5 offset:8352
ds_read_b64_tr_b16 v[52:53], v5 offset:10272
ds_read_b64_tr_b16 v[54:55], v5 offset:10400
s_waitcnt lgkmcnt(0)
s_lshl_b32 s14, s10, 1
s_add_u32 s14, s14, 0
s_and_b32 s14, s14, 7
s_lshl_b32 s14, s14, 19
s_add_u32 s15, s14, 0
s_add_u32 m0, s17, 8192
v_add_u32 v3, s15, v1
global_load_lds_dwordx4 v3, s[28:29]
s_add_u32 s15, s14, 131072
s_add_u32 m0, s17, 9216
v_add_u32 v3, s15, v1
global_load_lds_dwordx4 v3, s[28:29]
s_add_u32 s15, s14, 262144
s_add_u32 m0, s17, 10240
v_add_u32 v3, s15, v1
global_load_lds_dwordx4 v3, s[28:29]
s_add_u32 s15, s14, 393216
s_add_u32 m0, s17, 11264
v_add_u32 v3, s15, v1
global_load_lds_dwordx4 v3, s[28:29]
s_add_u32 s15, s14, 524288
s_add_u32 m0, s17, 12288
v_add_u32 v3, s15, v1
global_load_lds_dwordx4 v3, s[28:29]
s_add_u32 s15, s14, 655360
s_add_u32 m0, s17, 13312
v_add_u32 v3, s15, v1
global_load_lds_dwordx4 v3, s[28:29]
s_add_u32 s15, s14, 786432
s_add_u32 m0, s17, 14336
v_add_u32 v3, s15, v1
global_load_lds_dwordx4 v3, s[28:29]
s_add_u32 s15, s14, 917504
s_add_u32 m0, s17, 15360
v_add_u32 v3, s15, v1
global_load_lds_dwordx4 v3, s[28:29]
s_waitcnt vmcnt(24)
ds_read_b64_tr_b16 a[176:177], v4 offset:16384
ds_read_b64_tr_b16 a[178:179], v4 offset:16512
ds_read_b64_tr_b16 a[180:181], v4 offset:18432
ds_read_b64_tr_b16 a[182:183], v4 offset:18560
ds_read_b64_tr_b16 a[184:185], v4 offset:16416
ds_read_b64_tr_b16 a[186:187], v4 offset:16544
ds_read_b64_tr_b16 a[188:189], v4 offset:18464
ds_read_b64_tr_b16 a[190:191], v4 offset:18592
s_waitcnt lgkmcnt(7)
ds_read_b64_tr_b16 v[56:57], v5 offset:16384
ds_read_b64_tr_b16 v[58:59], v5 offset:16512
ds_read_b64_tr_b16 v[60:61], v5 offset:18432
ds_read_b64_tr_b16 v[62:63], v5 offset:18560
ds_read_b64_tr_b16 a[192:193], v5 offset:16416
ds_read_b64_tr_b16 a[194:195], v5 offset:16544
ds_read_b64_tr_b16 a[196:197], v5 offset:18464
ds_read_b64_tr_b16 a[198:199], v5 offset:18592
s_waitcnt lgkmcnt(0)
s_lshl_b32 s14, s10, 1
s_add_u32 s14, s14, 2
s_and_b32 s14, s14, 7
s_lshl_b32 s14, s14, 19
s_add_u32 s15, s14, 0
s_add_u32 m0, s17, 16384
v_add_u32 v3, s15, v1
global_load_lds_dwordx4 v3, s[28:29]
s_add_u32 s15, s14, 131072
s_add_u32 m0, s17, 17408
v_add_u32 v3, s15, v1
global_load_lds_dwordx4 v3, s[28:29]
s_add_u32 s15, s14, 262144
s_add_u32 m0, s17, 18432
v_add_u32 v3, s15, v1
global_load_lds_dwordx4 v3, s[28:29]
s_add_u32 s15, s14, 393216
s_add_u32 m0, s17, 19456
v_add_u32 v3, s15, v1
global_load_lds_dwordx4 v3, s[28:29]
s_add_u32 s15, s14, 524288
s_add_u32 m0, s17, 20480
v_add_u32 v3, s15, v1
global_load_lds_dwordx4 v3, s[28:29]
s_add_u32 s15, s14, 655360
s_add_u32 m0, s17, 21504
v_add_u32 v3, s15, v1
global_load_lds_dwordx4 v3, s[28:29]
s_add_u32 s15, s14, 786432
s_add_u32 m0, s17, 22528
v_add_u32 v3, s15, v1
global_load_lds_dwordx4 v3, s[28:29]
s_add_u32 s15, s14, 917504
s_add_u32 m0, s17, 23552
v_add_u32 v3, s15, v1
global_load_lds_dwordx4 v3, s[28:29]
s_waitcnt vmcnt(24)
ds_read_b64_tr_b16 v[64:65], v4 offset:24576
ds_read_b64_tr_b16 v[66:67], v4 offset:24704
ds_read_b64_tr_b16 v[68:69], v4 offset:26624
ds_read_b64_tr_b16 v[70:71], v4 offset:26752
ds_read_b64_tr_b16 v[72:73], v4 offset:24608
ds_read_b64_tr_b16 v[74:75], v4 offset:24736
ds_read_b64_tr_b16 v[76:77], v4 offset:26656
ds_read_b64_tr_b16 v[78:79], v4 offset:26784
s_waitcnt lgkmcnt(7)
ds_read_b64_tr_b16 a[200:201], v5 offset:24576
ds_read_b64_tr_b16 a[202:203], v5 offset:24704
ds_read_b64_tr_b16 a[204:205], v5 offset:26624
ds_read_b64_tr_b16 a[206:207], v5 offset:26752
ds_read_b64_tr_b16 a[208:209], v5 offset:24608
ds_read_b64_tr_b16 a[210:211], v5 offset:24736
ds_read_b64_tr_b16 a[212:213], v5 offset:26656
ds_read_b64_tr_b16 a[214:215], v5 offset:26784
s_waitcnt lgkmcnt(0)
s_add_u32 s14, s10, 0
s_and_b32 s14, s14, 3
s_lshl_b32 s14, s14, 15
s_add_u32 s15, s14, 0
s_add_u32 m0, s17, 24576
v_add_u32 v3, s15, v2
global_load_lds_dwordx4 v3, s[30:31]
s_add_u32 s15, s14, 8192
s_add_u32 m0, s17, 25600
v_add_u32 v3, s15, v2
global_load_lds_dwordx4 v3, s[30:31]
s_add_u32 s15, s14, 16384
s_add_u32 m0, s17, 26624
v_add_u32 v3, s15, v2
global_load_lds_dwordx4 v3, s[30:31]
s_add_u32 s15, s14, 24576
s_add_u32 m0, s17, 27648
v_add_u32 v3, s15, v2
global_load_lds_dwordx4 v3, s[30:31]
s_add_u32 s15, s14, 512
s_add_u32 m0, s17, 28672
v_add_u32 v3, s15, v2
global_load_lds_dwordx4 v3, s[30:31]
s_add_u32 s15, s14, 8704
s_add_u32 m0, s17, 29696
v_add_u32 v3, s15, v2
global_load_lds_dwordx4 v3, s[30:31]
s_add_u32 s15, s14, 16896
s_add_u32 m0, s17, 30720
v_add_u32 v3, s15, v2
global_load_lds_dwordx4 v3, s[30:31]
s_add_u32 s15, s14, 25088
s_add_u32 m0, s17, 31744
v_add_u32 v3, s15, v2
global_load_lds_dwordx4 v3, s[30:31]
s_waitcnt vmcnt(24)
ds_read_b64_tr_b16 v[80:81], v4 offset:0
ds_read_b64_tr_b16 v[82:83], v4 offset:128
ds_read_b64_tr_b16 v[84:85], v4 offset:2048
ds_read_b64_tr_b16 v[86:87], v4 offset:2176
ds_read_b64_tr_b16 v[88:89], v4 offset:32
ds_read_b64_tr_b16 v[90:91], v4 offset:160
ds_read_b64_tr_b16 v[92:93], v4 offset:2080
ds_read_b64_tr_b16 v[94:95], v4 offset:2208
s_waitcnt lgkmcnt(7)
ds_read_b64_tr_b16 a[216:217], v5 offset:0
ds_read_b64_tr_b16 a[218:219], v5 offset:128
ds_read_b64_tr_b16 a[220:221], v5 offset:2048
ds_read_b64_tr_b16 a[222:223], v5 offset:2176
ds_read_b64_tr_b16 a[224:225], v5 offset:32
ds_read_b64_tr_b16 a[226:227], v5 offset:160
ds_read_b64_tr_b16 a[228:229], v5 offset:2080
ds_read_b64_tr_b16 a[230:231], v5 offset:2208
s_waitcnt lgkmcnt(0)
ds_write_b128 v9, v[32:35] offset:0
ds_write_b128 v9, v[36:39] offset:1024
ds_write_b128 v9, v[40:43] offset:2048
ds_write_b128 v9, v[44:47] offset:3072
ds_write_b128 v9, v[48:51] offset:4096
ds_write_b128 v9, v[52:55] offset:5120
ds_write_b128 v9, v[56:59] offset:6144
ds_write_b128 v9, v[60:63] offset:7168
s_waitcnt lgkmcnt(0)
s_waitcnt vmcnt(16)
ds_read_b64_tr_b16 v[96:97], v6 offset:8192
ds_read_b64_tr_b16 v[98:99], v6 offset:8320
ds_read_b64_tr_b16 v[100:101], v6 offset:10240
ds_read_b64_tr_b16 v[102:103], v6 offset:10368
ds_read_b64_tr_b16 v[104:105], v6 offset:8224
ds_read_b64_tr_b16 v[106:107], v6 offset:8352
ds_read_b64_tr_b16 v[108:109], v6 offset:10272
ds_read_b64_tr_b16 v[110:111], v6 offset:10400
s_waitcnt lgkmcnt(7)
ds_read_b64_tr_b16 a[232:233], v6 offset:12288
ds_read_b64_tr_b16 a[234:235], v6 offset:12416
ds_read_b64_tr_b16 a[236:237], v6 offset:14336
ds_read_b64_tr_b16 a[238:239], v6 offset:14464
ds_read_b64_tr_b16 a[240:241], v6 offset:12320
ds_read_b64_tr_b16 a[242:243], v6 offset:12448
ds_read_b64_tr_b16 a[244:245], v6 offset:14368
ds_read_b64_tr_b16 a[246:247], v6 offset:14496
s_waitcnt lgkmcnt(0)
ds_write_b128 v9, v[64:67] offset:8192
ds_write_b128 v9, v[68:71] offset:9216
ds_write_b128 v9, v[72:75] offset:10240
ds_write_b128 v9, v[76:79] offset:11264
ds_write_b128 v9, v[80:83] offset:12288
ds_write_b128 v9, v[84:87] offset:13312
ds_write_b128 v9, v[88:91] offset:14336
ds_write_b128 v9, v[92:95] offset:15360
s_waitcnt lgkmcnt(0)
s_waitcnt vmcnt(8)
ds_read_b64_tr_b16 v[112:113], v6 offset:16384
ds_read_b64_tr_b16 v[114:115], v6 offset:16512
ds_read_b64_tr_b16 v[116:117], v6 offset:18432
ds_read_b64_tr_b16 v[118:119], v6 offset:18560
ds_read_b64_tr_b16 v[120:121], v6 offset:16416
ds_read_b64_tr_b16 v[122:123], v6 offset:16544
ds_read_b64_tr_b16 v[124:125], v6 offset:18464
ds_read_b64_tr_b16 v[126:127], v6 offset:18592
s_waitcnt lgkmcnt(7)
ds_read_b64_tr_b16 v[32:33], v6 offset:20480
ds_read_b64_tr_b16 v[34:35], v6 offset:20608
ds_read_b64_tr_b16 v[36:37], v6 offset:22528
ds_read_b64_tr_b16 v[38:39], v6 offset:22656
ds_read_b64_tr_b16 a[248:249], v6 offset:20512
ds_read_b64_tr_b16 a[250:251], v6 offset:20640
ds_read_b64_tr_b16 a[252:253], v6 offset:22560
ds_read_b64_tr_b16 a[254:255], v6 offset:22688
s_waitcnt lgkmcnt(0)
ds_write_b128 v9, v[96:99] offset:16384
ds_write_b128 v9, v[100:103] offset:17408
ds_write_b128 v9, v[104:107] offset:18432
ds_write_b128 v9, v[108:111] offset:19456
ds_write_b128 v9, v[112:115] offset:20480
ds_write_b128 v9, v[116:119] offset:21504
ds_write_b128 v9, v[120:123] offset:22528
ds_write_b128 v9, v[124:127] offset:23552
s_waitcnt lgkmcnt(0)
s_waitcnt vmcnt(0)
ds_read_b32 v16, v7 offset:24576
ds_read_b32 v17, v7 offset:24704
ds_read_b32 v18, v8 offset:24640
ds_read_b32 v19, v8 offset:24768
ds_read_b32 v20, v7 offset:24832
ds_read_b32 v21, v7 offset:24960
ds_read_b32 v22, v8 offset:24896
ds_read_b32 v23, v8 offset:25024
s_waitcnt lgkmcnt(7)
ds_read_b32 v24, v7 offset:25600
ds_read_b32 v25, v7 offset:25728
ds_read_b32 v26, v8 offset:25664
ds_read_b32 v27, v8 offset:25792
ds_read_b32 v28, v7 offset:25856
ds_read_b32 v29, v7 offset:25984
ds_read_b32 v30, v8 offset:25920
ds_read_b32 v31, v8 offset:26048
s_waitcnt lgkmcnt(0)
v_perm_b32 v40, v17, v16, s22
v_perm_b32 v48, v17, v16, s23
v_perm_b32 v41, v19, v18, s22
v_perm_b32 v49, v19, v18, s23
v_perm_b32 v42, v21, v20, s22
v_perm_b32 v50, v21, v20, s23
v_perm_b32 v43, v23, v22, s22
v_perm_b32 v51, v23, v22, s23
v_perm_b32 v44, v25, v24, s22
v_perm_b32 v52, v25, v24, s23
v_perm_b32 v45, v27, v26, s22
v_perm_b32 v53, v27, v26, s23
v_perm_b32 v46, v29, v28, s22
v_perm_b32 v54, v29, v28, s23
v_perm_b32 v47, v31, v30, s22
v_perm_b32 v55, v31, v30, s23
ds_read_b32 v16, v7 offset:28672
ds_read_b32 v17, v7 offset:28800
ds_read_b32 v18, v8 offset:28736
ds_read_b32 v19, v8 offset:28864
ds_read_b32 v20, v7 offset:28928
ds_read_b32 v21, v7 offset:29056
ds_read_b32 v22, v8 offset:28992
ds_read_b32 v23, v8 offset:29120
s_waitcnt lgkmcnt(7)
ds_read_b32 v24, v7 offset:29696
ds_read_b32 v25, v7 offset:29824
ds_read_b32 v26, v8 offset:29760
ds_read_b32 v27, v8 offset:29888
ds_read_b32 v28, v7 offset:29952
ds_read_b32 v29, v7 offset:30080
ds_read_b32 v30, v8 offset:30016
ds_read_b32 v31, v8 offset:30144
s_waitcnt lgkmcnt(0)
v_perm_b32 v56, v17, v16, s22
v_perm_b32 v224, v17, v16, s23
v_perm_b32 v57, v19, v18, s22
v_perm_b32 v225, v19, v18, s23
v_perm_b32 v58, v21, v20, s22
v_perm_b32 v226, v21, v20, s23
v_perm_b32 v59, v23, v22, s22
v_perm_b32 v227, v23, v22, s23
v_perm_b32 v60, v25, v24, s22
v_perm_b32 v228, v25, v24, s23
v_perm_b32 v61, v27, v26, s22
v_perm_b32 v229, v27, v26, s23
v_perm_b32 v62, v29, v28, s22
v_perm_b32 v230, v29, v28, s23
v_perm_b32 v63, v31, v30, s22
v_perm_b32 v231, v31, v30, s23
ds_write_b128 v9, v[32:35] offset:24576
ds_write_b128 v9, v[36:39] offset:25600
ds_write_b128 v9, v[40:43] offset:26624
ds_write_b128 v9, v[44:47] offset:27648
ds_write_b128 v9, v[48:51] offset:28672
ds_write_b128 v9, v[52:55] offset:29696
ds_write_b128 v9, v[56:59] offset:30720
ds_write_b128 v9, v[60:63] offset:31744
s_waitcnt lgkmcnt(0)
s_branch LW_done
LW_odd:
s_lshl_b32 s14, s10, 1
s_add_u32 s14, s14, 0
s_and_b32 s14, s14, 7
s_lshl_b32 s14, s14, 19
s_add_u32 s15, s14, 0
s_add_u32 m0, s17, 0
v_add_u32 v3, s15, v1
global_load_lds_dwordx4 v3, s[24:25]
s_add_u32 s15, s14, 131072
s_add_u32 m0, s17, 1024
v_add_u32 v3, s15, v1
global_load_lds_dwordx4 v3, s[24:25]
s_add_u32 s15, s14, 262144
s_add_u32 m0, s17, 2048
v_add_u32 v3, s15, v1
global_load_lds_dwordx4 v3, s[24:25]
s_add_u32 s15, s14, 393216
s_add_u32 m0, s17, 3072
v_add_u32 v3, s15, v1
global_load_lds_dwordx4 v3, s[24:25]
s_add_u32 s15, s14, 0
s_add_u32 m0, s17, 4096
v_add_u32 v3, s15, v1
global_load_lds_dwordx4 v3, s[26:27]
s_add_u32 s15, s14, 131072
s_add_u32 m0, s17, 5120
v_add_u32 v3, s15, v1
global_load_lds_dwordx4 v3, s[26:27]
s_add_u32 s15, s14, 262144
s_add_u32 m0, s17, 6144
v_add_u32 v3, s15, v1
global_load_lds_dwordx4 v3, s[26:27]
s_add_u32 s15, s14, 393216
s_add_u32 m0, s17, 7168
v_add_u32 v3, s15, v1
global_load_lds_dwordx4 v3, s[26:27]
s_lshl_b32 s14, s10, 1
s_add_u32 s14, s14, 4
s_and_b32 s14, s14, 7
s_lshl_b32 s14, s14, 19
s_add_u32 s15, s14, 0
s_add_u32 m0, s17, 8192
v_add_u32 v3, s15, v1
global_load_lds_dwordx4 v3, s[24:25]
s_add_u32 s15, s14, 131072
s_add_u32 m0, s17, 9216
v_add_u32 v3, s15, v1
global_load_lds_dwordx4 v3, s[24:25]
s_add_u32 s15, s14, 262144
s_add_u32 m0, s17, 10240
v_add_u32 v3, s15, v1
global_load_lds_dwordx4 v3, s[24:25]
s_add_u32 s15, s14, 393216
s_add_u32 m0, s17, 11264
v_add_u32 v3, s15, v1
global_load_lds_dwordx4 v3, s[24:25]
s_add_u32 s15, s14, 0
s_add_u32 m0, s17, 12288
v_add_u32 v3, s15, v1
global_load_lds_dwordx4 v3, s[26:27]
s_add_u32 s15, s14, 131072
s_add_u32 m0, s17, 13312
v_add_u32 v3, s15, v1
global_load_lds_dwordx4 v3, s[26:27]
s_add_u32 s15, s14, 262144
s_add_u32 m0, s17, 14336
v_add_u32 v3, s15, v1
global_load_lds_dwordx4 v3, s[26:27]
s_add_u32 s15, s14, 393216
s_add_u32 m0, s17, 15360
v_add_u32 v3, s15, v1
global_load_lds_dwordx4 v3, s[26:27]
s_lshl_b32 s14, s10, 1
s_add_u32 s14, s14, 2
s_and_b32 s14, s14, 7
s_lshl_b32 s14, s14, 19
s_add_u32 s15, s14, 0
s_add_u32 m0, s17, 16384
v_add_u32 v3, s15, v1
global_load_lds_dwordx4 v3, s[28:29]
s_add_u32 s15, s14, 131072
s_add_u32 m0, s17, 17408
v_add_u32 v3, s15, v1
global_load_lds_dwordx4 v3, s[28:29]
s_add_u32 s15, s14, 262144
s_add_u32 m0, s17, 18432
v_add_u32 v3, s15, v1
global_load_lds_dwordx4 v3, s[28:29]
s_add_u32 s15, s14, 393216
s_add_u32 m0, s17, 19456
v_add_u32 v3, s15, v1
global_load_lds_dwordx4 v3, s[28:29]
s_add_u32 s15, s14, 524288
s_add_u32 m0, s17, 20480
v_add_u32 v3, s15, v1
global_load_lds_dwordx4 v3, s[28:29]
s_add_u32 s15, s14, 655360
s_add_u32 m0, s17, 21504
v_add_u32 v3, s15, v1
global_load_lds_dwordx4 v3, s[28:29]
s_add_u32 s15, s14, 786432
s_add_u32 m0, s17, 22528
v_add_u32 v3, s15, v1
global_load_lds_dwordx4 v3, s[28:29]
s_add_u32 s15, s14, 917504
s_add_u32 m0, s17, 23552
v_add_u32 v3, s15, v1
global_load_lds_dwordx4 v3, s[28:29]
s_lshl_b32 s14, s10, 1
s_add_u32 s14, s14, 4
s_and_b32 s14, s14, 7
s_lshl_b32 s14, s14, 19
s_add_u32 s15, s14, 0
s_add_u32 m0, s17, 24576
v_add_u32 v3, s15, v1
global_load_lds_dwordx4 v3, s[28:29]
s_add_u32 s15, s14, 131072
s_add_u32 m0, s17, 25600
v_add_u32 v3, s15, v1
global_load_lds_dwordx4 v3, s[28:29]
s_add_u32 s15, s14, 262144
s_add_u32 m0, s17, 26624
v_add_u32 v3, s15, v1
global_load_lds_dwordx4 v3, s[28:29]
s_add_u32 s15, s14, 393216
s_add_u32 m0, s17, 27648
v_add_u32 v3, s15, v1
global_load_lds_dwordx4 v3, s[28:29]
s_add_u32 s15, s14, 524288
s_add_u32 m0, s17, 28672
v_add_u32 v3, s15, v1
global_load_lds_dwordx4 v3, s[28:29]
s_add_u32 s15, s14, 655360
s_add_u32 m0, s17, 29696
v_add_u32 v3, s15, v1
global_load_lds_dwordx4 v3, s[28:29]
s_add_u32 s15, s14, 786432
s_add_u32 m0, s17, 30720
v_add_u32 v3, s15, v1
global_load_lds_dwordx4 v3, s[28:29]
s_add_u32 s15, s14, 917504
s_add_u32 m0, s17, 31744
v_add_u32 v3, s15, v1
global_load_lds_dwordx4 v3, s[28:29]
s_waitcnt vmcnt(24)
ds_read_b64_tr_b16 v[32:33], v4 offset:0
ds_read_b64_tr_b16 v[34:35], v4 offset:128
ds_read_b64_tr_b16 v[36:37], v4 offset:2048
ds_read_b64_tr_b16 v[38:39], v4 offset:2176
ds_read_b64_tr_b16 v[40:41], v4 offset:32
ds_read_b64_tr_b16 v[42:43], v4 offset:160
ds_read_b64_tr_b16 v[44:45], v4 offset:2080
ds_read_b64_tr_b16 v[46:47], v4 offset:2208
s_waitcnt lgkmcnt(7)
ds_read_b64_tr_b16 a[200:201], v5 offset:0
ds_read_b64_tr_b16 a[202:203], v5 offset:128
ds_read_b64_tr_b16 a[204:205], v5 offset:2048
ds_read_b64_tr_b16 a[206:207], v5 offset:2176
ds_read_b64_tr_b16 a[208:209], v5 offset:32
ds_read_b64_tr_b16 a[210:211], v5 offset:160
ds_read_b64_tr_b16 a[212:213], v5 offset:2080
ds_read_b64_tr_b16 a[214:215], v5 offset:2208
s_waitcnt lgkmcnt(0)
s_add_u32 s14, s10, 1
s_and_b32 s14, s14, 3
s_lshl_b32 s14, s14, 15
s_add_u32 s15, s14, 0
s_add_u32 m0, s17, 0
v_add_u32 v3, s15, v2
global_load_lds_dwordx4 v3, s[30:31]
s_add_u32 s15, s14, 8192
s_add_u32 m0, s17, 1024
v_add_u32 v3, s15, v2
global_load_lds_dwordx4 v3, s[30:31]
s_add_u32 s15, s14, 16384
s_add_u32 m0, s17, 2048
v_add_u32 v3, s15, v2
global_load_lds_dwordx4 v3, s[30:31]
s_add_u32 s15, s14, 24576
s_add_u32 m0, s17, 3072
v_add_u32 v3, s15, v2
global_load_lds_dwordx4 v3, s[30:31]
s_add_u32 s15, s14, 512
s_add_u32 m0, s17, 4096
v_add_u32 v3, s15, v2
global_load_lds_dwordx4 v3, s[30:31]
s_add_u32 s15, s14, 8704
s_add_u32 m0, s17, 5120
v_add_u32 v3, s15, v2
global_load_lds_dwordx4 v3, s[30:31]
s_add_u32 s15, s14, 16896
s_add_u32 m0, s17, 6144
v_add_u32 v3, s15, v2
global_load_lds_dwordx4 v3, s[30:31]
s_add_u32 s15, s14, 25088
s_add_u32 m0, s17, 7168
v_add_u32 v3, s15, v2
global_load_lds_dwordx4 v3, s[30:31]
s_waitcnt vmcnt(24)
ds_read_b64_tr_b16 a[128:129], v4 offset:8192
ds_read_b64_tr_b16 a[130:131], v4 offset:8320
ds_read_b64_tr_b16 a[132:133], v4 offset:10240
ds_read_b64_tr_b16 a[134:135], v4 offset:10368
ds_read_b64_tr_b16 a[136:137], v4 offset:8224
ds_read_b64_tr_b16 a[138:139], v4 offset:8352
ds_read_b64_tr_b16 a[140:141], v4 offset:10272
ds_read_b64_tr_b16 a[142:143], v4 offset:10400
s_waitcnt lgkmcnt(7)
ds_read_b64_tr_b16 a[144:145], v5 offset:8192
ds_read_b64_tr_b16 a[146:147], v5 offset:8320
ds_read_b64_tr_b16 a[148:149], v5 offset:10240
ds_read_b64_tr_b16 a[150:151], v5 offset:10368
ds_read_b64_tr_b16 v[48:49], v5 offset:8224
ds_read_b64_tr_b16 v[50:51], v5 offset:8352
ds_read_b64_tr_b16 v[52:53], v5 offset:10272
ds_read_b64_tr_b16 v[54:55], v5 offset:10400
s_waitcnt lgkmcnt(0)
s_add_u32 s14, s10, 2
s_and_b32 s14, s14, 3
s_lshl_b32 s14, s14, 15
s_add_u32 s15, s14, 0
s_add_u32 m0, s17, 8192
v_add_u32 v3, s15, v2
global_load_lds_dwordx4 v3, s[30:31]
s_add_u32 s15, s14, 8192
s_add_u32 m0, s17, 9216
v_add_u32 v3, s15, v2
global_load_lds_dwordx4 v3, s[30:31]
s_add_u32 s15, s14, 16384
s_add_u32 m0, s17, 10240
v_add_u32 v3, s15, v2
global_load_lds_dwordx4 v3, s[30:31]
s_add_u32 s15, s14, 24576
s_add_u32 m0, s17, 11264
v_add_u32 v3, s15, v2
global_load_lds_dwordx4 v3, s[30:31]
s_add_u32 s15, s14, 512
s_add_u32 m0, s17, 12288
v_add_u32 v3, s15, v2
global_load_lds_dwordx4 v3, s[30:31]
s_add_u32 s15, s14, 8704
s_add_u32 m0, s17, 13312
v_add_u32 v3, s15, v2
global_load_lds_dwordx4 v3, s[30:31]
s_add_u32 s15, s14, 16896
s_add_u32 m0, s17, 14336
v_add_u32 v3, s15, v2
global_load_lds_dwordx4 v3, s[30:31]
s_add_u32 s15, s14, 25088
s_add_u32 m0, s17, 15360
v_add_u32 v3, s15, v2
global_load_lds_dwordx4 v3, s[30:31]
s_waitcnt vmcnt(24)
ds_read_b64_tr_b16 v[56:57], v6 offset:16384
ds_read_b64_tr_b16 v[58:59], v6 offset:16512
ds_read_b64_tr_b16 v[60:61], v6 offset:18432
ds_read_b64_tr_b16 v[62:63], v6 offset:18560
ds_read_b64_tr_b16 v[64:65], v6 offset:16416
ds_read_b64_tr_b16 v[66:67], v6 offset:16544
ds_read_b64_tr_b16 v[68:69], v6 offset:18464
ds_read_b64_tr_b16 v[70:71], v6 offset:18592
s_waitcnt lgkmcnt(7)
ds_read_b64_tr_b16 v[72:73], v6 offset:20480
ds_read_b64_tr_b16 v[74:75], v6 offset:20608
ds_read_b64_tr_b16 v[76:77], v6 offset:22528
ds_read_b64_tr_b16 v[78:79], v6 offset:22656
ds_read_b64_tr_b16 a[248:249], v6 offset:20512
ds_read_b64_tr_b16 a[250:251], v6 offset:20640
ds_read_b64_tr_b16 a[252:253], v6 offset:22560
ds_read_b64_tr_b16 a[254:255], v6 offset:22688
s_waitcnt lgkmcnt(0)
s_add_u32 s14, s10, 3
s_and_b32 s14, s14, 3
s_lshl_b32 s14, s14, 15
s_add_u32 s15, s14, 0
s_add_u32 m0, s17, 16384
v_add_u32 v3, s15, v2
global_load_lds_dwordx4 v3, s[30:31]
s_add_u32 s15, s14, 8192
s_add_u32 m0, s17, 17408
v_add_u32 v3, s15, v2
global_load_lds_dwordx4 v3, s[30:31]
s_add_u32 s15, s14, 16384
s_add_u32 m0, s17, 18432
v_add_u32 v3, s15, v2
global_load_lds_dwordx4 v3, s[30:31]
s_add_u32 s15, s14, 24576
s_add_u32 m0, s17, 19456
v_add_u32 v3, s15, v2
global_load_lds_dwordx4 v3, s[30:31]
s_add_u32 s15, s14, 512
s_add_u32 m0, s17, 20480
v_add_u32 v3, s15, v2
global_load_lds_dwordx4 v3, s[30:31]
s_add_u32 s15, s14, 8704
s_add_u32 m0, s17, 21504
v_add_u32 v3, s15, v2
global_load_lds_dwordx4 v3, s[30:31]
s_add_u32 s15, s14, 16896
s_add_u32 m0, s17, 22528
v_add_u32 v3, s15, v2
global_load_lds_dwordx4 v3, s[30:31]
s_add_u32 s15, s14, 25088
s_add_u32 m0, s17, 23552
v_add_u32 v3, s15, v2
global_load_lds_dwordx4 v3, s[30:31]
s_waitcnt vmcnt(24)
ds_read_b64_tr_b16 a[40:41], v6 offset:24576
ds_read_b64_tr_b16 a[42:43], v6 offset:24704
ds_read_b64_tr_b16 a[44:45], v6 offset:26624
ds_read_b64_tr_b16 a[46:47], v6 offset:26752
ds_read_b64_tr_b16 a[48:49], v6 offset:24608
ds_read_b64_tr_b16 a[50:51], v6 offset:24736
ds_read_b64_tr_b16 a[52:53], v6 offset:26656
ds_read_b64_tr_b16 a[54:55], v6 offset:26784
s_waitcnt lgkmcnt(7)
ds_read_b64_tr_b16 a[56:57], v6 offset:28672
ds_read_b64_tr_b16 a[58:59], v6 offset:28800
ds_read_b64_tr_b16 a[60:61], v6 offset:30720
ds_read_b64_tr_b16 a[62:63], v6 offset:30848
ds_read_b64_tr_b16 a[64:65], v6 offset:28704
ds_read_b64_tr_b16 a[66:67], v6 offset:28832
ds_read_b64_tr_b16 a[68:69], v6 offset:30752
ds_read_b64_tr_b16 a[70:71], v6 offset:30880
s_waitcnt lgkmcnt(0)
s_lshl_b32 s14, s10, 1
s_add_u32 s14, s14, 1
s_and_b32 s14, s14, 7
s_lshl_b32 s14, s14, 19
s_add_u32 s15, s14, 0
s_add_u32 m0, s17, 24576
v_add_u32 v3, s15, v1
global_load_lds_dwordx4 v3, s[24:25]
s_add_u32 s15, s14, 131072
s_add_u32 m0, s17, 25600
v_add_u32 v3, s15, v1
global_load_lds_dwordx4 v3, s[24:25]
s_add_u32 s15, s14, 262144
s_add_u32 m0, s17, 26624
v_add_u32 v3, s15, v1
global_load_lds_dwordx4 v3, s[24:25]
s_add_u32 s15, s14, 393216
s_add_u32 m0, s17, 27648
v_add_u32 v3, s15, v1
global_load_lds_dwordx4 v3, s[24:25]
s_add_u32 s15, s14, 0
s_add_u32 m0, s17, 28672
v_add_u32 v3, s15, v1
global_load_lds_dwordx4 v3, s[26:27]
s_add_u32 s15, s14, 131072
s_add_u32 m0, s17, 29696
v_add_u32 v3, s15, v1
global_load_lds_dwordx4 v3, s[26:27]
s_add_u32 s15, s14, 262144
s_add_u32 m0, s17, 30720
v_add_u32 v3, s15, v1
global_load_lds_dwordx4 v3, s[26:27]
s_add_u32 s15, s14, 393216
s_add_u32 m0, s17, 31744
v_add_u32 v3, s15, v1
global_load_lds_dwordx4 v3, s[26:27]
s_waitcnt vmcnt(24)
ds_read_b32 v16, v7 offset:0
ds_read_b32 v17, v7 offset:128
ds_read_b32 v18, v7 offset:64
ds_read_b32 v19, v7 offset:192
ds_read_b32 v20, v7 offset:256
ds_read_b32 v21, v7 offset:384
ds_read_b32 v22, v7 offset:320
ds_read_b32 v23, v7 offset:448
s_waitcnt lgkmcnt(7)
ds_read_b32 v24, v7 offset:1024
ds_read_b32 v25, v7 offset:1152
ds_read_b32 v26, v7 offset:1088
ds_read_b32 v27, v7 offset:1216
ds_read_b32 v28, v7 offset:1280
ds_read_b32 v29, v7 offset:1408
ds_read_b32 v30, v7 offset:1344
ds_read_b32 v31, v7 offset:1472
s_waitcnt lgkmcnt(0)
v_perm_b32 v128, v17, v16, s22
v_perm_b32 v136, v17, v16, s23
v_perm_b32 v129, v19, v18, s22
v_perm_b32 v137, v19, v18, s23
v_perm_b32 v130, v21, v20, s22
v_perm_b32 v138, v21, v20, s23
v_perm_b32 v131, v23, v22, s22
v_perm_b32 v139, v23, v22, s23
v_perm_b32 v132, v25, v24, s22
v_perm_b32 v140, v25, v24, s23
v_perm_b32 v133, v27, v26, s22
v_perm_b32 v141, v27, v26, s23
v_perm_b32 v134, v29, v28, s22
v_perm_b32 v142, v29, v28, s23
v_perm_b32 v135, v31, v30, s22
v_perm_b32 v143, v31, v30, s23
ds_read_b32 v16, v7 offset:4096
ds_read_b32 v17, v7 offset:4224
ds_read_b32 v18, v7 offset:4160
ds_read_b32 v19, v7 offset:4288
ds_read_b32 v20, v7 offset:4352
ds_read_b32 v21, v7 offset:4480
ds_read_b32 v22, v7 offset:4416
ds_read_b32 v23, v7 offset:4544
s_waitcnt lgkmcnt(7)
ds_read_b32 v24, v7 offset:5120
ds_read_b32 v25, v7 offset:5248
ds_read_b32 v26, v7 offset:5184
ds_read_b32 v27, v7 offset:5312
ds_read_b32 v28, v7 offset:5376
ds_read_b32 v29, v7 offset:5504
ds_read_b32 v30, v7 offset:5440
ds_read_b32 v31, v7 offset:5568
s_waitcnt lgkmcnt(0)
v_perm_b32 v144, v17, v16, s22
v_perm_b32 v152, v17, v16, s23
v_perm_b32 v145, v19, v18, s22
v_perm_b32 v153, v19, v18, s23
v_perm_b32 v146, v21, v20, s22
v_perm_b32 v154, v21, v20, s23
v_perm_b32 v147, v23, v22, s22
v_perm_b32 v155, v23, v22, s23
v_perm_b32 v148, v25, v24, s22
v_perm_b32 v156, v25, v24, s23
v_perm_b32 v149, v27, v26, s22
v_perm_b32 v157, v27, v26, s23
v_perm_b32 v150, v29, v28, s22
v_perm_b32 v158, v29, v28, s23
v_perm_b32 v151, v31, v30, s22
v_perm_b32 v159, v31, v30, s23
s_lshl_b32 s14, s10, 1
s_add_u32 s14, s14, 2
s_and_b32 s14, s14, 7
s_lshl_b32 s14, s14, 19
s_add_u32 s15, s14, 0
s_add_u32 m0, s17, 0
v_add_u32 v3, s15, v1
global_load_lds_dwordx4 v3, s[24:25]
s_add_u32 s15, s14, 131072
s_add_u32 m0, s17, 1024
v_add_u32 v3, s15, v1
global_load_lds_dwordx4 v3, s[24:25]
s_add_u32 s15, s14, 262144
s_add_u32 m0, s17, 2048
v_add_u32 v3, s15, v1
global_load_lds_dwordx4 v3, s[24:25]
s_add_u32 s15, s14, 393216
s_add_u32 m0, s17, 3072
v_add_u32 v3, s15, v1
global_load_lds_dwordx4 v3, s[24:25]
s_add_u32 s15, s14, 0
s_add_u32 m0, s17, 4096
v_add_u32 v3, s15, v1
global_load_lds_dwordx4 v3, s[26:27]
s_add_u32 s15, s14, 131072
s_add_u32 m0, s17, 5120
v_add_u32 v3, s15, v1
global_load_lds_dwordx4 v3, s[26:27]
s_add_u32 s15, s14, 262144
s_add_u32 m0, s17, 6144
v_add_u32 v3, s15, v1
global_load_lds_dwordx4 v3, s[26:27]
s_add_u32 s15, s14, 393216
s_add_u32 m0, s17, 7168
v_add_u32 v3, s15, v1
global_load_lds_dwordx4 v3, s[26:27]
s_waitcnt vmcnt(24)
ds_read_b32 v16, v7 offset:8192
ds_read_b32 v17, v7 offset:8320
ds_read_b32 v18, v7 offset:8256
ds_read_b32 v19, v7 offset:8384
ds_read_b32 v20, v7 offset:8448
ds_read_b32 v21, v7 offset:8576
ds_read_b32 v22, v7 offset:8512
ds_read_b32 v23, v7 offset:8640
s_waitcnt lgkmcnt(7)
ds_read_b32 v24, v7 offset:9216
ds_read_b32 v25, v7 offset:9344
ds_read_b32 v26, v7 offset:9280
ds_read_b32 v27, v7 offset:9408
ds_read_b32 v28, v7 offset:9472
ds_read_b32 v29, v7 offset:9600
ds_read_b32 v30, v7 offset:9536
ds_read_b32 v31, v7 offset:9664
s_waitcnt lgkmcnt(0)
v_perm_b32 v160, v17, v16, s22
v_perm_b32 v168, v17, v16, s23
v_perm_b32 v161, v19, v18, s22
v_perm_b32 v169, v19, v18, s23
v_perm_b32 v162, v21, v20, s22
v_perm_b32 v170, v21, v20, s23
v_perm_b32 v163, v23, v22, s22
v_perm_b32 v171, v23, v22, s23
v_perm_b32 v164, v25, v24, s22
v_perm_b32 v172, v25, v24, s23
v_perm_b32 v165, v27, v26, s22
v_perm_b32 v173, v27, v26, s23
v_perm_b32 v166, v29, v28, s22
v_perm_b32 v174, v29, v28, s23
v_perm_b32 v167, v31, v30, s22
v_perm_b32 v175, v31, v30, s23
ds_read_b32 v16, v7 offset:12288
ds_read_b32 v17, v7 offset:12416
ds_read_b32 v18, v7 offset:12352
ds_read_b32 v19, v7 offset:12480
ds_read_b32 v20, v7 offset:12544
ds_read_b32 v21, v7 offset:12672
ds_read_b32 v22, v7 offset:12608
ds_read_b32 v23, v7 offset:12736
s_waitcnt lgkmcnt(7)
ds_read_b32 v24, v7 offset:13312
ds_read_b32 v25, v7 offset:13440
ds_read_b32 v26, v7 offset:13376
ds_read_b32 v27, v7 offset:13504
ds_read_b32 v28, v7 offset:13568
ds_read_b32 v29, v7 offset:13696
ds_read_b32 v30, v7 offset:13632
ds_read_b32 v31, v7 offset:13760
s_waitcnt lgkmcnt(0)
v_perm_b32 v176, v17, v16, s22
v_perm_b32 v184, v17, v16, s23
v_perm_b32 v177, v19, v18, s22
v_perm_b32 v185, v19, v18, s23
v_perm_b32 v178, v21, v20, s22
v_perm_b32 v186, v21, v20, s23
v_perm_b32 v179, v23, v22, s22
v_perm_b32 v187, v23, v22, s23
v_perm_b32 v180, v25, v24, s22
v_perm_b32 v188, v25, v24, s23
v_perm_b32 v181, v27, v26, s22
v_perm_b32 v189, v27, v26, s23
v_perm_b32 v182, v29, v28, s22
v_perm_b32 v190, v29, v28, s23
v_perm_b32 v183, v31, v30, s22
v_perm_b32 v191, v31, v30, s23
s_lshl_b32 s14, s10, 1
s_add_u32 s14, s14, 3
s_and_b32 s14, s14, 7
s_lshl_b32 s14, s14, 19
s_add_u32 s15, s14, 0
s_add_u32 m0, s17, 8192
v_add_u32 v3, s15, v1
global_load_lds_dwordx4 v3, s[24:25]
s_add_u32 s15, s14, 131072
s_add_u32 m0, s17, 9216
v_add_u32 v3, s15, v1
global_load_lds_dwordx4 v3, s[24:25]
s_add_u32 s15, s14, 262144
s_add_u32 m0, s17, 10240
v_add_u32 v3, s15, v1
global_load_lds_dwordx4 v3, s[24:25]
s_add_u32 s15, s14, 393216
s_add_u32 m0, s17, 11264
v_add_u32 v3, s15, v1
global_load_lds_dwordx4 v3, s[24:25]
s_add_u32 s15, s14, 0
s_add_u32 m0, s17, 12288
v_add_u32 v3, s15, v1
global_load_lds_dwordx4 v3, s[26:27]
s_add_u32 s15, s14, 131072
s_add_u32 m0, s17, 13312
v_add_u32 v3, s15, v1
global_load_lds_dwordx4 v3, s[26:27]
s_add_u32 s15, s14, 262144
s_add_u32 m0, s17, 14336
v_add_u32 v3, s15, v1
global_load_lds_dwordx4 v3, s[26:27]
s_add_u32 s15, s14, 393216
s_add_u32 m0, s17, 15360
v_add_u32 v3, s15, v1
global_load_lds_dwordx4 v3, s[26:27]
s_waitcnt vmcnt(24)
ds_read_b32 v16, v7 offset:16384
ds_read_b32 v17, v7 offset:16512
ds_read_b32 v18, v7 offset:16448
ds_read_b32 v19, v7 offset:16576
ds_read_b32 v20, v7 offset:16640
ds_read_b32 v21, v7 offset:16768
ds_read_b32 v22, v7 offset:16704
ds_read_b32 v23, v7 offset:16832
s_waitcnt lgkmcnt(7)
ds_read_b32 v24, v7 offset:17408
ds_read_b32 v25, v7 offset:17536
ds_read_b32 v26, v7 offset:17472
ds_read_b32 v27, v7 offset:17600
ds_read_b32 v28, v7 offset:17664
ds_read_b32 v29, v7 offset:17792
ds_read_b32 v30, v7 offset:17728
ds_read_b32 v31, v7 offset:17856
s_waitcnt lgkmcnt(0)
v_perm_b32 v192, v17, v16, s22
v_perm_b32 v200, v17, v16, s23
v_perm_b32 v193, v19, v18, s22
v_perm_b32 v201, v19, v18, s23
v_perm_b32 v194, v21, v20, s22
v_perm_b32 v202, v21, v20, s23
v_perm_b32 v195, v23, v22, s22
v_perm_b32 v203, v23, v22, s23
v_perm_b32 v196, v25, v24, s22
v_perm_b32 v204, v25, v24, s23
v_perm_b32 v197, v27, v26, s22
v_perm_b32 v205, v27, v26, s23
v_perm_b32 v198, v29, v28, s22
v_perm_b32 v206, v29, v28, s23
v_perm_b32 v199, v31, v30, s22
v_perm_b32 v207, v31, v30, s23
ds_read_b32 v16, v7 offset:20480
ds_read_b32 v17, v7 offset:20608
ds_read_b32 v18, v7 offset:20544
ds_read_b32 v19, v7 offset:20672
ds_read_b32 v20, v7 offset:20736
ds_read_b32 v21, v7 offset:20864
ds_read_b32 v22, v7 offset:20800
ds_read_b32 v23, v7 offset:20928
s_waitcnt lgkmcnt(7)
ds_read_b32 v24, v7 offset:21504
ds_read_b32 v25, v7 offset:21632
ds_read_b32 v26, v7 offset:21568
ds_read_b32 v27, v7 offset:21696
ds_read_b32 v28, v7 offset:21760
ds_read_b32 v29, v7 offset:21888
ds_read_b32 v30, v7 offset:21824
ds_read_b32 v31, v7 offset:21952
s_waitcnt lgkmcnt(0)
v_perm_b32 v208, v17, v16, s22
v_perm_b32 v216, v17, v16, s23
v_perm_b32 v209, v19, v18, s22
v_perm_b32 v217, v19, v18, s23
v_perm_b32 v210, v21, v20, s22
v_perm_b32 v218, v21, v20, s23
v_perm_b32 v211, v23, v22, s22
v_perm_b32 v219, v23, v22, s23
v_perm_b32 v212, v25, v24, s22
v_perm_b32 v220, v25, v24, s23
v_perm_b32 v213, v27, v26, s22
v_perm_b32 v221, v27, v26, s23
v_perm_b32 v214, v29, v28, s22
v_perm_b32 v222, v29, v28, s23
v_perm_b32 v215, v31, v30, s22
v_perm_b32 v223, v31, v30, s23
s_lshl_b32 s14, s10, 1
s_add_u32 s14, s14, 5
s_and_b32 s14, s14, 7
s_lshl_b32 s14, s14, 19
s_add_u32 s15, s14, 0
s_add_u32 m0, s17, 16384
v_add_u32 v3, s15, v1
global_load_lds_dwordx4 v3, s[24:25]
s_add_u32 s15, s14, 131072
s_add_u32 m0, s17, 17408
v_add_u32 v3, s15, v1
global_load_lds_dwordx4 v3, s[24:25]
s_add_u32 s15, s14, 262144
s_add_u32 m0, s17, 18432
v_add_u32 v3, s15, v1
global_load_lds_dwordx4 v3, s[24:25]
s_add_u32 s15, s14, 393216
s_add_u32 m0, s17, 19456
v_add_u32 v3, s15, v1
global_load_lds_dwordx4 v3, s[24:25]
s_add_u32 s15, s14, 0
s_add_u32 m0, s17, 20480
v_add_u32 v3, s15, v1
global_load_lds_dwordx4 v3, s[26:27]
s_add_u32 s15, s14, 131072
s_add_u32 m0, s17, 21504
v_add_u32 v3, s15, v1
global_load_lds_dwordx4 v3, s[26:27]
s_add_u32 s15, s14, 262144
s_add_u32 m0, s17, 22528
v_add_u32 v3, s15, v1
global_load_lds_dwordx4 v3, s[26:27]
s_add_u32 s15, s14, 393216
s_add_u32 m0, s17, 23552
v_add_u32 v3, s15, v1
global_load_lds_dwordx4 v3, s[26:27]
s_waitcnt vmcnt(24)
ds_read_b64_tr_b16 v[80:81], v4 offset:24576
ds_read_b64_tr_b16 v[82:83], v4 offset:24704
ds_read_b64_tr_b16 v[84:85], v4 offset:26624
ds_read_b64_tr_b16 v[86:87], v4 offset:26752
ds_read_b64_tr_b16 v[88:89], v4 offset:24608
ds_read_b64_tr_b16 v[90:91], v4 offset:24736
ds_read_b64_tr_b16 v[92:93], v4 offset:26656
ds_read_b64_tr_b16 v[94:95], v4 offset:26784
s_waitcnt lgkmcnt(7)
ds_read_b64_tr_b16 a[216:217], v5 offset:24576
ds_read_b64_tr_b16 a[218:219], v5 offset:24704
ds_read_b64_tr_b16 a[220:221], v5 offset:26624
ds_read_b64_tr_b16 a[222:223], v5 offset:26752
ds_read_b64_tr_b16 a[224:225], v5 offset:24608
ds_read_b64_tr_b16 a[226:227], v5 offset:24736
ds_read_b64_tr_b16 a[228:229], v5 offset:26656
ds_read_b64_tr_b16 a[230:231], v5 offset:26784
s_waitcnt lgkmcnt(0)
s_lshl_b32 s14, s10, 1
s_add_u32 s14, s14, 6
s_and_b32 s14, s14, 7
s_lshl_b32 s14, s14, 19
s_add_u32 s15, s14, 0
s_add_u32 m0, s17, 24576
v_add_u32 v3, s15, v1
global_load_lds_dwordx4 v3, s[24:25]
s_add_u32 s15, s14, 131072
s_add_u32 m0, s17, 25600
v_add_u32 v3, s15, v1
global_load_lds_dwordx4 v3, s[24:25]
s_add_u32 s15, s14, 262144
s_add_u32 m0, s17, 26624
v_add_u32 v3, s15, v1
global_load_lds_dwordx4 v3, s[24:25]
s_add_u32 s15, s14, 393216
s_add_u32 m0, s17, 27648
v_add_u32 v3, s15, v1
global_load_lds_dwordx4 v3, s[24:25]
s_add_u32 s15, s14, 0
s_add_u32 m0, s17, 28672
v_add_u32 v3, s15, v1
global_load_lds_dwordx4 v3, s[26:27]
s_add_u32 s15, s14, 131072
s_add_u32 m0, s17, 29696
v_add_u32 v3, s15, v1
global_load_lds_dwordx4 v3, s[26:27]
s_add_u32 s15, s14, 262144
s_add_u32 m0, s17, 30720
v_add_u32 v3, s15, v1
global_load_lds_dwordx4 v3, s[26:27]
s_add_u32 s15, s14, 393216
s_add_u32 m0, s17, 31744
v_add_u32 v3, s15, v1
global_load_lds_dwordx4 v3, s[26:27]
s_waitcnt vmcnt(24)
ds_read_b64_tr_b16 v[232:233], v4 offset:0
ds_read_b64_tr_b16 v[234:235], v4 offset:128
ds_read_b64_tr_b16 v[236:237], v4 offset:2048
ds_read_b64_tr_b16 v[238:239], v4 offset:2176
ds_read_b64_tr_b16 v[240:241], v4 offset:32
ds_read_b64_tr_b16 v[242:243], v4 offset:160
ds_read_b64_tr_b16 v[244:245], v4 offset:2080
ds_read_b64_tr_b16 v[246:247], v4 offset:2208
s_waitcnt lgkmcnt(7)
ds_read_b64_tr_b16 v[248:249], v5 offset:0
ds_read_b64_tr_b16 v[250:251], v5 offset:128
ds_read_b64_tr_b16 v[252:253], v5 offset:2048
ds_read_b64_tr_b16 v[254:255], v5 offset:2176
ds_read_b64_tr_b16 a[0:1], v5 offset:32
ds_read_b64_tr_b16 a[2:3], v5 offset:160
ds_read_b64_tr_b16 a[4:5], v5 offset:2080
ds_read_b64_tr_b16 a[6:7], v5 offset:2208
s_waitcnt lgkmcnt(0)
s_lshl_b32 s14, s10, 1
s_add_u32 s14, s14, 7
s_and_b32 s14, s14, 7
s_lshl_b32 s14, s14, 19
s_add_u32 s15, s14, 0
s_add_u32 m0, s17, 0
v_add_u32 v3, s15, v1
global_load_lds_dwordx4 v3, s[24:25]
s_add_u32 s15, s14, 131072
s_add_u32 m0, s17, 1024
v_add_u32 v3, s15, v1
global_load_lds_dwordx4 v3, s[24:25]
s_add_u32 s15, s14, 262144
s_add_u32 m0, s17, 2048
v_add_u32 v3, s15, v1
global_load_lds_dwordx4 v3, s[24:25]
s_add_u32 s15, s14, 393216
s_add_u32 m0, s17, 3072
v_add_u32 v3, s15, v1
global_load_lds_dwordx4 v3, s[24:25]
s_add_u32 s15, s14, 0
s_add_u32 m0, s17, 4096
v_add_u32 v3, s15, v1
global_load_lds_dwordx4 v3, s[26:27]
s_add_u32 s15, s14, 131072
s_add_u32 m0, s17, 5120
v_add_u32 v3, s15, v1
global_load_lds_dwordx4 v3, s[26:27]
s_add_u32 s15, s14, 262144
s_add_u32 m0, s17, 6144
v_add_u32 v3, s15, v1
global_load_lds_dwordx4 v3, s[26:27]
s_add_u32 s15, s14, 393216
s_add_u32 m0, s17, 7168
v_add_u32 v3, s15, v1
global_load_lds_dwordx4 v3, s[26:27]
s_waitcnt vmcnt(24)
ds_read_b64_tr_b16 a[104:105], v4 offset:8192
ds_read_b64_tr_b16 a[106:107], v4 offset:8320
ds_read_b64_tr_b16 a[108:109], v4 offset:10240
ds_read_b64_tr_b16 a[110:111], v4 offset:10368
ds_read_b64_tr_b16 a[112:113], v4 offset:8224
ds_read_b64_tr_b16 a[114:115], v4 offset:8352
ds_read_b64_tr_b16 a[116:117], v4 offset:10272
ds_read_b64_tr_b16 a[118:119], v4 offset:10400
s_waitcnt lgkmcnt(7)
ds_read_b64_tr_b16 a[120:121], v5 offset:8192
ds_read_b64_tr_b16 a[122:123], v5 offset:8320
ds_read_b64_tr_b16 a[124:125], v5 offset:10240
ds_read_b64_tr_b16 a[126:127], v5 offset:10368
ds_read_b64_tr_b16 v[96:97], v5 offset:8224
ds_read_b64_tr_b16 v[98:99], v5 offset:8352
ds_read_b64_tr_b16 v[100:101], v5 offset:10272
ds_read_b64_tr_b16 v[102:103], v5 offset:10400
s_waitcnt lgkmcnt(0)
s_lshl_b32 s14, s10, 1
s_add_u32 s14, s14, 6
s_and_b32 s14, s14, 7
s_lshl_b32 s14, s14, 19
s_add_u32 s15, s14, 0
s_add_u32 m0, s17, 8192
v_add_u32 v3, s15, v1
global_load_lds_dwordx4 v3, s[28:29]
s_add_u32 s15, s14, 131072
s_add_u32 m0, s17, 9216
v_add_u32 v3, s15, v1
global_load_lds_dwordx4 v3, s[28:29]
s_add_u32 s15, s14, 262144
s_add_u32 m0, s17, 10240
v_add_u32 v3, s15, v1
global_load_lds_dwordx4 v3, s[28:29]
s_add_u32 s15, s14, 393216
s_add_u32 m0, s17, 11264
v_add_u32 v3, s15, v1
global_load_lds_dwordx4 v3, s[28:29]
s_add_u32 s15, s14, 524288
s_add_u32 m0, s17, 12288
v_add_u32 v3, s15, v1
global_load_lds_dwordx4 v3, s[28:29]
s_add_u32 s15, s14, 655360
s_add_u32 m0, s17, 13312
v_add_u32 v3, s15, v1
global_load_lds_dwordx4 v3, s[28:29]
s_add_u32 s15, s14, 786432
s_add_u32 m0, s17, 14336
v_add_u32 v3, s15, v1
global_load_lds_dwordx4 v3, s[28:29]
s_add_u32 s15, s14, 917504
s_add_u32 m0, s17, 15360
v_add_u32 v3, s15, v1
global_load_lds_dwordx4 v3, s[28:29]
s_waitcnt vmcnt(24)
ds_read_b64_tr_b16 a[152:153], v4 offset:16384
ds_read_b64_tr_b16 a[154:155], v4 offset:16512
ds_read_b64_tr_b16 a[156:157], v4 offset:18432
ds_read_b64_tr_b16 a[158:159], v4 offset:18560
ds_read_b64_tr_b16 a[160:161], v4 offset:16416
ds_read_b64_tr_b16 a[162:163], v4 offset:16544
ds_read_b64_tr_b16 a[164:165], v4 offset:18464
ds_read_b64_tr_b16 a[166:167], v4 offset:18592
s_waitcnt lgkmcnt(7)
ds_read_b64_tr_b16 a[168:169], v5 offset:16384
ds_read_b64_tr_b16 a[170:171], v5 offset:16512
ds_read_b64_tr_b16 a[172:173], v5 offset:18432
ds_read_b64_tr_b16 a[174:175], v5 offset:18560
ds_read_b64_tr_b16 v[104:105], v5 offset:16416
ds_read_b64_tr_b16 v[106:107], v5 offset:16544
ds_read_b64_tr_b16 v[108:109], v5 offset:18464
ds_read_b64_tr_b16 v[110:111], v5 offset:18592
s_waitcnt lgkmcnt(0)
s_lshl_b32 s14, s10, 1
s_add_u32 s14, s14, 0
s_and_b32 s14, s14, 7
s_lshl_b32 s14, s14, 19
s_add_u32 s15, s14, 0
s_add_u32 m0, s17, 16384
v_add_u32 v3, s15, v1
global_load_lds_dwordx4 v3, s[28:29]
s_add_u32 s15, s14, 131072
s_add_u32 m0, s17, 17408
v_add_u32 v3, s15, v1
global_load_lds_dwordx4 v3, s[28:29]
s_add_u32 s15, s14, 262144
s_add_u32 m0, s17, 18432
v_add_u32 v3, s15, v1
global_load_lds_dwordx4 v3, s[28:29]
s_add_u32 s15, s14, 393216
s_add_u32 m0, s17, 19456
v_add_u32 v3, s15, v1
global_load_lds_dwordx4 v3, s[28:29]
s_add_u32 s15, s14, 524288
s_add_u32 m0, s17, 20480
v_add_u32 v3, s15, v1
global_load_lds_dwordx4 v3, s[28:29]
s_add_u32 s15, s14, 655360
s_add_u32 m0, s17, 21504
v_add_u32 v3, s15, v1
global_load_lds_dwordx4 v3, s[28:29]
s_add_u32 s15, s14, 786432
s_add_u32 m0, s17, 22528
v_add_u32 v3, s15, v1
global_load_lds_dwordx4 v3, s[28:29]
s_add_u32 s15, s14, 917504
s_add_u32 m0, s17, 23552
v_add_u32 v3, s15, v1
global_load_lds_dwordx4 v3, s[28:29]
s_waitcnt vmcnt(24)
ds_read_b64_tr_b16 a[8:9], v4 offset:24576
ds_read_b64_tr_b16 a[10:11], v4 offset:24704
ds_read_b64_tr_b16 a[12:13], v4 offset:26624
ds_read_b64_tr_b16 a[14:15], v4 offset:26752
ds_read_b64_tr_b16 a[16:17], v4 offset:24608
ds_read_b64_tr_b16 a[18:19], v4 offset:24736
ds_read_b64_tr_b16 a[20:21], v4 offset:26656
ds_read_b64_tr_b16 a[22:23], v4 offset:26784
s_waitcnt lgkmcnt(7)
ds_read_b64_tr_b16 a[24:25], v5 offset:24576
ds_read_b64_tr_b16 a[26:27], v5 offset:24704
ds_read_b64_tr_b16 a[28:29], v5 offset:26624
ds_read_b64_tr_b16 a[30:31], v5 offset:26752
ds_read_b64_tr_b16 a[32:33], v5 offset:24608
ds_read_b64_tr_b16 a[34:35], v5 offset:24736
ds_read_b64_tr_b16 a[36:37], v5 offset:26656
ds_read_b64_tr_b16 a[38:39], v5 offset:26784
s_waitcnt lgkmcnt(0)
s_add_u32 s14, s10, 0
s_and_b32 s14, s14, 3
s_lshl_b32 s14, s14, 15
s_add_u32 s15, s14, 0
s_add_u32 m0, s17, 24576
v_add_u32 v3, s15, v2
global_load_lds_dwordx4 v3, s[30:31]
s_add_u32 s15, s14, 8192
s_add_u32 m0, s17, 25600
v_add_u32 v3, s15, v2
global_load_lds_dwordx4 v3, s[30:31]
s_add_u32 s15, s14, 16384
s_add_u32 m0, s17, 26624
v_add_u32 v3, s15, v2
global_load_lds_dwordx4 v3, s[30:31]
s_add_u32 s15, s14, 24576
s_add_u32 m0, s17, 27648
v_add_u32 v3, s15, v2
global_load_lds_dwordx4 v3, s[30:31]
s_add_u32 s15, s14, 512
s_add_u32 m0, s17, 28672
v_add_u32 v3, s15, v2
global_load_lds_dwordx4 v3, s[30:31]
s_add_u32 s15, s14, 8704
s_add_u32 m0, s17, 29696
v_add_u32 v3, s15, v2
global_load_lds_dwordx4 v3, s[30:31]
s_add_u32 s15, s14, 16896
s_add_u32 m0, s17, 30720
v_add_u32 v3, s15, v2
global_load_lds_dwordx4 v3, s[30:31]
s_add_u32 s15, s14, 25088
s_add_u32 m0, s17, 31744
v_add_u32 v3, s15, v2
global_load_lds_dwordx4 v3, s[30:31]
s_waitcnt vmcnt(24)
ds_read_b64_tr_b16 a[176:177], v4 offset:0
ds_read_b64_tr_b16 a[178:179], v4 offset:128
ds_read_b64_tr_b16 a[180:181], v4 offset:2048
ds_read_b64_tr_b16 a[182:183], v4 offset:2176
ds_read_b64_tr_b16 a[184:185], v4 offset:32
ds_read_b64_tr_b16 a[186:187], v4 offset:160
ds_read_b64_tr_b16 a[188:189], v4 offset:2080
ds_read_b64_tr_b16 a[190:191], v4 offset:2208
s_waitcnt lgkmcnt(7)
ds_read_b64_tr_b16 v[112:113], v5 offset:0
ds_read_b64_tr_b16 v[114:115], v5 offset:128
ds_read_b64_tr_b16 v[116:117], v5 offset:2048
ds_read_b64_tr_b16 v[118:119], v5 offset:2176
ds_read_b64_tr_b16 a[192:193], v5 offset:32
ds_read_b64_tr_b16 a[194:195], v5 offset:160
ds_read_b64_tr_b16 a[196:197], v5 offset:2080
ds_read_b64_tr_b16 a[198:199], v5 offset:2208
s_waitcnt lgkmcnt(0)
ds_write_b128 v9, v[48:51] offset:2048
ds_write_b128 v9, v[52:55] offset:3072
ds_write_b128 v9, v[96:99] offset:0
ds_write_b128 v9, v[100:103] offset:1024
ds_write_b128 v9, v[104:107] offset:4096
ds_write_b128 v9, v[108:111] offset:5120
ds_write_b128 v9, v[112:115] offset:6144
ds_write_b128 v9, v[116:119] offset:7168
s_waitcnt lgkmcnt(0)
s_waitcnt vmcnt(16)
ds_read_b64_tr_b16 a[72:73], v6 offset:8192
ds_read_b64_tr_b16 a[74:75], v6 offset:8320
ds_read_b64_tr_b16 a[76:77], v6 offset:10240
ds_read_b64_tr_b16 a[78:79], v6 offset:10368
ds_read_b64_tr_b16 a[80:81], v6 offset:8224
ds_read_b64_tr_b16 a[82:83], v6 offset:8352
ds_read_b64_tr_b16 a[84:85], v6 offset:10272
ds_read_b64_tr_b16 a[86:87], v6 offset:10400
s_waitcnt lgkmcnt(7)
ds_read_b64_tr_b16 a[88:89], v6 offset:12288
ds_read_b64_tr_b16 a[90:91], v6 offset:12416
ds_read_b64_tr_b16 a[92:93], v6 offset:14336
ds_read_b64_tr_b16 a[94:95], v6 offset:14464
ds_read_b64_tr_b16 a[96:97], v6 offset:12320
ds_read_b64_tr_b16 a[98:99], v6 offset:12448
ds_read_b64_tr_b16 a[100:101], v6 offset:14368
ds_read_b64_tr_b16 a[102:103], v6 offset:14496
s_waitcnt lgkmcnt(0)
ds_write_b128 v9, v[32:35] offset:8192
ds_write_b128 v9, v[36:39] offset:9216
ds_write_b128 v9, v[40:43] offset:10240
ds_write_b128 v9, v[44:47] offset:11264
ds_write_b128 v9, v[80:83] offset:12288
ds_write_b128 v9, v[84:87] offset:13312
ds_write_b128 v9, v[88:91] offset:14336
ds_write_b128 v9, v[92:95] offset:15360
s_waitcnt lgkmcnt(0)
s_waitcnt vmcnt(8)
ds_read_b64_tr_b16 v[120:121], v6 offset:16384
ds_read_b64_tr_b16 v[122:123], v6 offset:16512
ds_read_b64_tr_b16 v[124:125], v6 offset:18432
ds_read_b64_tr_b16 v[126:127], v6 offset:18560
ds_read_b64_tr_b16 v[48:49], v6 offset:16416
ds_read_b64_tr_b16 v[50:51], v6 offset:16544
ds_read_b64_tr_b16 v[52:53], v6 offset:18464
ds_read_b64_tr_b16 v[54:55], v6 offset:18592
s_waitcnt lgkmcnt(7)
ds_read_b64_tr_b16 a[232:233], v6 offset:20480
ds_read_b64_tr_b16 a[234:235], v6 offset:20608
ds_read_b64_tr_b16 a[236:237], v6 offset:22528
ds_read_b64_tr_b16 a[238:239], v6 offset:22656
ds_read_b64_tr_b16 a[240:241], v6 offset:20512
ds_read_b64_tr_b16 a[242:243], v6 offset:20640
ds_read_b64_tr_b16 a[244:245], v6 offset:22560
ds_read_b64_tr_b16 a[246:247], v6 offset:22688
s_waitcnt lgkmcnt(0)
ds_write_b128 v9, v[56:59] offset:20480
ds_write_b128 v9, v[60:63] offset:21504
ds_write_b128 v9, v[64:67] offset:22528
ds_write_b128 v9, v[68:71] offset:23552
ds_write_b128 v9, v[120:123] offset:16384
ds_write_b128 v9, v[124:127] offset:17408
ds_write_b128 v9, v[48:51] offset:18432
ds_write_b128 v9, v[52:55] offset:19456
s_waitcnt lgkmcnt(0)
s_waitcnt vmcnt(0)
ds_read_b32 v16, v7 offset:24576
ds_read_b32 v17, v7 offset:24704
ds_read_b32 v18, v8 offset:24640
ds_read_b32 v19, v8 offset:24768
ds_read_b32 v20, v7 offset:24832
ds_read_b32 v21, v7 offset:24960
ds_read_b32 v22, v8 offset:24896
ds_read_b32 v23, v8 offset:25024
s_waitcnt lgkmcnt(7)
ds_read_b32 v24, v7 offset:25600
ds_read_b32 v25, v7 offset:25728
ds_read_b32 v26, v8 offset:25664
ds_read_b32 v27, v8 offset:25792
ds_read_b32 v28, v7 offset:25856
ds_read_b32 v29, v7 offset:25984
ds_read_b32 v30, v8 offset:25920
ds_read_b32 v31, v8 offset:26048
s_waitcnt lgkmcnt(0)
v_perm_b32 v96, v17, v16, s22
v_perm_b32 v104, v17, v16, s23
v_perm_b32 v97, v19, v18, s22
v_perm_b32 v105, v19, v18, s23
v_perm_b32 v98, v21, v20, s22
v_perm_b32 v106, v21, v20, s23
v_perm_b32 v99, v23, v22, s22
v_perm_b32 v107, v23, v22, s23
v_perm_b32 v100, v25, v24, s22
v_perm_b32 v108, v25, v24, s23
v_perm_b32 v101, v27, v26, s22
v_perm_b32 v109, v27, v26, s23
v_perm_b32 v102, v29, v28, s22
v_perm_b32 v110, v29, v28, s23
v_perm_b32 v103, v31, v30, s22
v_perm_b32 v111, v31, v30, s23
ds_read_b32 v16, v7 offset:28672
ds_read_b32 v17, v7 offset:28800
ds_read_b32 v18, v8 offset:28736
ds_read_b32 v19, v8 offset:28864
ds_read_b32 v20, v7 offset:28928
ds_read_b32 v21, v7 offset:29056
ds_read_b32 v22, v8 offset:28992
ds_read_b32 v23, v8 offset:29120
s_waitcnt lgkmcnt(7)
ds_read_b32 v24, v7 offset:29696
ds_read_b32 v25, v7 offset:29824
ds_read_b32 v26, v8 offset:29760
ds_read_b32 v27, v8 offset:29888
ds_read_b32 v28, v7 offset:29952
ds_read_b32 v29, v7 offset:30080
ds_read_b32 v30, v8 offset:30016
ds_read_b32 v31, v8 offset:30144
s_waitcnt lgkmcnt(0)
v_perm_b32 v112, v17, v16, s22
v_perm_b32 v224, v17, v16, s23
v_perm_b32 v113, v19, v18, s22
v_perm_b32 v225, v19, v18, s23
v_perm_b32 v114, v21, v20, s22
v_perm_b32 v226, v21, v20, s23
v_perm_b32 v115, v23, v22, s22
v_perm_b32 v227, v23, v22, s23
v_perm_b32 v116, v25, v24, s22
v_perm_b32 v228, v25, v24, s23
v_perm_b32 v117, v27, v26, s22
v_perm_b32 v229, v27, v26, s23
v_perm_b32 v118, v29, v28, s22
v_perm_b32 v230, v29, v28, s23
v_perm_b32 v119, v31, v30, s22
v_perm_b32 v231, v31, v30, s23
ds_write_b128 v9, v[72:75] offset:24576
ds_write_b128 v9, v[76:79] offset:25600
ds_write_b128 v9, v[96:99] offset:26624
ds_write_b128 v9, v[100:103] offset:27648
ds_write_b128 v9, v[104:107] offset:28672
ds_write_b128 v9, v[108:111] offset:29696
ds_write_b128 v9, v[112:115] offset:30720
ds_write_b128 v9, v[116:119] offset:31744
s_waitcnt lgkmcnt(0)
LW_done:
s_barrier
KB_roles:
s_cmp_eq_u32 s72, 0
s_cbranch_scc0 KB_slow
s_cmp_eq_u32 s12, 0
s_cbranch_scc0 F_worker
v_and_b32 v40, 15, v0
v_lshrrev_b32 v41, 4, v0
v_lshlrev_b32 v4, 4, v0
s_lshl_b32 s20, s10, 15
s_add_u32 s20, s20, 32768
v_add_u32 v16, s20, v4
v_lshrrev_b32 v42, 3, v40
v_and_b32 v43, 7, v0
v_mov_b32 v44, 0x4444
v_mov_b32 v45, 0xeeee
v_cmp_eq_u32 vcc, 1, v42
s_nop 1
v_cndmask_b32 v1, v44, v45, vcc
v_lshlrev_b32 v46, 2, v41
v_sub_u32 v46, v40, v46
v_mov_b32 v44, 0x3f80
v_mov_b32 v45, 0x3f800000
v_cmp_eq_u32 vcc, 0, v46
s_nop 1
v_cndmask_b32 v18, 0, v44, vcc
v_cmp_eq_u32 vcc, 1, v46
s_nop 1
v_cndmask_b32 v18, v18, v45, vcc
v_cmp_eq_u32 vcc, 2, v46
s_nop 1
v_cndmask_b32 v19, 0, v44, vcc
v_cmp_eq_u32 vcc, 3, v46
s_nop 1
v_cndmask_b32 v19, v19, v45, vcc
v_and_b32 v44, 3, v40
v_lshlrev_b32 v44, 2, v44
v_lshrrev_b32 v45, 2, v40
v_add_u32 v46, v44, v45
v_mov_b32 v44, 0x3f80
v_mov_b32 v45, 0x3f800000
v_cmp_eq_u32 vcc, 0, v46
s_nop 1
v_cndmask_b32 v52, 0, v44, vcc
v_cmp_eq_u32 vcc, 1, v46
s_nop 1
v_cndmask_b32 v52, v52, v45, vcc
v_cmp_eq_u32 vcc, 2, v46
s_nop 1
v_cndmask_b32 v53, 0, v44, vcc
v_cmp_eq_u32 vcc, 3, v46
s_nop 1
v_cndmask_b32 v53, v53, v45, vcc
v_cmp_eq_u32 vcc, 4, v46
s_nop 1
v_cndmask_b32 v54, 0, v44, vcc
v_cmp_eq_u32 vcc, 5, v46
s_nop 1
v_cndmask_b32 v54, v54, v45, vcc
v_cmp_eq_u32 vcc, 6, v46
s_nop 1
v_cndmask_b32 v55, 0, v44, vcc
v_cmp_eq_u32 vcc, 7, v46
s_nop 1
v_cndmask_b32 v55, v55, v45, vcc
ds_write_b128 v4, v[52:55] offset:24576
v_lshrrev_b32 v44, 1, v41
v_lshlrev_b32 v44, 3, v44
v_lshrrev_b32 v45, 2, v40
v_lshl_add_u32 v44, v45, 1, v44
v_and_b32 v45, 1, v41
v_add_u32 v44, v44, v45
s_lshl_b32 s20, s10, 4
v_add_u32 v44, s20, v44
v_lshlrev_b32 v44, 11, v44
v_and_b32 v45, 3, v0
v_lshl_add_u32 v44, v45, 4, v44
s_lshl_b32 s20, s11, 6
v_add_u32 v74, s20, v44
v_lshlrev_b32 v46, 4, v41
v_lshl_add_u32 v46, v45, 2, v46
s_lshl_b32 s20, s10, 5
s_add_u32 s20, s20, s11
s_lshl_b32 s21, s20, 6
v_add_u32 v2, s21, v46
s_lshl_b32 s21, s20, 11
s_add_u32 s34, s8, s21
s_addc_u32 s35, s9, 0
s_add_u32 s34, s34, 0x40000
s_addc_u32 s35, s35, 0
s_add_u32 s30, s8, 0x40000
s_addc_u32 s31, s9, 0
s_add_u32 s32, s8, 0x60000
s_addc_u32 s33, s9, 0
s_add_u32 s60, s8, 0x80000
s_addc_u32 s61, s9, 0
s_lshl_b32 s20, s10, 11
v_add_u32 v7, s20, v4
s_mov_b32 m0, s20
s_lshl_b32 s20, s10, 2
v_add_u32 v11, s20, v4
v_lshlrev_b32 v44, 7, v41
v_lshl_add_u32 v44, v43, 4, v44
v_lshl_add_u32 v45, v42, 3, v44
s_lshl_b32 s20, s10, 9
v_add_u32 v12, s20, v45
s_add_u32 s21, s10, 1
s_and_b32 s21, s21, 3
s_lshl_b32 s20, s21, 11
v_add_u32 v8, s20, v4
s_lshl_b32 s20, s21, 9
v_add_u32 v13, s20, v44
s_add_u32 s21, s10, 2
s_and_b32 s21, s21, 3
s_lshl_b32 s20, s21, 11
v_add_u32 v9, s20, v4
s_lshl_b32 s20, s21, 9
v_add_u32 v14, s20, v44
s_add_u32 s21, s10, 3
s_and_b32 s21, s21, 3
s_lshl_b32 s20, s21, 11
v_add_u32 v10, s20, v4
s_lshl_b32 s20, s21, 9
v_add_u32 v15, s20, v44
v_xor_b32 v3, 0x80, v10
v_xor_b32 v6, 0x80, v9
v_xor_b32 v5, 0x80, v8
v_xor_b32 v17, 0x80, v7
ds_write_b32 v7, v74 offset:25600
s_lshl_b32 s20, s11, 2
s_add_u32 s20, s20, s10
s_lshl_b32 s20, s20, 12
s_mul_i32 s21, s13, 0x2400000
s_add_u32 s20, s20, s21
s_add_u32 s24, s8, s20
s_addc_u32 s25, s9, 0
s_add_u32 s24, s24, 0x4000000
s_addc_u32 s25, s25, 0
s_add_u32 s26, s24, 0x80000
s_addc_u32 s27, s25, 0
s_lshl_b32 s20, s13, 19
s_add_u32 s28, s8, s20
s_addc_u32 s29, s9, 0
s_add_u32 s28, s28, 0x100000
s_addc_u32 s29, s29, 0
s_lshl_b32 s20, s10, 11
s_add_u32 s44, s28, s20
s_addc_u32 s45, s29, 0
s_lshl_b32 s20, s11, 8
s_add_u32 s54, s8, s20
s_addc_u32 s55, s9, 0
s_add_u32 s54, s54, 0x2000
s_addc_u32 s55, s55, 0
s_add_u32 s42, s60, s39
s_addc_u32 s43, s61, 0
s_xor_b32 s39, s39, 0x2000
s_add_u32 s46, s60, s39
s_addc_u32 s47, s61, 0
s_mov_b32 s40, 0x3f803f80
s_mov_b32 s41, 0x3f803f80
s_mov_b32 s48, 0x000f000f
s_mov_b32 s49, 0x000f000f
s_mov_b32 s50, 0x11111111
s_mov_b32 s51, 0x11111111
s_mov_b32 s52, 0x3e0293ee
s_mov_b32 s53, 0x3e0293ee
s_mov_b32 s62, 0x42700000
s_mov_b32 s63, 0xff81ff81
s_mov_b32 s64, 0
s_mov_b64 s[56:57], 0
s_waitcnt lgkmcnt(0)
global_load_lds_dwordx4 v4, s[44:45] sc1
global_load_lds_dwordx4 v4, s[44:45] offset:1024 sc1
v_mov_b32 v88, 0
v_mov_b32 v89, 0
v_mov_b32 v90, 0
v_mov_b32 v91, 0
v_mov_b32 v92, 0
v_mov_b32 v93, 0
v_mov_b32 v94, 0
v_mov_b32 v95, 0
v_mov_b32 v96, 0
v_mov_b32 v97, 0
v_mov_b32 v98, 0
v_mov_b32 v99, 0
v_mov_b32 v100, 0
v_mov_b32 v101, 0
v_mov_b32 v102, 0
v_mov_b32 v103, 0
v_mov_b64 v[64:65], 0
v_mov_b64 v[66:67], 0
v_mov_b64 v[68:69], 0
v_mov_b64 v[70:71], 0
v_mov_b64 v[72:73], 0
v_mov_b64 v[74:75], 0
v_mov_b64 v[76:77], 0
v_mov_b64 v[78:79], 0
ds_read_b128 v[28:31], v16 offset:8192
ds_read_b128 v[32:35], v16 offset:9216
ds_read_b128 v[36:39], v16 offset:10240
ds_read_b128 v[40:43], v16 offset:11264
ds_read_b128 v[44:47], v16 offset:12288
ds_read_b128 v[48:51], v16 offset:13312
ds_read_b128 v[104:107], v16 offset:14336
ds_read_b128 v[108:111], v16 offset:15360
ds_read_b128 v[112:115], v16 offset:16384
ds_read_b128 v[116:119], v16 offset:17408
ds_read_b128 v[120:123], v16 offset:18432
ds_read_b128 v[124:127], v16 offset:19456
s_mov_b32 s19, 0
Fr_k0:
global_load_dwordx2 v[80:81], v88, s[54:55] sc1
s_add_u32 s19, s19, 1
s_cmp_gt_u32 s19, 400000
s_cbranch_scc1 KB_fail
s_waitcnt vmcnt(0)
v_min_u32 v80, v80, v81
v_cmp_ge_u32 vcc, s13, v80
s_cbranch_vccz Fr_k1
s_sleep 1
s_branch Fr_k0
Fr_k1:
global_load_dwordx4 v[80:83], v4, s[24:25] sc1
global_load_dwordx4 v[84:87], v4, s[24:25] offset:1024 sc1
global_load_dwordx4 v[90:93], v4, s[24:25] offset:2048 sc1
global_load_dwordx4 v[98:101], v4, s[24:25] offset:3072 sc1
s_mov_b32 s19, 0
s_waitcnt vmcnt(0) lgkmcnt(0)
s_barrier
s_add_u32 s54, s54, 0x8
s_addc_u32 s55, s55, 0
s_waitcnt lgkmcnt(0)
s_branch Fr_top
.p2align 6
Fr_top:
s_waitcnt vmcnt(3)
ds_read_b128 v[20:23], v7 offset:0
s_waitcnt vmcnt(2)
ds_read_b128 v[24:27], v7 offset:1024
ds_read_b128 v[52:55], v17 offset:0
ds_read_b128 v[56:59], v17 offset:1024
s_waitcnt lgkmcnt(3)
v_smfmac_f32_16x16x64_bf16 v[64:67], v[20:23], v[28:35], v1
v_cmp_eq_u32 vcc, s63, v20
v_smfmac_f32_16x16x64_bf16 v[68:71], v[20:23], v[36:43], v1
s_waitcnt lgkmcnt(2)
v_cmp_eq_u32 s[58:59], s63, v24
v_smfmac_f32_16x16x64_bf16 v[64:67], v[24:27], v[44:51], v1
s_or_b64 vcc, vcc, s[58:59]
s_cbranch_scc1 Fr_p2retry
v_smfmac_f32_16x16x64_bf16 v[68:71], v[24:27], v[104:111], v1
v_smfmac_f32_16x16x64_bf16 v[72:75], v[20:23], v[112:119], v1
v_smfmac_f32_16x16x64_bf16 v[76:79], v[20:23], v[120:127], v1
s_waitcnt lgkmcnt(0)
v_smfmac_f32_16x16x64_bf16 v[72:75], v[24:27], a[232:239], v1
s_barrier
ds_read_b128 v[28:31], v8 offset:0
v_smfmac_f32_16x16x64_bf16 v[76:79], v[24:27], a[240:247], v1
ds_read_b128 v[60:63], v5 offset:0
v_smfmac_f32_16x16x64_bf16 v[64:67], v[52:55], a[200:207], v1
ds_read_b128 v[32:35], v8 offset:1024
global_load_dwordx4 v[90:93], v4, s[24:25] offset:2048 sc1
v_smfmac_f32_16x16x64_bf16 v[68:71], v[52:55], a[208:215], v1
ds_read_b128 v[104:107], v16 offset:0
v_lshlrev_b32 v0, 2, v4
v_smfmac_f32_16x16x64_bf16 v[64:67], v[56:59], a[216:223], v1
ds_read_b128 v[52:55], v5 offset:1024
v_smfmac_f32_16x16x64_bf16 v[68:71], v[56:59], a[224:231], v1
ds_read_b128 v[108:111], v16 offset:1024
s_waitcnt lgkmcnt(4)
v_smfmac_f32_16x16x64_bf16 v[64:67], v[28:31], v[232:239], v1
ds_read_b128 v[56:59], v6 offset:0
global_load_dwordx4 v[98:101], v4, s[24:25] offset:3072 sc1
v_smfmac_f32_16x16x64_bf16 v[68:71], v[28:31], v[240:247], v1
ds_read_b128 v[36:39], v9 offset:0
v_smfmac_f32_16x16x64_bf16 v[64:67], v[60:63], v[248:255], v1
ds_read_b128 v[112:115], v16 offset:2048
v_smfmac_f32_16x16x64_bf16 v[68:71], v[60:63], a[0:7], v1
ds_read_b128 v[116:119], v16 offset:3072
s_waitcnt lgkmcnt(4)
v_smfmac_f32_16x16x64_bf16 v[64:67], v[32:35], a[104:111], v1
ds_read_b128 v[60:63], v6 offset:1024
global_load_dword v0, v0, s[26:27] sc1
v_smfmac_f32_16x16x64_bf16 v[68:71], v[32:35], a[112:119], v1
ds_read_b128 v[40:43], v9 offset:1024
v_smfmac_f32_16x16x64_bf16 v[64:67], v[52:55], a[120:127], v1
ds_read_b128 v[120:123], v16 offset:4096
global_load_dword v0, v88, s[54:55] sc1
v_smfmac_f32_16x16x64_bf16 v[68:71], v[52:55], v[104:111], v1
ds_read_b128 v[124:127], v16 offset:5120
s_waitcnt lgkmcnt(4)
v_smfmac_f32_16x16x64_bf16 v[64:67], v[36:39], a[128:135], v1
ds_read_b128 v[52:55], v3 offset:0
v_smfmac_f32_16x16x64_bf16 v[68:71], v[36:39], a[136:143], v1
ds_read_b128 v[44:47], v10 offset:0
v_smfmac_f32_16x16x64_bf16 v[64:67], v[56:59], a[144:151], v1
ds_read_b128 v[104:107], v16 offset:6144
v_smfmac_f32_16x16x64_bf16 v[68:71], v[56:59], v[112:119], v1
ds_read_b128 v[108:111], v16 offset:7168
s_waitcnt lgkmcnt(4)
v_smfmac_f32_16x16x64_bf16 v[64:67], v[40:43], a[152:159], v1
ds_read_b128 v[56:59], v3 offset:1024
v_smfmac_f32_16x16x64_bf16 v[68:71], v[40:43], a[160:167], v1
ds_read_b128 v[48:51], v10 offset:1024
v_smfmac_f32_16x16x64_bf16 v[64:67], v[60:63], a[168:175], v1
ds_read_b128 v[112:115], v16 offset:20480
v_smfmac_f32_16x16x64_bf16 v[68:71], v[60:63], v[120:127], v1
ds_read_b128 v[116:119], v16 offset:21504
s_waitcnt lgkmcnt(4)
v_smfmac_f32_16x16x64_bf16 v[64:67], v[44:47], a[8:15], v1
ds_read_b128 v[120:123], v16 offset:22528
v_smfmac_f32_16x16x64_bf16 v[64:67], v[52:55], a[24:31], v1
ds_read_b128 v[124:127], v16 offset:23552
s_waitcnt lgkmcnt(4)
v_smfmac_f32_16x16x64_bf16 v[64:67], v[48:51], a[176:183], v1
s_mov_b64 exec, s[56:57]
global_store_dword v2, v89, s[28:29] sc1
s_mov_b64 exec, -1
v_smfmac_f32_16x16x64_bf16 v[64:67], v[56:59], v[104:111], v1
ds_read_b128 v[104:107], v16 offset:24576
v_smfmac_f32_16x16x64_bf16 v[68:71], v[44:47], a[16:23], v1
v_smfmac_f32_16x16x64_bf16 v[68:71], v[52:55], a[32:39], v1
ds_read_b128 v[108:111], v16 offset:25600
v_cvt_pk_bf16_f32 v64, v64, v65
v_smfmac_f32_16x16x64_bf16 v[68:71], v[48:51], a[184:191], v1
s_waitcnt lgkmcnt(2)
v_cvt_pk_bf16_f32 v65, v66, v67
v_smfmac_f32_16x16x64_bf16 v[68:71], v[56:59], a[192:199], v1
v_smfmac_f32_16x16x64_bf16 v[72:75], v[28:31], v[112:119], v1
v_mfma_f32_16x16x16_bf16 v[60:63], v[64:65], v[18:19], 0
v_cvt_pk_bf16_f32 v68, v68, v69
v_cvt_pk_bf16_f32 v69, v70, v71
v_mov_b32 v20, 0
v_mov_b32 v25, 0
v_mfma_f32_16x16x16_bf16 v[52:55], v[68:69], v[18:19], 0
s_nop 2
v_cvt_pk_bf16_f32 v64, v60, v61
v_cvt_pk_bf16_f32 v65, v62, v63
v_smfmac_f32_16x16x64_bf16 v[76:79], v[28:31], v[120:127], v1
s_nop 1
v_cvt_pk_bf16_f32 v66, v52, v53
v_cvt_pk_bf16_f32 v67, v54, v55
v_mov_b64 v[28:29], s[40:41]
v_mov_b64 v[30:31], s[40:41]
v_mfma_f32_16x16x32_bf16 v[56:59], v[64:67], v[64:67], 0
v_mfma_f32_16x16x32_bf16 v[52:55], v[80:83], v[64:67], 0
s_add_u32 s24, s24, 0x80000
s_addc_u32 s25, s25, 0
s_waitcnt lgkmcnt(0)
v_mfma_f32_16x16x32_bf16 v[68:71], v[84:87], v[64:67], 0
v_mov_b32_dpp v56, v57 row_ror:8 row_mask:0xf bank_mask:0xc
v_mov_b32_dpp v58, v59 row_ror:8 row_mask:0xf bank_mask:0xc
v_smfmac_f32_16x16x64_bf16 v[72:75], v[32:35], v[104:111], v1
s_nop 0
v_permlane32_swap_b32 v58, v56
s_nop 1
v_mov_b32_dpp v52, v68 row_ror:8 row_mask:0xf bank_mask:0xc
v_mov_b32_dpp v53, v69 row_ror:8 row_mask:0xf bank_mask:0xc
v_mov_b32_dpp v54, v70 row_ror:8 row_mask:0xf bank_mask:0xc
v_mov_b32_dpp v55, v71 row_ror:8 row_mask:0xf bank_mask:0xc
ds_write_b128 v7, v[52:55] offset:8192
ds_write_b32 v11, v56 offset:9216
v_smfmac_f32_16x16x64_bf16 v[76:79], v[32:35], a[248:255], v1
global_load_dwordx4 v[80:83], v4, s[24:25] sc1
v_smfmac_f32_16x16x64_bf16 v[72:75], v[36:39], a[40:47], v1
ds_read_b128 v[112:115], v16 offset:26624
v_smfmac_f32_16x16x64_bf16 v[72:75], v[40:43], a[56:63], v1
ds_read_b128 v[116:119], v16 offset:27648
v_smfmac_f32_16x16x64_bf16 v[72:75], v[44:47], a[72:79], v1
global_load_dwordx4 v[84:87], v4, s[24:25] offset:1024 sc1
v_smfmac_f32_16x16x64_bf16 v[72:75], v[48:51], a[88:95], v1
s_waitcnt lgkmcnt(2)
s_barrier
ds_read_b128 v[56:59], v8 offset:8192
ds_read_b128 v[60:63], v9 offset:8192
v_smfmac_f32_16x16x64_bf16 v[76:79], v[36:39], a[48:55], v1
ds_read_b128 v[68:71], v10 offset:8192
ds_read_b128 v[64:67], v4 offset:9216
v_smfmac_f32_16x16x64_bf16 v[76:79], v[40:43], a[64:71], v1
ds_read_b128 v[120:123], v16 offset:28672
v_permlane32_swap_b32 v74, v72
v_smfmac_f32_16x16x64_bf16 v[76:79], v[44:47], a[80:87], v1
ds_read_b128 v[124:127], v16 offset:29696
v_permlane32_swap_b32 v75, v73
v_smfmac_f32_16x16x64_bf16 v[76:79], v[48:51], a[96:103], v1
ds_read_b128 v[104:107], v16 offset:30720
v_pk_add_f32 v[72:73], v[72:73], v[74:75]
s_waitcnt lgkmcnt(6)
v_pk_add_f32 v[52:53], v[52:53], v[56:57]
v_pk_add_f32 v[54:55], v[54:55], v[58:59]
v_cvt_pk_bf16_f32 v94, v73, 0
v_cvt_pk_bf16_f32 v89, v72, 0
s_waitcnt lgkmcnt(4)
v_pk_add_f32 v[60:61], v[60:61], v[68:69]
v_pk_add_f32 v[62:63], v[62:63], v[70:71]
s_waitcnt lgkmcnt(3)
v_pk_add_f32 v[64:65], v[64:65], v[66:67]
v_pk_add_f32 v[52:53], v[52:53], v[60:61]
v_pk_add_f32 v[54:55], v[54:55], v[62:63]
v_add_f32 v56, v64, v65
v_pk_mul_f32 v[52:53], v[52:53], s[52:53]
v_pk_mul_f32 v[54:55], v[54:55], s[52:53]
v_mul_f32 v56, s52, v56
v_exp_f32 v58, v52
v_exp_f32 v59, v53
v_exp_f32 v60, v54
v_exp_f32 v61, v55
v_exp_f32 v62, v56
v_cvt_pk_bf16_f32 v22, v58, v59
v_cvt_pk_bf16_f32 v23, v60, v61
v_cvt_pk_bf16_f32 v24, v62, 0
v_cvt_pk_bf16_f32 v21, v62, 0
s_waitcnt vmcnt(5)
v_mfma_f32_16x16x32_bf16 v[64:67], v[28:31], v[22:25], 0
v_permlane32_swap_b32 v78, v76
v_mfma_f32_16x16x32_bf16 v[68:71], v[92:95], v[22:25], 0
v_permlane32_swap_b32 v79, v77
v_mfma_f32_16x16x32_bf16 v[32:35], v[88:91], v[20:23], 0
v_pk_add_f32 v[76:77], v[76:77], v[78:79]
v_cvt_pk_bf16_f32 v102, v77, 0
v_cvt_pk_bf16_f32 v97, v76, 0
v_add_f32_dpp v64, v64, v64 row_ror:8 row_mask:0xf bank_mask:0xf
v_mfma_f32_16x16x32_bf16 v[36:39], v[100:103], v[22:25], 0
v_rcp_f32 v64, v64
v_mfma_f32_16x16x32_bf16 v[40:43], v[96:99], v[20:23], 0
v_add_f32_dpp v32, v68, v32 row_ror:8 row_mask:0xf bank_mask:0x3
v_add_f32_dpp v33, v69, v33 row_ror:8 row_mask:0xf bank_mask:0x3
v_add_f32_dpp v34, v70, v34 row_ror:8 row_mask:0xf bank_mask:0x3
v_add_f32_dpp v35, v71, v35 row_ror:8 row_mask:0xf bank_mask:0x3
v_max3_f32 v57, abs(v52), abs(v53), abs(v54)
v_max3_f32 v57, abs(v55), abs(v56), v57
v_cmp_nlt_f32 vcc, v57, s62
s_nop 0
v_add_f32_dpp v32, v40, v36 row_ror:8 row_mask:0xf bank_mask:0xc
v_add_f32_dpp v33, v41, v37 row_ror:8 row_mask:0xf bank_mask:0xc
v_add_f32_dpp v34, v42, v38 row_ror:8 row_mask:0xf bank_mask:0xc
v_add_f32_dpp v35, v43, v39 row_ror:8 row_mask:0xf bank_mask:0xc
v_pk_mul_f32 v[32:33], v[32:33], v[64:65] op_sel_hi:[1,0]
v_pk_mul_f32 v[34:35], v[34:35], v[64:65] op_sel_hi:[1,0]
v_cvt_pk_bf16_f32 v20, v32, v33
v_cvt_pk_bf16_f32 v21, v34, v35
ds_write_b64 v12, v[20:21] offset:16384
s_cbranch_vccnz Fr_slowmax
Fr_maxdone:
v_mov_b32_dpp v22, v20 row_ror:8 row_mask:0xf bank_mask:0xf
v_mov_b32_dpp v23, v21 row_ror:8 row_mask:0xf bank_mask:0xf
v_mov_b64 v[48:49], 0
v_mov_b64 v[50:51], 0
v_mov_b64 v[36:37], 0
v_mov_b64 v[38:39], 0
v_mov_b64 v[40:41], 0
s_waitcnt lgkmcnt(0)
s_barrier
ds_read_b128 v[24:27], v13 offset:16384
v_smfmac_f32_16x16x64_bf16 v[48:51], v[20:23], v[224:231], v1
ds_read_b128 v[28:31], v14 offset:16384
v_mov_b64 v[42:43], 0
v_smfmac_f32_16x16x64_bf16 v[36:39], v[20:23], v[112:119], v1
ds_read_b128 v[32:35], v15 offset:16384
v_mov_b64 v[44:45], 0
v_smfmac_f32_16x16x64_bf16 v[40:43], v[20:23], v[120:127], v1
ds_read_b128 v[108:111], v16 offset:31744
v_mov_b64 v[46:47], 0
s_waitcnt lgkmcnt(3)
v_smfmac_f32_16x16x64_bf16 v[36:39], v[24:27], v[128:135], v1
s_waitcnt lgkmcnt(2)
v_smfmac_f32_16x16x64_bf16 v[36:39], v[28:31], v[160:167], v1
s_waitcnt lgkmcnt(1)
v_smfmac_f32_16x16x64_bf16 v[36:39], v[32:35], v[192:199], v1
ds_read_b32 v74, v7 offset:25600
v_smfmac_f32_16x16x64_bf16 v[40:43], v[24:27], v[136:143], v1
v_smfmac_f32_16x16x64_bf16 v[40:43], v[28:31], v[168:175], v1
v_cvt_pk_bf16_f32 v36, v36, v37
v_smfmac_f32_16x16x64_bf16 v[40:43], v[32:35], v[200:207], v1
s_waitcnt lgkmcnt(0)
v_cvt_pk_bf16_f32 v37, v38, v39
v_smfmac_f32_16x16x64_bf16 v[44:47], v[20:23], v[104:111], v1
s_mov_b64 exec, s[50:51]
v_and_or_b32 v36, v36, -2, s38
v_smfmac_f32_16x16x64_bf16 v[44:47], v[24:27], v[144:151], v1
s_mov_b64 exec, -1
v_cvt_pk_bf16_f32 v38, v40, v41
v_smfmac_f32_16x16x64_bf16 v[44:47], v[28:31], v[176:183], v1
v_cvt_pk_bf16_f32 v39, v42, v43
v_smfmac_f32_16x16x64_bf16 v[44:47], v[32:35], v[208:215], v1
global_store_dwordx4 v74, v[36:39], s[30:31]
v_smfmac_f32_16x16x64_bf16 v[48:51], v[24:27], v[152:159], v1
v_smfmac_f32_16x16x64_bf16 v[48:51], v[28:31], v[184:191], v1
v_cvt_pk_bf16_f32 v44, v44, v45
v_smfmac_f32_16x16x64_bf16 v[48:51], v[32:35], v[216:223], v1
v_cvt_pk_bf16_f32 v45, v46, v47
s_mov_b64 exec, s[50:51]
v_and_or_b32 v44, v44, -2, s38
s_mov_b64 exec, -1
s_nop 3
v_cvt_pk_bf16_f32 v46, v48, v49
v_cvt_pk_bf16_f32 v47, v50, v51
global_store_dwordx4 v74, v[44:47], s[32:33]
ds_read_b128 v[20:23], v4 offset:24576
ds_read_b128 v[104:107], v16 offset:14336
ds_read_b128 v[108:111], v16 offset:15360
ds_read_b128 v[112:115], v16 offset:16384
ds_read_b128 v[116:119], v16 offset:17408
ds_read_b128 v[120:123], v16 offset:18432
ds_read_b128 v[124:127], v16 offset:19456
s_nop 15
s_nop 14
s_cmp_lt_u32 s10, 2
s_cbranch_scc1 Fr_p1s
s_nop 15
Fr_p1s:
global_load_dwordx4 v[52:55], v4, s[34:35] sc1
global_load_dwordx4 v[56:59], v4, s[34:35] offset:1024 sc1
v_mov_b32 v25, s63
v_cndmask_b32 v26, 0, 1, s[50:51]
v_mov_b64 v[64:65], 0
v_mov_b64 v[66:67], 0
v_mov_b64 v[68:69], 0
v_mov_b64 v[70:71], 0
v_mov_b64 v[72:73], 0
v_mov_b64 v[74:75], 0
v_mov_b64 v[76:77], 0
v_mov_b64 v[78:79], 0
s_nop 15
s_nop 5
global_load_dwordx4 v[90:93], v4, s[34:35] sc1
global_load_dwordx4 v[98:101], v4, s[34:35] offset:1024 sc1
s_waitcnt lgkmcnt(6)
s_waitcnt vmcnt(3)
v_mfma_f32_16x16x32_bf16 v[60:63], v[20:23], v[52:55], 0
s_waitcnt vmcnt(2)
v_mfma_f32_16x16x32_bf16 v[60:63], v[20:23], v[56:59], v[60:63]
v_bitop3_b32 v24, v52, v56, s38 bitop3:0x7e
v_and_b32 v24, v26, v24
v_cmp_ne_u32 vcc, 0, v24
s_nop 3
s_cbranch_vccnz Fr_p1retry
Fr_p1ok:
v_add_f32_dpp v60, v60, v60 row_ror:8 row_mask:0xf bank_mask:0xf
v_add_f32_dpp v61, v61, v61 row_ror:8 row_mask:0xf bank_mask:0xf
s_nop 0
v_add_f32_dpp v60, v60, v60 row_ror:4 row_mask:0xf bank_mask:0xf
v_add_f32_dpp v61, v61, v61 row_ror:4 row_mask:0xf bank_mask:0xf
s_mov_b64 exec, s[48:49]
v_cvt_pk_bf16_f32 v89, v60, v61
global_store_dword v2, v89, s[42:43]
global_store_dword v2, v25, s[46:47]
s_mov_b64 exec, -1
s_xor_b32 s38, s38, 1
s_add_u32 s64, s64, 1
s_add_u32 s28, s28, 0x2000
s_addc_u32 s29, s29, 0
s_cmp_lt_u32 s64, 63
s_cbranch_scc0 Fr_fin
ds_read_b128 v[28:31], v16 offset:8192
ds_read_b128 v[32:35], v16 offset:9216
ds_read_b128 v[36:39], v16 offset:10240
ds_read_b128 v[40:43], v16 offset:11264
ds_read_b128 v[44:47], v16 offset:12288
ds_read_b128 v[48:51], v16 offset:13312
s_lshl_b32 s20, s10, 11
s_add_u32 s44, s42, s20
s_addc_u32 s45, s43, 0
v_cmp_ge_u32 vcc, s13, v0
s_cbranch_vccnz Fr_kvwait
Fr_kvok:
s_nop 11
global_load_lds_dwordx4 v4, s[44:45] sc1
global_load_lds_dwordx4 v4, s[44:45] offset:1024 sc1
s_add_u32 s42, s60, s39
s_addc_u32 s43, s61, 0
s_xor_b32 s39, s39, 0x2000
s_add_u32 s46, s60, s39
s_addc_u32 s47, s61, 0
s_add_u32 s26, s26, 0x80000
s_addc_u32 s27, s27, 0
s_cmp_lt_u32 s64, 62
s_cselect_b32 s20, 4, 0
s_mov_b64 s[56:57], s[48:49]
s_add_u32 s54, s54, s20
s_addc_u32 s55, s55, 0
s_nop 15
s_nop 8
global_load_lds_dwordx4 v4, s[44:45] sc1
global_load_lds_dwordx4 v4, s[44:45] offset:1024 sc1
s_waitcnt lgkmcnt(0)
s_branch Fr_top
Fr_kvwait:
global_load_dword v0, v88, s[54:55] sc1
s_add_u32 s19, s19, 1
s_cmp_gt_u32 s19, 400000
s_cbranch_scc1 KB_fail
s_waitcnt vmcnt(0)
v_cmp_ge_u32 vcc, s13, v0
s_cbranch_vccz Fr_kvok
s_sleep 1
s_branch Fr_kvwait
Fr_p1retry:
global_load_dwordx4 v[52:55], v4, s[34:35] sc1
global_load_dwordx4 v[56:59], v4, s[34:35] offset:1024 sc1
s_waitcnt vmcnt(3)
v_mfma_f32_16x16x32_bf16 v[60:63], v[20:23], v[90:93], 0
s_waitcnt vmcnt(2)
v_mfma_f32_16x16x32_bf16 v[60:63], v[20:23], v[98:101], v[60:63]
v_bitop3_b32 v24, v90, v98, s38 bitop3:0x7e
v_and_b32 v24, v26, v24
v_cmp_ne_u32 vcc, 0, v24
s_nop 3
s_cbranch_vccz Fr_p1ok
global_load_dwordx4 v[90:93], v4, s[34:35] sc1
global_load_dwordx4 v[98:101], v4, s[34:35] offset:1024 sc1
s_add_u32 s19, s19, 1
s_cmp_gt_u32 s19, 400000
s_cbranch_scc1 KB_fail
s_waitcnt vmcnt(3)
v_mfma_f32_16x16x32_bf16 v[60:63], v[20:23], v[52:55], 0
s_waitcnt vmcnt(2)
v_mfma_f32_16x16x32_bf16 v[60:63], v[20:23], v[56:59], v[60:63]
v_bitop3_b32 v24, v52, v56, s38 bitop3:0x7e
v_and_b32 v24, v26, v24
v_cmp_ne_u32 vcc, 0, v24
s_nop 3
s_cbranch_vccz Fr_p1ok
s_branch Fr_p1retry
Fr_p2retry:
global_load_lds_dwordx4 v4, s[44:45] sc1
global_load_lds_dwordx4 v4, s[44:45] offset:1024 sc1
s_add_u32 s19, s19, 1
s_cmp_gt_u32 s19, 400000
s_cbranch_scc1 KB_fail
s_nop 0
v_mov_b64 v[64:65], 0
v_mov_b64 v[66:67], 0
v_mov_b64 v[68:69], 0
v_mov_b64 v[70:71], 0
s_waitcnt lgkmcnt(0)
s_branch Fr_top
Fr_slowmax:
v_max3_f32 v57, v52, v53, v54
v_max3_f32 v57, v55, v56, v57
s_nop 1
v_max_f32_dpp v57, v57, v57 row_ror:8 row_mask:0xf bank_mask:0xf
v_mov_b32 v58, v57
s_nop 1
v_permlane16_swap_b32 v57, v58
v_max_f32 v57, v57, v58
v_mov_b32 v58, v57
s_nop 1
v_permlane32_swap_b32 v57, v58
v_max_f32 v57, v57, v58
s_waitcnt lgkmcnt(0)
v_mov_b32 v20, 0
v_sub_f32 v52, v52, v57
v_sub_f32 v53, v53, v57
v_sub_f32 v54, v54, v57
v_sub_f32 v55, v55, v57
v_sub_f32 v56, v56, v57
v_exp_f32 v58, v52
v_exp_f32 v59, v53
v_exp_f32 v60, v54
v_exp_f32 v61, v55
v_exp_f32 v62, v56
v_cvt_pk_bf16_f32 v22, v58, v59
v_cvt_pk_bf16_f32 v23, v60, v61
v_cvt_pk_bf16_f32 v24, v62, 0
v_cvt_pk_bf16_f32 v21, v62, 0
s_nop 0
v_mfma_f32_16x16x32_bf16 v[64:67], v[28:31], v[22:25], 0
v_mfma_f32_16x16x32_bf16 v[68:71], v[92:95], v[22:25], 0
v_mfma_f32_16x16x32_bf16 v[32:35], v[88:91], v[20:23], 0
v_add_f32_dpp v64, v64, v64 row_ror:8 row_mask:0xf bank_mask:0xf
v_mfma_f32_16x16x32_bf16 v[36:39], v[100:103], v[22:25], 0
v_rcp_f32 v64, v64
v_mfma_f32_16x16x32_bf16 v[40:43], v[96:99], v[20:23], 0
v_add_f32_dpp v32, v68, v32 row_ror:8 row_mask:0xf bank_mask:0x3
v_add_f32_dpp v33, v69, v33 row_ror:8 row_mask:0xf bank_mask:0x3
v_add_f32_dpp v34, v70, v34 row_ror:8 row_mask:0xf bank_mask:0x3
v_add_f32_dpp v35, v71, v35 row_ror:8 row_mask:0xf bank_mask:0x3
s_nop 3
v_add_f32_dpp v32, v40, v36 row_ror:8 row_mask:0xf bank_mask:0xc
v_add_f32_dpp v33, v41, v37 row_ror:8 row_mask:0xf bank_mask:0xc
v_add_f32_dpp v34, v42, v38 row_ror:8 row_mask:0xf bank_mask:0xc
v_add_f32_dpp v35, v43, v39 row_ror:8 row_mask:0xf bank_mask:0xc
v_pk_mul_f32 v[32:33], v[32:33], v[64:65] op_sel_hi:[1,0]
v_pk_mul_f32 v[34:35], v[34:35], v[64:65] op_sel_hi:[1,0]
v_cvt_pk_bf16_f32 v20, v32, v33
v_cvt_pk_bf16_f32 v21, v34, v35
ds_write_b64 v12, v[20:21] offset:16384
s_branch Fr_maxdone
Fr_fin:
s_mov_b64 exec, s[48:49]
global_store_dword v2, v89, s[28:29] sc1
s_mov_b64 exec, -1
s_waitcnt vmcnt(0) lgkmcnt(0)
v_lshrrev_b32 v0, 4, v4
s_barrier
s_branch KB_next
F_worker:
s_cmp_eq_u32 s10, 0
s_cbranch_scc0 Fw_y2d
v_and_b32 v1, 7, v0
v_lshlrev_b32 v1, 8, v1
s_mov_b32 s19, 0
s_add_u32 s20, s8, 0x7000
s_addc_u32 s21, s9, 0
Fw_y2:
global_load_dword v4, v1, s[20:21] sc1
s_add_u32 s19, s19, 1
s_cmp_gt_u32 s19, 400000
s_cbranch_scc1 KB_fail
s_waitcnt vmcnt(0)
v_cmp_ge_u32 vcc, s13, v4
s_cbranch_vccz Fw_y2d
s_sleep 1
s_branch Fw_y2
Fw_y2d:
s_barrier
s_sub_u32 s36, s12, 1
s_mov_b32 s66, s36
s_add_u32 s67, s36, 1
s_mov_b32 s68, -1
Fw_F:
v_and_b32 v76, 15, v0
v_lshrrev_b32 v77, 4, v0
v_lshlrev_b32 v1, 4, v0
v_lshlrev_b32 v6, 2, v0
s_lshl_b32 s14, s11, 14
s_lshl_b32 s15, s10, 12
s_add_u32 s14, s14, s15
v_lshrrev_b32 v78, 3, v0
v_lshlrev_b32 v2, 13, v78
v_and_b32 v78, 7, v0
v_lshl_add_u32 v2, v78, 4, v2
v_and_b32 v78, 32, v0
v_lshlrev_b32 v78, 1, v78
v_xor_b32 v2, v78, v2
s_lshl_b32 s26, s10, 13
s_mov_b32 s36, s66
s_add_u32 s20, s8, s14
s_addc_u32 s21, s9, 0
s_add_u32 s20, s20, 0x280000
s_addc_u32 s21, s21, 0
s_lshl_b32 s14, s13, 21
s_lshl_b32 s15, s10, 19
s_add_u32 s15, s15, s14
s_lshl_b32 s16, s36, 7
s_add_u32 s15, s15, s16
s_add_u32 s28, s8, s15
s_addc_u32 s29, s9, 0
s_add_u32 s28, s28, 0xa00000
s_addc_u32 s29, s29, 0
global_load_dwordx4 v[8:11], v1, s[20:21] offset:0
global_load_dwordx4 v[12:15], v1, s[20:21] offset:1024
global_load_dwordx4 v[16:19], v1, s[20:21] offset:2048
global_load_dwordx4 v[20:23], v1, s[20:21] offset:3072
s_add_u32 m0, s26, 0
s_add_u32 s30, s28, 0x0
s_addc_u32 s31, s29, 0
global_load_lds_dwordx4 v2, s[30:31] sc1
s_add_u32 m0, s26, 1024
s_add_u32 s30, s28, 0x10000
s_addc_u32 s31, s29, 0
global_load_lds_dwordx4 v2, s[30:31] sc1
s_add_u32 m0, s26, 2048
s_add_u32 s30, s28, 0x20000
s_addc_u32 s31, s29, 0
global_load_lds_dwordx4 v2, s[30:31] sc1
s_add_u32 m0, s26, 3072
s_add_u32 s30, s28, 0x30000
s_addc_u32 s31, s29, 0
global_load_lds_dwordx4 v2, s[30:31] sc1
s_add_u32 m0, s26, 4096
s_add_u32 s30, s28, 0x40000
s_addc_u32 s31, s29, 0
global_load_lds_dwordx4 v2, s[30:31] sc1
s_add_u32 m0, s26, 5120
s_add_u32 s30, s28, 0x50000
s_addc_u32 s31, s29, 0
global_load_lds_dwordx4 v2, s[30:31] sc1
s_add_u32 m0, s26, 6144
s_add_u32 s30, s28, 0x60000
s_addc_u32 s31, s29, 0
global_load_lds_dwordx4 v2, s[30:31] sc1
s_add_u32 m0, s26, 7168
s_add_u32 s30, s28, 0x70000
s_addc_u32 s31, s29, 0
global_load_lds_dwordx4 v2, s[30:31] sc1
v_lshlrev_b32 v7, 9, v77
v_lshl_add_u32 v7, v76, 2, v7
v_and_b32 v78, 1, v77
v_lshl_add_u32 v7, v78, 6, v7
v_add_u32 v7, s26, v7
v_xor_b32 v84, 64, v7
v_lshrrev_b32 v78, 5, v0
v_bfe_u32 v79, v0, 2, 3
v_and_b32 v80, 3, v0
s_lshl_b32 s15, s36, 15
s_cmp_eq_u32 s13, 0
s_cbranch_scc0 Fw_F1_x2
v_lshlrev_b32 v5, 10, v79
v_lshl_add_u32 v5, v78, 4, v5
s_lshl_b32 s16, s10, 13
s_lshl_b32 s17, s11, 5
s_add_u32 s16, s16, s17
s_add_u32 s16, s16, s15
s_add_u32 s22, s4, s16
s_addc_u32 s23, s5, 0
s_branch Fw_F1_x3
Fw_F1_x2:
v_lshlrev_b32 v5, 4, v79
v_lshl_add_u32 v5, v78, 8, v5
s_lshr_b32 s16, s11, 3
s_lshl_b32 s16, s16, 13
s_and_b32 s17, s11, 7
s_lshl_b32 s17, s17, 9
s_add_u32 s16, s16, s17
s_lshr_b32 s17, s10, 1
s_lshl_b32 s17, s17, 12
s_add_u32 s16, s16, s17
s_and_b32 s17, s10, 1
s_lshl_b32 s17, s17, 7
s_add_u32 s16, s16, s17
s_add_u32 s16, s16, s15
s_add_u32 s22, s8, s16
s_addc_u32 s23, s9, 0
s_add_u32 s22, s22, 0x1200000
s_addc_u32 s23, s23, 0
Fw_F1_x3:
v_lshl_add_u32 v5, v80, 2, v5
global_load_dword v72, v5, s[22:23] sc1
global_load_dword v72, v5, s[22:23] sc1
s_lshl_b32 s16, s10, 13
s_lshl_b32 s17, s11, 8
s_add_u32 s16, s16, s17
s_add_u32 s16, s16, s15
s_add_u32 s16, s16, s14
s_add_u32 s24, s8, s16
s_addc_u32 s25, s9, 0
s_add_u32 s24, s24, 0xe00000
s_addc_u32 s25, s25, 0
v_add_u32 v3, s26, v1
v_lshrrev_b32 v4, 1, v80
v_lshl_add_u32 v4, v78, 1, v4
v_lshl_add_u32 v4, v4, 4, v79
v_lshlrev_b32 v4, 4, v4
v_and_b32 v80, 1, v0
v_lshl_add_u32 v4, v80, 3, v4
s_lshr_b32 s14, s10, 1
s_lshl_b32 s14, s14, 10
s_and_b32 s16, s10, 1
s_lshl_b32 s16, s16, 7
s_add_u32 s14, s14, s16
v_add_u32 v4, s14, v4
Fw_F1_l:
s_waitcnt vmcnt(8)
ds_read_b32 v24, v7 offset:0
ds_read_b32 v40, v84 offset:0
ds_read_b32 v25, v7 offset:128
ds_read_b32 v41, v84 offset:128
ds_read_b32 v26, v7 offset:256
ds_read_b32 v42, v84 offset:256
ds_read_b32 v27, v7 offset:384
ds_read_b32 v43, v84 offset:384
s_waitcnt vmcnt(6)
ds_read_b32 v28, v7 offset:2048
ds_read_b32 v44, v84 offset:2048
ds_read_b32 v29, v7 offset:2176
ds_read_b32 v45, v84 offset:2176
ds_read_b32 v30, v7 offset:2304
ds_read_b32 v46, v84 offset:2304
s_waitcnt lgkmcnt(13)
ds_read_b32 v31, v7 offset:2432
ds_read_b32 v47, v84 offset:2432
s_waitcnt lgkmcnt(8)
v_mfma_f32_16x16x32_bf16 v[56:59], v[8:11], v[24:27], 0
v_mfma_f32_16x16x32_bf16 v[60:63], v[8:11], v[40:43], 0
s_waitcnt vmcnt(4)
ds_read_b32 v32, v7 offset:4096
ds_read_b32 v48, v84 offset:4096
ds_read_b32 v33, v7 offset:4224
ds_read_b32 v49, v84 offset:4224
ds_read_b32 v34, v7 offset:4352
ds_read_b32 v50, v84 offset:4352
s_waitcnt lgkmcnt(13)
ds_read_b32 v35, v7 offset:4480
ds_read_b32 v51, v84 offset:4480
s_waitcnt lgkmcnt(8)
v_mfma_f32_16x16x32_bf16 v[56:59], v[12:15], v[28:31], v[56:59]
v_mfma_f32_16x16x32_bf16 v[60:63], v[12:15], v[44:47], v[60:63]
s_waitcnt vmcnt(2)
ds_read_b32 v36, v7 offset:6144
ds_read_b32 v52, v84 offset:6144
ds_read_b32 v37, v7 offset:6272
ds_read_b32 v53, v84 offset:6272
ds_read_b32 v38, v7 offset:6400
ds_read_b32 v54, v84 offset:6400
s_waitcnt lgkmcnt(13)
ds_read_b32 v39, v7 offset:6528
ds_read_b32 v55, v84 offset:6528
s_waitcnt lgkmcnt(8)
v_mfma_f32_16x16x32_bf16 v[56:59], v[16:19], v[32:35], v[56:59]
v_mfma_f32_16x16x32_bf16 v[60:63], v[16:19], v[48:51], v[60:63]
s_waitcnt lgkmcnt(0)
v_mfma_f32_16x16x32_bf16 v[56:59], v[20:23], v[36:39], v[56:59]
v_mfma_f32_16x16x32_bf16 v[60:63], v[20:23], v[52:55], v[60:63]
s_waitcnt vmcnt(1)
v_lshlrev_b32 v74, 16, v72
v_and_b32 v75, 0xffff0000, v72
s_add_u32 s36, s36, 7
s_cmp_lt_u32 s36, s67
s_cbranch_scc0 Fw_F1_nl
s_add_u32 s28, s28, 0x380
s_addc_u32 s29, s29, 0
s_add_u32 s22, s22, 0x38000
s_addc_u32 s23, s23, 0
s_add_u32 m0, s26, 0
s_add_u32 s30, s28, 0x0
s_addc_u32 s31, s29, 0
global_load_lds_dwordx4 v2, s[30:31] sc1
s_add_u32 m0, s26, 1024
s_add_u32 s30, s28, 0x10000
s_addc_u32 s31, s29, 0
global_load_lds_dwordx4 v2, s[30:31] sc1
s_add_u32 m0, s26, 2048
s_add_u32 s30, s28, 0x20000
s_addc_u32 s31, s29, 0
global_load_lds_dwordx4 v2, s[30:31] sc1
s_add_u32 m0, s26, 3072
s_add_u32 s30, s28, 0x30000
s_addc_u32 s31, s29, 0
global_load_lds_dwordx4 v2, s[30:31] sc1
s_add_u32 m0, s26, 4096
s_add_u32 s30, s28, 0x40000
s_addc_u32 s31, s29, 0
global_load_lds_dwordx4 v2, s[30:31] sc1
s_add_u32 m0, s26, 5120
s_add_u32 s30, s28, 0x50000
s_addc_u32 s31, s29, 0
global_load_lds_dwordx4 v2, s[30:31] sc1
Fw_F1_nl:
ds_write_b128 v3, v[56:59] offset:6144
s_nop 0
ds_write_b128 v3, v[60:63] offset:7168
s_waitcnt lgkmcnt(0)
s_barrier
ds_read_b64 v[64:65], v4 offset:6144
ds_read_b64 v[66:67], v4 offset:14336
ds_read_b64 v[68:69], v4 offset:22528
ds_read_b64 v[70:71], v4 offset:30720
s_waitcnt lgkmcnt(0)
s_cmp_lt_u32 s36, s67
s_cbranch_scc0 Fw_F1_n2
s_barrier
s_add_u32 m0, s26, 6144
s_add_u32 s30, s28, 0x60000
s_addc_u32 s31, s29, 0
global_load_lds_dwordx4 v2, s[30:31] sc1
s_add_u32 m0, s26, 7168
s_add_u32 s30, s28, 0x70000
s_addc_u32 s31, s29, 0
global_load_lds_dwordx4 v2, s[30:31] sc1
global_load_dword v72, v5, s[22:23] sc1
Fw_F1_n2:
v_pk_add_f32 v[64:65], v[64:65], v[66:67]
v_pk_add_f32 v[68:69], v[68:69], v[70:71]
v_pk_add_f32 v[64:65], v[64:65], v[68:69]
v_cvt_pk_bf16_f32 v64, v64, v65
v_lshlrev_b32 v66, 16, v64
v_and_b32 v67, 0xffff0000, v64
v_pk_add_f32 v[66:67], v[66:67], v[74:75]
v_cvt_pk_bf16_f32 v64, v66, v67
global_store_dword v6, v64, s[24:25]
s_add_u32 s24, s24, 0x38000
s_addc_u32 s25, s25, 0
s_cmp_lt_u32 s36, s67
s_cbranch_scc1 Fw_F1_l
v_lshlrev_b32 v4, 4, v0
v_mov_b32 v20, 0x4444
v_mov_b32 v21, 0xeeee
s_mov_b32 s20, 0xff00ff00
s_mov_b32 s21, 0xff00ff00
v_cndmask_b32 v1, v20, v21, s[20:21]
s_lshl_b32 s20, s10, 15
s_add_u32 s20, s20, 32768
v_add_u32 v13, s20, v4
s_add_u32 s20, s10, 0
s_and_b32 s20, s20, 3
s_lshl_b32 s20, s20, 11
v_add_u32 v5, s20, v4
v_xor_b32 v9, 0x80, v5
s_add_u32 s20, s10, 1
s_and_b32 s20, s20, 3
s_lshl_b32 s20, s20, 11
v_add_u32 v6, s20, v4
v_xor_b32 v10, 0x80, v6
s_add_u32 s20, s10, 2
s_and_b32 s20, s20, 3
s_lshl_b32 s20, s20, 11
v_add_u32 v7, s20, v4
v_xor_b32 v11, 0x80, v7
s_add_u32 s20, s10, 3
s_and_b32 s20, s20, 3
s_lshl_b32 s20, s20, 11
v_add_u32 v8, s20, v4
v_xor_b32 v12, 0x80, v8
s_add_u32 s18, s18, 1
s_waitcnt vmcnt(0)
s_barrier
s_cmp_eq_u32 s10, 0
s_cbranch_scc0 Fw_g1_d
s_lshl_b32 s22, s12, 8
s_add_u32 s20, s8, s22
s_addc_u32 s21, s9, 0
s_add_u32 s20, s20, 0x1000
s_addc_u32 s21, s21, 0
v_mov_b32 v127, s18
v_and_b32 v126, 31, v0
v_lshlrev_b32 v126, 2, v126
v_cmp_eq_u32 vcc, s11, v0
s_mov_b64 exec, vcc
global_store_dword v126, v127, s[20:21]
s_mov_b64 exec, -1
s_mov_b32 s19, 0
Fw_g1_p:
global_load_dword v127, v126, s[20:21] sc1
s_add_u32 s19, s19, 1
s_cmp_gt_u32 s19, 400000
s_cbranch_scc1 KB_fail
s_waitcnt vmcnt(0)
v_cmp_gt_u32 vcc, s18, v127
s_cbranch_vccnz Fw_g1_p
Fw_g1_d:
s_barrier
s_mov_b32 s36, s66
s_lshl_b32 s20, s36, 15
s_lshl_b32 s21, s13, 21
s_add_u32 s20, s20, s21
s_lshl_b32 s21, s10, 13
s_add_u32 s20, s20, s21
s_add_u32 s22, s8, s20
s_addc_u32 s23, s9, 0
s_add_u32 s22, s22, 0xe01000
s_addc_u32 s23, s23, 0
global_load_dwordx4 v[80:83], v4, s[22:23] offset:-4096 sc1
global_load_dwordx4 v[84:87], v4, s[22:23] offset:-3072 sc1
global_load_dwordx4 v[88:91], v4, s[22:23] offset:-2048 sc1
global_load_dwordx4 v[92:95], v4, s[22:23] offset:-1024 sc1
global_load_dwordx4 v[96:99], v4, s[22:23] offset:0 sc1
global_load_dwordx4 v[100:103], v4, s[22:23] offset:1024 sc1
global_load_dwordx4 v[104:107], v4, s[22:23] offset:2048 sc1
global_load_dwordx4 v[108:111], v4, s[22:23] offset:3072 sc1
Fw_F2:
v_mov_b64 v[16:17], 0
v_mov_b64 v[18:19], 0
v_mov_b64 v[20:21], 0
v_mov_b64 v[22:23], 0
v_mov_b64 v[24:25], 0
v_mov_b64 v[26:27], 0
v_mov_b64 v[28:29], 0
v_mov_b64 v[30:31], 0
v_mov_b64 v[32:33], 0
v_mov_b64 v[34:35], 0
v_mov_b64 v[36:37], 0
v_mov_b64 v[38:39], 0
v_mov_b64 v[40:41], 0
v_mov_b64 v[42:43], 0
v_mov_b64 v[44:45], 0
v_mov_b64 v[46:47], 0
v_mov_b64 v[48:49], 0
v_mov_b64 v[50:51], 0
v_mov_b64 v[52:53], 0
v_mov_b64 v[54:55], 0
v_mov_b64 v[56:57], 0
v_mov_b64 v[58:59], 0
v_mov_b64 v[60:61], 0
v_mov_b64 v[62:63], 0
v_mov_b64 v[64:65], 0
v_mov_b64 v[66:67], 0
v_mov_b64 v[68:69], 0
v_mov_b64 v[70:71], 0
v_mov_b64 v[72:73], 0
v_mov_b64 v[74:75], 0
v_mov_b64 v[76:77], 0
v_mov_b64 v[78:79], 0
v_mov_b32 v112, 0
v_mov_b32 v113, 0
v_mov_b32 v114, 0x3f803f80
s_lshl_b32 s20, s10, 13
v_add_u32 v14, s20, v4
s_cmp_eq_u32 s68, -1
s_cbranch_scc0 Fw_F2_st
s_waitcnt vmcnt(7)
v_dot2c_f32_bf16 v112, v80, v114
v_dot2c_f32_bf16 v113, v80, v80
v_dot2c_f32_bf16 v112, v81, v114
v_dot2c_f32_bf16 v113, v81, v81
v_dot2c_f32_bf16 v112, v82, v114
v_dot2c_f32_bf16 v113, v82, v82
v_dot2c_f32_bf16 v112, v83, v114
v_dot2c_f32_bf16 v113, v83, v83
s_waitcnt vmcnt(6)
v_dot2c_f32_bf16 v112, v84, v114
v_dot2c_f32_bf16 v113, v84, v84
v_dot2c_f32_bf16 v112, v85, v114
v_dot2c_f32_bf16 v113, v85, v85
v_dot2c_f32_bf16 v112, v86, v114
v_dot2c_f32_bf16 v113, v86, v86
v_dot2c_f32_bf16 v112, v87, v114
v_dot2c_f32_bf16 v113, v87, v87
s_waitcnt vmcnt(5)
v_dot2c_f32_bf16 v112, v88, v114
v_dot2c_f32_bf16 v113, v88, v88
v_dot2c_f32_bf16 v112, v89, v114
v_dot2c_f32_bf16 v113, v89, v89
v_dot2c_f32_bf16 v112, v90, v114
v_dot2c_f32_bf16 v113, v90, v90
v_dot2c_f32_bf16 v112, v91, v114
v_dot2c_f32_bf16 v113, v91, v91
s_waitcnt vmcnt(4)
v_dot2c_f32_bf16 v112, v92, v114
v_dot2c_f32_bf16 v113, v92, v92
v_dot2c_f32_bf16 v112, v93, v114
v_dot2c_f32_bf16 v113, v93, v93
v_dot2c_f32_bf16 v112, v94, v114
v_dot2c_f32_bf16 v113, v94, v94
v_dot2c_f32_bf16 v112, v95, v114
v_dot2c_f32_bf16 v113, v95, v95
s_waitcnt vmcnt(3)
v_dot2c_f32_bf16 v112, v96, v114
v_dot2c_f32_bf16 v113, v96, v96
v_dot2c_f32_bf16 v112, v97, v114
v_dot2c_f32_bf16 v113, v97, v97
v_dot2c_f32_bf16 v112, v98, v114
v_dot2c_f32_bf16 v113, v98, v98
v_dot2c_f32_bf16 v112, v99, v114
v_dot2c_f32_bf16 v113, v99, v99
s_waitcnt vmcnt(2)
v_dot2c_f32_bf16 v112, v100, v114
v_dot2c_f32_bf16 v113, v100, v100
v_dot2c_f32_bf16 v112, v101, v114
v_dot2c_f32_bf16 v113, v101, v101
v_dot2c_f32_bf16 v112, v102, v114
v_dot2c_f32_bf16 v113, v102, v102
v_dot2c_f32_bf16 v112, v103, v114
v_dot2c_f32_bf16 v113, v103, v103
s_waitcnt vmcnt(1)
v_dot2c_f32_bf16 v112, v104, v114
v_dot2c_f32_bf16 v113, v104, v104
v_dot2c_f32_bf16 v112, v105, v114
v_dot2c_f32_bf16 v113, v105, v105
v_dot2c_f32_bf16 v112, v106, v114
v_dot2c_f32_bf16 v113, v106, v106
v_dot2c_f32_bf16 v112, v107, v114
v_dot2c_f32_bf16 v113, v107, v107
s_waitcnt vmcnt(0)
v_dot2c_f32_bf16 v112, v108, v114
v_dot2c_f32_bf16 v113, v108, v108
v_dot2c_f32_bf16 v112, v109, v114
v_dot2c_f32_bf16 v113, v109, v109
v_dot2c_f32_bf16 v112, v110, v114
v_dot2c_f32_bf16 v113, v110, v110
v_dot2c_f32_bf16 v112, v111, v114
v_dot2c_f32_bf16 v113, v111, v111
s_branch Fw_F2_sd
Fw_F2_st:
s_waitcnt vmcnt(6)
v_dot2c_f32_bf16 v112, v80, v114
v_dot2c_f32_bf16 v113, v80, v80
v_dot2c_f32_bf16 v112, v81, v114
v_dot2c_f32_bf16 v113, v81, v81
v_dot2c_f32_bf16 v112, v82, v114
v_dot2c_f32_bf16 v113, v82, v82
v_dot2c_f32_bf16 v112, v83, v114
v_dot2c_f32_bf16 v113, v83, v83
v_dot2c_f32_bf16 v112, v84, v114
v_dot2c_f32_bf16 v113, v84, v84
v_dot2c_f32_bf16 v112, v85, v114
v_dot2c_f32_bf16 v113, v85, v85
v_dot2c_f32_bf16 v112, v86, v114
v_dot2c_f32_bf16 v113, v86, v86
v_dot2c_f32_bf16 v112, v87, v114
v_dot2c_f32_bf16 v113, v87, v87
v_dot2c_f32_bf16 v112, v88, v114
v_dot2c_f32_bf16 v113, v88, v88
v_dot2c_f32_bf16 v112, v89, v114
v_dot2c_f32_bf16 v113, v89, v89
v_dot2c_f32_bf16 v112, v90, v114
v_dot2c_f32_bf16 v113, v90, v90
v_dot2c_f32_bf16 v112, v91, v114
v_dot2c_f32_bf16 v113, v91, v91
v_dot2c_f32_bf16 v112, v92, v114
v_dot2c_f32_bf16 v113, v92, v92
v_dot2c_f32_bf16 v112, v93, v114
v_dot2c_f32_bf16 v113, v93, v93
v_dot2c_f32_bf16 v112, v94, v114
v_dot2c_f32_bf16 v113, v94, v94
v_dot2c_f32_bf16 v112, v95, v114
v_dot2c_f32_bf16 v113, v95, v95
v_dot2c_f32_bf16 v112, v96, v114
v_dot2c_f32_bf16 v113, v96, v96
v_dot2c_f32_bf16 v112, v97, v114
v_dot2c_f32_bf16 v113, v97, v97
v_dot2c_f32_bf16 v112, v98, v114
v_dot2c_f32_bf16 v113, v98, v98
v_dot2c_f32_bf16 v112, v99, v114
v_dot2c_f32_bf16 v113, v99, v99
v_dot2c_f32_bf16 v112, v100, v114
v_dot2c_f32_bf16 v113, v100, v100
v_dot2c_f32_bf16 v112, v101, v114
v_dot2c_f32_bf16 v113, v101, v101
v_dot2c_f32_bf16 v112, v102, v114
v_dot2c_f32_bf16 v113, v102, v102
v_dot2c_f32_bf16 v112, v103, v114
v_dot2c_f32_bf16 v113, v103, v103
v_dot2c_f32_bf16 v112, v104, v114
v_dot2c_f32_bf16 v113, v104, v104
v_dot2c_f32_bf16 v112, v105, v114
v_dot2c_f32_bf16 v113, v105, v105
v_dot2c_f32_bf16 v112, v106, v114
v_dot2c_f32_bf16 v113, v106, v106
v_dot2c_f32_bf16 v112, v107, v114
v_dot2c_f32_bf16 v113, v107, v107
v_dot2c_f32_bf16 v112, v108, v114
v_dot2c_f32_bf16 v113, v108, v108
v_dot2c_f32_bf16 v112, v109, v114
v_dot2c_f32_bf16 v113, v109, v109
v_dot2c_f32_bf16 v112, v110, v114
v_dot2c_f32_bf16 v113, v110, v110
v_dot2c_f32_bf16 v112, v111, v114
v_dot2c_f32_bf16 v113, v111, v111
Fw_F2_sd:
s_nop 1
v_add_f32_dpp v112, v112, v112 row_ror:8 row_mask:0xf bank_mask:0xf
v_mov_b32 v116, v112
s_nop 1
v_permlane16_swap_b32 v112, v116
v_add_f32 v112, v112, v116
v_mov_b32 v116, v112
s_nop 1
v_permlane32_swap_b32 v112, v116
v_add_f32 v112, v112, v116
v_add_f32_dpp v113, v113, v113 row_ror:8 row_mask:0xf bank_mask:0xf
v_mov_b32 v116, v113
s_nop 1
v_permlane16_swap_b32 v113, v116
v_add_f32 v113, v113, v116
v_mov_b32 v116, v113
s_nop 1
v_permlane32_swap_b32 v113, v116
v_add_f32 v113, v113, v116
v_mul_f32 v112, 0x3b000000, v112
v_mul_f32 v113, 0x3b000000, v113
v_fma_f32 v113, -v112, v112, v113
v_max_f32 v113, 0, v113
v_add_f32 v113, 0x3727c5ac, v113
v_rsq_f32 v113, v113
s_nop 0
v_mul_f32 v112, -v112, v113
v_lshlrev_b32 v116, 16, v80
v_and_b32 v117, 0xffff0000, v80
v_pk_fma_f32 v[116:117], v[116:117], v[112:113], v[112:113] op_sel:[0,1,0] op_sel_hi:[1,1,0]
v_cvt_pk_bf16_f32 v80, v116, v117
v_lshlrev_b32 v116, 16, v81
v_and_b32 v117, 0xffff0000, v81
v_pk_fma_f32 v[116:117], v[116:117], v[112:113], v[112:113] op_sel:[0,1,0] op_sel_hi:[1,1,0]
v_cvt_pk_bf16_f32 v81, v116, v117
v_lshlrev_b32 v116, 16, v82
v_and_b32 v117, 0xffff0000, v82
v_pk_fma_f32 v[116:117], v[116:117], v[112:113], v[112:113] op_sel:[0,1,0] op_sel_hi:[1,1,0]
v_cvt_pk_bf16_f32 v82, v116, v117
v_lshlrev_b32 v116, 16, v83
v_and_b32 v117, 0xffff0000, v83
v_pk_fma_f32 v[116:117], v[116:117], v[112:113], v[112:113] op_sel:[0,1,0] op_sel_hi:[1,1,0]
v_cvt_pk_bf16_f32 v83, v116, v117
ds_write_b128 v14, v[80:83] offset:0
v_lshlrev_b32 v116, 16, v84
v_and_b32 v117, 0xffff0000, v84
v_pk_fma_f32 v[116:117], v[116:117], v[112:113], v[112:113] op_sel:[0,1,0] op_sel_hi:[1,1,0]
v_cvt_pk_bf16_f32 v84, v116, v117
v_lshlrev_b32 v116, 16, v85
v_and_b32 v117, 0xffff0000, v85
v_pk_fma_f32 v[116:117], v[116:117], v[112:113], v[112:113] op_sel:[0,1,0] op_sel_hi:[1,1,0]
v_cvt_pk_bf16_f32 v85, v116, v117
v_lshlrev_b32 v116, 16, v86
v_and_b32 v117, 0xffff0000, v86
v_pk_fma_f32 v[116:117], v[116:117], v[112:113], v[112:113] op_sel:[0,1,0] op_sel_hi:[1,1,0]
v_cvt_pk_bf16_f32 v86, v116, v117
v_lshlrev_b32 v116, 16, v87
v_and_b32 v117, 0xffff0000, v87
v_pk_fma_f32 v[116:117], v[116:117], v[112:113], v[112:113] op_sel:[0,1,0] op_sel_hi:[1,1,0]
v_cvt_pk_bf16_f32 v87, v116, v117
ds_write_b128 v14, v[84:87] offset:1024
v_lshlrev_b32 v116, 16, v88
v_and_b32 v117, 0xffff0000, v88
v_pk_fma_f32 v[116:117], v[116:117], v[112:113], v[112:113] op_sel:[0,1,0] op_sel_hi:[1,1,0]
v_cvt_pk_bf16_f32 v88, v116, v117
v_lshlrev_b32 v116, 16, v89
v_and_b32 v117, 0xffff0000, v89
v_pk_fma_f32 v[116:117], v[116:117], v[112:113], v[112:113] op_sel:[0,1,0] op_sel_hi:[1,1,0]
v_cvt_pk_bf16_f32 v89, v116, v117
v_lshlrev_b32 v116, 16, v90
v_and_b32 v117, 0xffff0000, v90
v_pk_fma_f32 v[116:117], v[116:117], v[112:113], v[112:113] op_sel:[0,1,0] op_sel_hi:[1,1,0]
v_cvt_pk_bf16_f32 v90, v116, v117
v_lshlrev_b32 v116, 16, v91
v_and_b32 v117, 0xffff0000, v91
v_pk_fma_f32 v[116:117], v[116:117], v[112:113], v[112:113] op_sel:[0,1,0] op_sel_hi:[1,1,0]
v_cvt_pk_bf16_f32 v91, v116, v117
ds_write_b128 v14, v[88:91] offset:2048
v_lshlrev_b32 v116, 16, v92
v_and_b32 v117, 0xffff0000, v92
v_pk_fma_f32 v[116:117], v[116:117], v[112:113], v[112:113] op_sel:[0,1,0] op_sel_hi:[1,1,0]
v_cvt_pk_bf16_f32 v92, v116, v117
v_lshlrev_b32 v116, 16, v93
v_and_b32 v117, 0xffff0000, v93
v_pk_fma_f32 v[116:117], v[116:117], v[112:113], v[112:113] op_sel:[0,1,0] op_sel_hi:[1,1,0]
v_cvt_pk_bf16_f32 v93, v116, v117
v_lshlrev_b32 v116, 16, v94
v_and_b32 v117, 0xffff0000, v94
v_pk_fma_f32 v[116:117], v[116:117], v[112:113], v[112:113] op_sel:[0,1,0] op_sel_hi:[1,1,0]
v_cvt_pk_bf16_f32 v94, v116, v117
v_lshlrev_b32 v116, 16, v95
v_and_b32 v117, 0xffff0000, v95
v_pk_fma_f32 v[116:117], v[116:117], v[112:113], v[112:113] op_sel:[0,1,0] op_sel_hi:[1,1,0]
v_cvt_pk_bf16_f32 v95, v116, v117
ds_write_b128 v14, v[92:95] offset:3072
v_lshlrev_b32 v116, 16, v96
v_and_b32 v117, 0xffff0000, v96
v_pk_fma_f32 v[116:117], v[116:117], v[112:113], v[112:113] op_sel:[0,1,0] op_sel_hi:[1,1,0]
v_cvt_pk_bf16_f32 v96, v116, v117
v_lshlrev_b32 v116, 16, v97
v_and_b32 v117, 0xffff0000, v97
v_pk_fma_f32 v[116:117], v[116:117], v[112:113], v[112:113] op_sel:[0,1,0] op_sel_hi:[1,1,0]
v_cvt_pk_bf16_f32 v97, v116, v117
v_lshlrev_b32 v116, 16, v98
v_and_b32 v117, 0xffff0000, v98
v_pk_fma_f32 v[116:117], v[116:117], v[112:113], v[112:113] op_sel:[0,1,0] op_sel_hi:[1,1,0]
v_cvt_pk_bf16_f32 v98, v116, v117
v_lshlrev_b32 v116, 16, v99
v_and_b32 v117, 0xffff0000, v99
v_pk_fma_f32 v[116:117], v[116:117], v[112:113], v[112:113] op_sel:[0,1,0] op_sel_hi:[1,1,0]
v_cvt_pk_bf16_f32 v99, v116, v117
ds_write_b128 v14, v[96:99] offset:4096
v_lshlrev_b32 v116, 16, v100
v_and_b32 v117, 0xffff0000, v100
v_pk_fma_f32 v[116:117], v[116:117], v[112:113], v[112:113] op_sel:[0,1,0] op_sel_hi:[1,1,0]
v_cvt_pk_bf16_f32 v100, v116, v117
v_lshlrev_b32 v116, 16, v101
v_and_b32 v117, 0xffff0000, v101
v_pk_fma_f32 v[116:117], v[116:117], v[112:113], v[112:113] op_sel:[0,1,0] op_sel_hi:[1,1,0]
v_cvt_pk_bf16_f32 v101, v116, v117
v_lshlrev_b32 v116, 16, v102
v_and_b32 v117, 0xffff0000, v102
v_pk_fma_f32 v[116:117], v[116:117], v[112:113], v[112:113] op_sel:[0,1,0] op_sel_hi:[1,1,0]
v_cvt_pk_bf16_f32 v102, v116, v117
v_lshlrev_b32 v116, 16, v103
v_and_b32 v117, 0xffff0000, v103
v_pk_fma_f32 v[116:117], v[116:117], v[112:113], v[112:113] op_sel:[0,1,0] op_sel_hi:[1,1,0]
v_cvt_pk_bf16_f32 v103, v116, v117
ds_write_b128 v14, v[100:103] offset:5120
v_lshlrev_b32 v116, 16, v104
v_and_b32 v117, 0xffff0000, v104
v_pk_fma_f32 v[116:117], v[116:117], v[112:113], v[112:113] op_sel:[0,1,0] op_sel_hi:[1,1,0]
v_cvt_pk_bf16_f32 v104, v116, v117
v_lshlrev_b32 v116, 16, v105
v_and_b32 v117, 0xffff0000, v105
v_pk_fma_f32 v[116:117], v[116:117], v[112:113], v[112:113] op_sel:[0,1,0] op_sel_hi:[1,1,0]
v_cvt_pk_bf16_f32 v105, v116, v117
v_lshlrev_b32 v116, 16, v106
v_and_b32 v117, 0xffff0000, v106
v_pk_fma_f32 v[116:117], v[116:117], v[112:113], v[112:113] op_sel:[0,1,0] op_sel_hi:[1,1,0]
v_cvt_pk_bf16_f32 v106, v116, v117
v_lshlrev_b32 v116, 16, v107
v_and_b32 v117, 0xffff0000, v107
v_pk_fma_f32 v[116:117], v[116:117], v[112:113], v[112:113] op_sel:[0,1,0] op_sel_hi:[1,1,0]
v_cvt_pk_bf16_f32 v107, v116, v117
ds_write_b128 v14, v[104:107] offset:6144
v_lshlrev_b32 v116, 16, v108
v_and_b32 v117, 0xffff0000, v108
v_pk_fma_f32 v[116:117], v[116:117], v[112:113], v[112:113] op_sel:[0,1,0] op_sel_hi:[1,1,0]
v_cvt_pk_bf16_f32 v108, v116, v117
v_lshlrev_b32 v116, 16, v109
v_and_b32 v117, 0xffff0000, v109
v_pk_fma_f32 v[116:117], v[116:117], v[112:113], v[112:113] op_sel:[0,1,0] op_sel_hi:[1,1,0]
v_cvt_pk_bf16_f32 v109, v116, v117
v_lshlrev_b32 v116, 16, v110
v_and_b32 v117, 0xffff0000, v110
v_pk_fma_f32 v[116:117], v[116:117], v[112:113], v[112:113] op_sel:[0,1,0] op_sel_hi:[1,1,0]
v_cvt_pk_bf16_f32 v110, v116, v117
v_lshlrev_b32 v116, 16, v111
v_and_b32 v117, 0xffff0000, v111
v_pk_fma_f32 v[116:117], v[116:117], v[112:113], v[112:113] op_sel:[0,1,0] op_sel_hi:[1,1,0]
v_cvt_pk_bf16_f32 v111, v116, v117
ds_write_b128 v14, v[108:111] offset:7168
s_waitcnt lgkmcnt(0)
s_barrier
ds_read_b128 v[112:115], v13 offset:8192
ds_read_b128 v[116:119], v13 offset:9216
ds_read_b128 v[80:83], v5 offset:0
ds_read_b128 v[84:87], v5 offset:8192
ds_read_b128 v[88:91], v5 offset:16384
ds_read_b128 v[92:95], v5 offset:24576
ds_read_b128 v[120:123], v13 offset:10240
ds_read_b128 v[124:127], v13 offset:11264
s_waitcnt lgkmcnt(5)
v_smfmac_f32_16x16x64_bf16 v[16:19], v[80:83], v[112:119], v1
s_waitcnt lgkmcnt(4)
v_smfmac_f32_16x16x64_bf16 v[20:23], v[84:87], v[112:119], v1
s_waitcnt lgkmcnt(3)
v_smfmac_f32_16x16x64_bf16 v[24:27], v[88:91], v[112:119], v1
s_waitcnt lgkmcnt(2)
v_smfmac_f32_16x16x64_bf16 v[28:31], v[92:95], v[112:119], v1
ds_read_b128 v[112:115], v13 offset:16384
ds_read_b128 v[116:119], v13 offset:17408
s_waitcnt lgkmcnt(2)
v_smfmac_f32_16x16x64_bf16 v[32:35], v[80:83], v[120:127], v1
ds_read_b128 v[96:99], v9 offset:0
v_smfmac_f32_16x16x64_bf16 v[36:39], v[84:87], v[120:127], v1
ds_read_b128 v[100:103], v9 offset:8192
v_smfmac_f32_16x16x64_bf16 v[40:43], v[88:91], v[120:127], v1
ds_read_b128 v[104:107], v9 offset:16384
v_smfmac_f32_16x16x64_bf16 v[44:47], v[92:95], v[120:127], v1
ds_read_b128 v[108:111], v9 offset:24576
ds_read_b128 v[120:123], v13 offset:18432
ds_read_b128 v[124:127], v13 offset:19456
s_waitcnt lgkmcnt(6)
v_smfmac_f32_16x16x64_bf16 v[48:51], v[80:83], v[112:119], v1
v_smfmac_f32_16x16x64_bf16 v[52:55], v[84:87], v[112:119], v1
v_smfmac_f32_16x16x64_bf16 v[56:59], v[88:91], v[112:119], v1
v_smfmac_f32_16x16x64_bf16 v[60:63], v[92:95], v[112:119], v1
ds_read_b128 v[112:115], v13 offset:12288
ds_read_b128 v[116:119], v13 offset:13312
s_waitcnt lgkmcnt(2)
v_smfmac_f32_16x16x64_bf16 v[64:67], v[80:83], v[120:127], v1
ds_read_b128 v[80:83], v5 offset:1024
v_smfmac_f32_16x16x64_bf16 v[68:71], v[84:87], v[120:127], v1
ds_read_b128 v[84:87], v5 offset:9216
v_smfmac_f32_16x16x64_bf16 v[72:75], v[88:91], v[120:127], v1
ds_read_b128 v[88:91], v5 offset:17408
v_smfmac_f32_16x16x64_bf16 v[76:79], v[92:95], v[120:127], v1
ds_read_b128 v[92:95], v5 offset:25600
ds_read_b128 v[120:123], v13 offset:14336
ds_read_b128 v[124:127], v13 offset:15360
v_smfmac_f32_16x16x64_bf16 v[16:19], v[96:99], a[200:207], v1
v_smfmac_f32_16x16x64_bf16 v[20:23], v[100:103], a[200:207], v1
v_smfmac_f32_16x16x64_bf16 v[24:27], v[104:107], a[200:207], v1
v_smfmac_f32_16x16x64_bf16 v[28:31], v[108:111], a[200:207], v1
v_smfmac_f32_16x16x64_bf16 v[32:35], v[96:99], a[208:215], v1
v_smfmac_f32_16x16x64_bf16 v[36:39], v[100:103], a[208:215], v1
v_smfmac_f32_16x16x64_bf16 v[40:43], v[104:107], a[208:215], v1
v_smfmac_f32_16x16x64_bf16 v[44:47], v[108:111], a[208:215], v1
s_waitcnt lgkmcnt(5)
v_smfmac_f32_16x16x64_bf16 v[16:19], v[80:83], v[112:119], v1
s_waitcnt lgkmcnt(4)
v_smfmac_f32_16x16x64_bf16 v[20:23], v[84:87], v[112:119], v1
s_waitcnt lgkmcnt(3)
v_smfmac_f32_16x16x64_bf16 v[24:27], v[88:91], v[112:119], v1
s_waitcnt lgkmcnt(2)
v_smfmac_f32_16x16x64_bf16 v[28:31], v[92:95], v[112:119], v1
ds_read_b128 v[112:115], v13 offset:20480
ds_read_b128 v[116:119], v13 offset:21504
s_waitcnt lgkmcnt(2)
v_smfmac_f32_16x16x64_bf16 v[32:35], v[80:83], v[120:127], v1
ds_read_b128 v[96:99], v9 offset:1024
v_smfmac_f32_16x16x64_bf16 v[36:39], v[84:87], v[120:127], v1
ds_read_b128 v[100:103], v9 offset:9216
v_smfmac_f32_16x16x64_bf16 v[40:43], v[88:91], v[120:127], v1
ds_read_b128 v[104:107], v9 offset:17408
v_smfmac_f32_16x16x64_bf16 v[44:47], v[92:95], v[120:127], v1
ds_read_b128 v[108:111], v9 offset:25600
ds_read_b128 v[120:123], v13 offset:22528
ds_read_b128 v[124:127], v13 offset:23552
v_smfmac_f32_16x16x64_bf16 v[48:51], v[80:83], a[232:239], v1
v_smfmac_f32_16x16x64_bf16 v[52:55], v[84:87], a[232:239], v1
v_smfmac_f32_16x16x64_bf16 v[56:59], v[88:91], a[232:239], v1
v_smfmac_f32_16x16x64_bf16 v[60:63], v[92:95], a[232:239], v1
v_smfmac_f32_16x16x64_bf16 v[64:67], v[80:83], a[240:247], v1
ds_read_b128 v[80:83], v6 offset:0
v_smfmac_f32_16x16x64_bf16 v[68:71], v[84:87], a[240:247], v1
ds_read_b128 v[84:87], v6 offset:8192
v_smfmac_f32_16x16x64_bf16 v[72:75], v[88:91], a[240:247], v1
ds_read_b128 v[88:91], v6 offset:16384
v_smfmac_f32_16x16x64_bf16 v[76:79], v[92:95], a[240:247], v1
ds_read_b128 v[92:95], v6 offset:24576
s_waitcnt lgkmcnt(9)
v_smfmac_f32_16x16x64_bf16 v[16:19], v[96:99], a[216:223], v1
s_waitcnt lgkmcnt(8)
v_smfmac_f32_16x16x64_bf16 v[20:23], v[100:103], a[216:223], v1
s_waitcnt lgkmcnt(7)
v_smfmac_f32_16x16x64_bf16 v[24:27], v[104:107], a[216:223], v1
s_waitcnt lgkmcnt(6)
v_smfmac_f32_16x16x64_bf16 v[28:31], v[108:111], a[216:223], v1
v_smfmac_f32_16x16x64_bf16 v[32:35], v[96:99], a[224:231], v1
v_smfmac_f32_16x16x64_bf16 v[36:39], v[100:103], a[224:231], v1
v_smfmac_f32_16x16x64_bf16 v[40:43], v[104:107], a[224:231], v1
v_smfmac_f32_16x16x64_bf16 v[44:47], v[108:111], a[224:231], v1
s_waitcnt lgkmcnt(3)
v_smfmac_f32_16x16x64_bf16 v[16:19], v[80:83], v[232:239], v1
s_waitcnt lgkmcnt(2)
v_smfmac_f32_16x16x64_bf16 v[20:23], v[84:87], v[232:239], v1
s_waitcnt lgkmcnt(1)
v_smfmac_f32_16x16x64_bf16 v[24:27], v[88:91], v[232:239], v1
s_waitcnt lgkmcnt(0)
v_smfmac_f32_16x16x64_bf16 v[28:31], v[92:95], v[232:239], v1
v_smfmac_f32_16x16x64_bf16 v[32:35], v[80:83], v[240:247], v1
ds_read_b128 v[96:99], v10 offset:0
v_smfmac_f32_16x16x64_bf16 v[36:39], v[84:87], v[240:247], v1
ds_read_b128 v[100:103], v10 offset:8192
v_smfmac_f32_16x16x64_bf16 v[40:43], v[88:91], v[240:247], v1
ds_read_b128 v[104:107], v10 offset:16384
v_smfmac_f32_16x16x64_bf16 v[44:47], v[92:95], v[240:247], v1
ds_read_b128 v[108:111], v10 offset:24576
v_smfmac_f32_16x16x64_bf16 v[48:51], v[80:83], v[112:119], v1
v_smfmac_f32_16x16x64_bf16 v[52:55], v[84:87], v[112:119], v1
v_smfmac_f32_16x16x64_bf16 v[56:59], v[88:91], v[112:119], v1
v_smfmac_f32_16x16x64_bf16 v[60:63], v[92:95], v[112:119], v1
ds_read_b128 v[112:115], v13 offset:24576
ds_read_b128 v[116:119], v13 offset:25600
v_smfmac_f32_16x16x64_bf16 v[64:67], v[80:83], v[120:127], v1
ds_read_b128 v[80:83], v6 offset:1024
v_smfmac_f32_16x16x64_bf16 v[68:71], v[84:87], v[120:127], v1
ds_read_b128 v[84:87], v6 offset:9216
v_smfmac_f32_16x16x64_bf16 v[72:75], v[88:91], v[120:127], v1
ds_read_b128 v[88:91], v6 offset:17408
v_smfmac_f32_16x16x64_bf16 v[76:79], v[92:95], v[120:127], v1
ds_read_b128 v[92:95], v6 offset:25600
ds_read_b128 v[120:123], v13 offset:0
ds_read_b128 v[124:127], v13 offset:1024
s_waitcnt lgkmcnt(11)
v_smfmac_f32_16x16x64_bf16 v[16:19], v[96:99], v[248:255], v1
s_waitcnt lgkmcnt(10)
v_smfmac_f32_16x16x64_bf16 v[20:23], v[100:103], v[248:255], v1
s_waitcnt lgkmcnt(9)
v_smfmac_f32_16x16x64_bf16 v[24:27], v[104:107], v[248:255], v1
s_waitcnt lgkmcnt(8)
v_smfmac_f32_16x16x64_bf16 v[28:31], v[108:111], v[248:255], v1
v_smfmac_f32_16x16x64_bf16 v[32:35], v[96:99], a[0:7], v1
v_smfmac_f32_16x16x64_bf16 v[36:39], v[100:103], a[0:7], v1
v_smfmac_f32_16x16x64_bf16 v[40:43], v[104:107], a[0:7], v1
v_smfmac_f32_16x16x64_bf16 v[44:47], v[108:111], a[0:7], v1
s_waitcnt lgkmcnt(5)
v_smfmac_f32_16x16x64_bf16 v[16:19], v[80:83], a[104:111], v1
s_waitcnt lgkmcnt(4)
v_smfmac_f32_16x16x64_bf16 v[20:23], v[84:87], a[104:111], v1
s_waitcnt lgkmcnt(3)
v_smfmac_f32_16x16x64_bf16 v[24:27], v[88:91], a[104:111], v1
s_waitcnt lgkmcnt(2)
v_smfmac_f32_16x16x64_bf16 v[28:31], v[92:95], a[104:111], v1
v_smfmac_f32_16x16x64_bf16 v[32:35], v[80:83], a[112:119], v1
ds_read_b128 v[96:99], v10 offset:1024
v_smfmac_f32_16x16x64_bf16 v[36:39], v[84:87], a[112:119], v1
ds_read_b128 v[100:103], v10 offset:9216
v_smfmac_f32_16x16x64_bf16 v[40:43], v[88:91], a[112:119], v1
ds_read_b128 v[104:107], v10 offset:17408
v_smfmac_f32_16x16x64_bf16 v[44:47], v[92:95], a[112:119], v1
ds_read_b128 v[108:111], v10 offset:25600
v_smfmac_f32_16x16x64_bf16 v[48:51], v[80:83], v[112:119], v1
v_smfmac_f32_16x16x64_bf16 v[52:55], v[84:87], v[112:119], v1
v_smfmac_f32_16x16x64_bf16 v[56:59], v[88:91], v[112:119], v1
v_smfmac_f32_16x16x64_bf16 v[60:63], v[92:95], v[112:119], v1
ds_read_b128 v[112:115], v13 offset:2048
ds_read_b128 v[116:119], v13 offset:3072
v_smfmac_f32_16x16x64_bf16 v[64:67], v[80:83], a[248:255], v1
ds_read_b128 v[80:83], v7 offset:0
v_smfmac_f32_16x16x64_bf16 v[68:71], v[84:87], a[248:255], v1
ds_read_b128 v[84:87], v7 offset:8192
v_smfmac_f32_16x16x64_bf16 v[72:75], v[88:91], a[248:255], v1
ds_read_b128 v[88:91], v7 offset:16384
v_smfmac_f32_16x16x64_bf16 v[76:79], v[92:95], a[248:255], v1
ds_read_b128 v[92:95], v7 offset:24576
s_waitcnt lgkmcnt(9)
v_smfmac_f32_16x16x64_bf16 v[16:19], v[96:99], a[120:127], v1
s_waitcnt lgkmcnt(8)
v_smfmac_f32_16x16x64_bf16 v[20:23], v[100:103], a[120:127], v1
s_waitcnt lgkmcnt(7)
v_smfmac_f32_16x16x64_bf16 v[24:27], v[104:107], a[120:127], v1
s_waitcnt lgkmcnt(6)
v_smfmac_f32_16x16x64_bf16 v[28:31], v[108:111], a[120:127], v1
v_smfmac_f32_16x16x64_bf16 v[32:35], v[96:99], v[120:127], v1
v_smfmac_f32_16x16x64_bf16 v[36:39], v[100:103], v[120:127], v1
v_smfmac_f32_16x16x64_bf16 v[40:43], v[104:107], v[120:127], v1
v_smfmac_f32_16x16x64_bf16 v[44:47], v[108:111], v[120:127], v1
ds_read_b128 v[120:123], v13 offset:4096
ds_read_b128 v[124:127], v13 offset:5120
s_waitcnt lgkmcnt(5)
v_smfmac_f32_16x16x64_bf16 v[16:19], v[80:83], a[128:135], v1
s_waitcnt lgkmcnt(4)
v_smfmac_f32_16x16x64_bf16 v[20:23], v[84:87], a[128:135], v1
s_waitcnt lgkmcnt(3)
v_smfmac_f32_16x16x64_bf16 v[24:27], v[88:91], a[128:135], v1
s_waitcnt lgkmcnt(2)
v_smfmac_f32_16x16x64_bf16 v[28:31], v[92:95], a[128:135], v1
v_smfmac_f32_16x16x64_bf16 v[32:35], v[80:83], a[136:143], v1
ds_read_b128 v[96:99], v11 offset:0
v_smfmac_f32_16x16x64_bf16 v[36:39], v[84:87], a[136:143], v1
ds_read_b128 v[100:103], v11 offset:8192
v_smfmac_f32_16x16x64_bf16 v[40:43], v[88:91], a[136:143], v1
ds_read_b128 v[104:107], v11 offset:16384
v_smfmac_f32_16x16x64_bf16 v[44:47], v[92:95], a[136:143], v1
ds_read_b128 v[108:111], v11 offset:24576
v_smfmac_f32_16x16x64_bf16 v[48:51], v[80:83], a[40:47], v1
v_smfmac_f32_16x16x64_bf16 v[52:55], v[84:87], a[40:47], v1
v_smfmac_f32_16x16x64_bf16 v[56:59], v[88:91], a[40:47], v1
v_smfmac_f32_16x16x64_bf16 v[60:63], v[92:95], a[40:47], v1
v_smfmac_f32_16x16x64_bf16 v[64:67], v[80:83], a[48:55], v1
ds_read_b128 v[80:83], v7 offset:1024
v_smfmac_f32_16x16x64_bf16 v[68:71], v[84:87], a[48:55], v1
ds_read_b128 v[84:87], v7 offset:9216
v_smfmac_f32_16x16x64_bf16 v[72:75], v[88:91], a[48:55], v1
ds_read_b128 v[88:91], v7 offset:17408
v_smfmac_f32_16x16x64_bf16 v[76:79], v[92:95], a[48:55], v1
ds_read_b128 v[92:95], v7 offset:25600
s_waitcnt lgkmcnt(7)
v_smfmac_f32_16x16x64_bf16 v[16:19], v[96:99], a[144:151], v1
s_waitcnt lgkmcnt(6)
v_smfmac_f32_16x16x64_bf16 v[20:23], v[100:103], a[144:151], v1
s_waitcnt lgkmcnt(5)
v_smfmac_f32_16x16x64_bf16 v[24:27], v[104:107], a[144:151], v1
s_waitcnt lgkmcnt(4)
v_smfmac_f32_16x16x64_bf16 v[28:31], v[108:111], a[144:151], v1
v_smfmac_f32_16x16x64_bf16 v[32:35], v[96:99], v[112:119], v1
v_smfmac_f32_16x16x64_bf16 v[36:39], v[100:103], v[112:119], v1
v_smfmac_f32_16x16x64_bf16 v[40:43], v[104:107], v[112:119], v1
v_smfmac_f32_16x16x64_bf16 v[44:47], v[108:111], v[112:119], v1
ds_read_b128 v[112:115], v13 offset:6144
ds_read_b128 v[116:119], v13 offset:7168
s_waitcnt lgkmcnt(5)
v_smfmac_f32_16x16x64_bf16 v[16:19], v[80:83], a[152:159], v1
s_waitcnt lgkmcnt(4)
v_smfmac_f32_16x16x64_bf16 v[20:23], v[84:87], a[152:159], v1
s_waitcnt lgkmcnt(3)
v_smfmac_f32_16x16x64_bf16 v[24:27], v[88:91], a[152:159], v1
s_waitcnt lgkmcnt(2)
v_smfmac_f32_16x16x64_bf16 v[28:31], v[92:95], a[152:159], v1
v_smfmac_f32_16x16x64_bf16 v[32:35], v[80:83], a[160:167], v1
ds_read_b128 v[96:99], v11 offset:1024
v_smfmac_f32_16x16x64_bf16 v[36:39], v[84:87], a[160:167], v1
ds_read_b128 v[100:103], v11 offset:9216
v_smfmac_f32_16x16x64_bf16 v[40:43], v[88:91], a[160:167], v1
ds_read_b128 v[104:107], v11 offset:17408
v_smfmac_f32_16x16x64_bf16 v[44:47], v[92:95], a[160:167], v1
ds_read_b128 v[108:111], v11 offset:25600
v_smfmac_f32_16x16x64_bf16 v[48:51], v[80:83], a[56:63], v1
v_smfmac_f32_16x16x64_bf16 v[52:55], v[84:87], a[56:63], v1
v_smfmac_f32_16x16x64_bf16 v[56:59], v[88:91], a[56:63], v1
v_smfmac_f32_16x16x64_bf16 v[60:63], v[92:95], a[56:63], v1
v_smfmac_f32_16x16x64_bf16 v[64:67], v[80:83], a[64:71], v1
ds_read_b128 v[80:83], v8 offset:0
v_smfmac_f32_16x16x64_bf16 v[68:71], v[84:87], a[64:71], v1
ds_read_b128 v[84:87], v8 offset:8192
v_smfmac_f32_16x16x64_bf16 v[72:75], v[88:91], a[64:71], v1
ds_read_b128 v[88:91], v8 offset:16384
v_smfmac_f32_16x16x64_bf16 v[76:79], v[92:95], a[64:71], v1
ds_read_b128 v[92:95], v8 offset:24576
s_waitcnt lgkmcnt(7)
v_smfmac_f32_16x16x64_bf16 v[16:19], v[96:99], a[168:175], v1
s_waitcnt lgkmcnt(6)
v_smfmac_f32_16x16x64_bf16 v[20:23], v[100:103], a[168:175], v1
s_waitcnt lgkmcnt(5)
v_smfmac_f32_16x16x64_bf16 v[24:27], v[104:107], a[168:175], v1
s_waitcnt lgkmcnt(4)
v_smfmac_f32_16x16x64_bf16 v[28:31], v[108:111], a[168:175], v1
v_smfmac_f32_16x16x64_bf16 v[32:35], v[96:99], v[120:127], v1
v_smfmac_f32_16x16x64_bf16 v[36:39], v[100:103], v[120:127], v1
v_smfmac_f32_16x16x64_bf16 v[40:43], v[104:107], v[120:127], v1
v_smfmac_f32_16x16x64_bf16 v[44:47], v[108:111], v[120:127], v1
s_waitcnt lgkmcnt(3)
v_smfmac_f32_16x16x64_bf16 v[16:19], v[80:83], a[8:15], v1
s_waitcnt lgkmcnt(2)
v_smfmac_f32_16x16x64_bf16 v[20:23], v[84:87], a[8:15], v1
s_waitcnt lgkmcnt(1)
v_smfmac_f32_16x16x64_bf16 v[24:27], v[88:91], a[8:15], v1
s_waitcnt lgkmcnt(0)
v_smfmac_f32_16x16x64_bf16 v[28:31], v[92:95], a[8:15], v1
v_smfmac_f32_16x16x64_bf16 v[32:35], v[80:83], a[16:23], v1
ds_read_b128 v[96:99], v12 offset:0
v_smfmac_f32_16x16x64_bf16 v[36:39], v[84:87], a[16:23], v1
ds_read_b128 v[100:103], v12 offset:8192
v_smfmac_f32_16x16x64_bf16 v[40:43], v[88:91], a[16:23], v1
ds_read_b128 v[104:107], v12 offset:16384
v_smfmac_f32_16x16x64_bf16 v[44:47], v[92:95], a[16:23], v1
ds_read_b128 v[108:111], v12 offset:24576
v_smfmac_f32_16x16x64_bf16 v[48:51], v[80:83], a[72:79], v1
v_smfmac_f32_16x16x64_bf16 v[52:55], v[84:87], a[72:79], v1
v_smfmac_f32_16x16x64_bf16 v[56:59], v[88:91], a[72:79], v1
v_smfmac_f32_16x16x64_bf16 v[60:63], v[92:95], a[72:79], v1
v_smfmac_f32_16x16x64_bf16 v[64:67], v[80:83], a[80:87], v1
ds_read_b128 v[80:83], v8 offset:1024
v_smfmac_f32_16x16x64_bf16 v[68:71], v[84:87], a[80:87], v1
ds_read_b128 v[84:87], v8 offset:9216
v_smfmac_f32_16x16x64_bf16 v[72:75], v[88:91], a[80:87], v1
ds_read_b128 v[88:91], v8 offset:17408
v_smfmac_f32_16x16x64_bf16 v[76:79], v[92:95], a[80:87], v1
ds_read_b128 v[92:95], v8 offset:25600
s_waitcnt lgkmcnt(7)
v_smfmac_f32_16x16x64_bf16 v[16:19], v[96:99], a[24:31], v1
s_waitcnt lgkmcnt(6)
v_smfmac_f32_16x16x64_bf16 v[20:23], v[100:103], a[24:31], v1
s_waitcnt lgkmcnt(5)
v_smfmac_f32_16x16x64_bf16 v[24:27], v[104:107], a[24:31], v1
s_waitcnt lgkmcnt(4)
v_smfmac_f32_16x16x64_bf16 v[28:31], v[108:111], a[24:31], v1
v_smfmac_f32_16x16x64_bf16 v[32:35], v[96:99], a[32:39], v1
v_smfmac_f32_16x16x64_bf16 v[36:39], v[100:103], a[32:39], v1
v_smfmac_f32_16x16x64_bf16 v[40:43], v[104:107], a[32:39], v1
v_smfmac_f32_16x16x64_bf16 v[44:47], v[108:111], a[32:39], v1
s_waitcnt lgkmcnt(3)
v_smfmac_f32_16x16x64_bf16 v[16:19], v[80:83], a[176:183], v1
s_waitcnt lgkmcnt(2)
v_smfmac_f32_16x16x64_bf16 v[20:23], v[84:87], a[176:183], v1
s_waitcnt lgkmcnt(1)
v_smfmac_f32_16x16x64_bf16 v[24:27], v[88:91], a[176:183], v1
s_waitcnt lgkmcnt(0)
v_smfmac_f32_16x16x64_bf16 v[28:31], v[92:95], a[176:183], v1
v_smfmac_f32_16x16x64_bf16 v[32:35], v[80:83], a[184:191], v1
ds_read_b128 v[96:99], v12 offset:1024
v_smfmac_f32_16x16x64_bf16 v[36:39], v[84:87], a[184:191], v1
ds_read_b128 v[100:103], v12 offset:9216
v_smfmac_f32_16x16x64_bf16 v[40:43], v[88:91], a[184:191], v1
ds_read_b128 v[104:107], v12 offset:17408
v_smfmac_f32_16x16x64_bf16 v[44:47], v[92:95], a[184:191], v1
ds_read_b128 v[108:111], v12 offset:25600
v_smfmac_f32_16x16x64_bf16 v[48:51], v[80:83], a[88:95], v1
v_smfmac_f32_16x16x64_bf16 v[52:55], v[84:87], a[88:95], v1
v_smfmac_f32_16x16x64_bf16 v[56:59], v[88:91], a[88:95], v1
v_smfmac_f32_16x16x64_bf16 v[60:63], v[92:95], a[88:95], v1
v_smfmac_f32_16x16x64_bf16 v[64:67], v[80:83], a[96:103], v1
v_smfmac_f32_16x16x64_bf16 v[68:71], v[84:87], a[96:103], v1
v_smfmac_f32_16x16x64_bf16 v[72:75], v[88:91], a[96:103], v1
v_smfmac_f32_16x16x64_bf16 v[76:79], v[92:95], a[96:103], v1
s_waitcnt lgkmcnt(3)
v_smfmac_f32_16x16x64_bf16 v[16:19], v[96:99], v[112:119], v1
s_waitcnt lgkmcnt(2)
v_smfmac_f32_16x16x64_bf16 v[20:23], v[100:103], v[112:119], v1
s_waitcnt lgkmcnt(1)
v_smfmac_f32_16x16x64_bf16 v[24:27], v[104:107], v[112:119], v1
s_waitcnt lgkmcnt(0)
v_smfmac_f32_16x16x64_bf16 v[28:31], v[108:111], v[112:119], v1
v_smfmac_f32_16x16x64_bf16 v[32:35], v[96:99], a[192:199], v1
v_smfmac_f32_16x16x64_bf16 v[36:39], v[100:103], a[192:199], v1
v_smfmac_f32_16x16x64_bf16 v[40:43], v[104:107], a[192:199], v1
v_smfmac_f32_16x16x64_bf16 v[44:47], v[108:111], a[192:199], v1
s_waitcnt vmcnt(0)
s_barrier
s_cmp_eq_u32 s68, -1
s_cbranch_scc1 Fw_F2_np
s_cmp_eq_u32 s10, 0
s_cbranch_scc0 Fw_F2_pf
s_lshl_b32 s22, s68, 2
s_add_u32 s20, s8, s22
s_addc_u32 s21, s9, 0
s_add_u32 s20, s20, 0x2000
s_addc_u32 s21, s21, 0
s_add_u32 s22, s13, 1
v_mov_b32 v126, 0
v_mov_b32 v127, s22
s_mov_b64 exec, 1
global_store_dword v126, v127, s[20:21] sc1
s_mov_b64 exec, -1
Fw_F2_pf:
Fw_F2_np:
s_add_u32 s17, s36, 7
s_cmp_lt_u32 s17, s67
s_cbranch_scc0 Fw_F2_nx
s_lshl_b32 s20, s17, 15
s_lshl_b32 s21, s13, 21
s_add_u32 s20, s20, s21
s_lshl_b32 s21, s10, 13
s_add_u32 s20, s20, s21
s_add_u32 s22, s8, s20
s_addc_u32 s23, s9, 0
s_add_u32 s22, s22, 0xe01000
s_addc_u32 s23, s23, 0
global_load_dwordx4 v[80:83], v4, s[22:23] offset:-4096 sc1
global_load_dwordx4 v[84:87], v4, s[22:23] offset:-3072 sc1
global_load_dwordx4 v[88:91], v4, s[22:23] offset:-2048 sc1
global_load_dwordx4 v[92:95], v4, s[22:23] offset:-1024 sc1
global_load_dwordx4 v[96:99], v4, s[22:23] offset:0 sc1
global_load_dwordx4 v[100:103], v4, s[22:23] offset:1024 sc1
global_load_dwordx4 v[104:107], v4, s[22:23] offset:2048 sc1
global_load_dwordx4 v[108:111], v4, s[22:23] offset:3072 sc1
Fw_F2_nx:
v_and_b32 v124, 15, v0
v_lshrrev_b32 v125, 4, v0
v_lshlrev_b32 v120, 2, v125
v_sub_u32 v120, v124, v120
v_cmp_gt_u32 vcc, 2, v125
s_nop 1
v_cndmask_b32 v121, 64, v120, vcc
v_add_u32 v120, 8, v120
v_cndmask_b32 v122, v120, 64, vcc
v_mov_b32 v126, 0x3f80
v_mov_b32 v127, 0x3f800000
v_cmp_eq_u32 vcc, 0, v121
s_nop 1
v_cndmask_b32 v112, 0, v126, vcc
v_cmp_eq_u32 vcc, 1, v121
s_nop 1
v_cndmask_b32 v112, v112, v127, vcc
v_cmp_eq_u32 vcc, 2, v121
s_nop 1
v_cndmask_b32 v113, 0, v126, vcc
v_cmp_eq_u32 vcc, 3, v121
s_nop 1
v_cndmask_b32 v113, v113, v127, vcc
v_mov_b32 v126, 0x3f80
v_mov_b32 v127, 0x3f800000
v_cmp_eq_u32 vcc, 8, v121
s_nop 1
v_cndmask_b32 v114, 0, v126, vcc
v_cmp_eq_u32 vcc, 9, v121
s_nop 1
v_cndmask_b32 v114, v114, v127, vcc
v_cmp_eq_u32 vcc, 10, v121
s_nop 1
v_cndmask_b32 v115, 0, v126, vcc
v_cmp_eq_u32 vcc, 11, v121
s_nop 1
v_cndmask_b32 v115, v115, v127, vcc
v_mov_b32 v126, 0x3f80
v_mov_b32 v127, 0x3f800000
v_cmp_eq_u32 vcc, 0, v122
s_nop 1
v_cndmask_b32 v116, 0, v126, vcc
v_cmp_eq_u32 vcc, 1, v122
s_nop 1
v_cndmask_b32 v116, v116, v127, vcc
v_cmp_eq_u32 vcc, 2, v122
s_nop 1
v_cndmask_b32 v117, 0, v126, vcc
v_cmp_eq_u32 vcc, 3, v122
s_nop 1
v_cndmask_b32 v117, v117, v127, vcc
v_mov_b32 v126, 0x3f80
v_mov_b32 v127, 0x3f800000
v_cmp_eq_u32 vcc, 8, v122
s_nop 1
v_cndmask_b32 v118, 0, v126, vcc
v_cmp_eq_u32 vcc, 9, v122
s_nop 1
v_cndmask_b32 v118, v118, v127, vcc
v_cmp_eq_u32 vcc, 10, v122
s_nop 1
v_cndmask_b32 v119, 0, v126, vcc
v_cmp_eq_u32 vcc, 11, v122
s_nop 1
v_cndmask_b32 v119, v119, v127, vcc
v_cvt_pk_bf16_f32 v120, v16, v17
v_cvt_pk_bf16_f32 v121, v18, v19
v_cvt_pk_bf16_f32 v122, v20, v21
v_cvt_pk_bf16_f32 v123, v22, v23
s_nop 1
v_mfma_f32_16x16x32_bf16 v[16:19], v[120:123], v[112:115], 0
v_mfma_f32_16x16x32_bf16 v[20:23], v[120:123], v[116:119], 0
v_cvt_pk_bf16_f32 v124, v32, v33
v_cvt_pk_bf16_f32 v125, v34, v35
v_cvt_pk_bf16_f32 v126, v36, v37
v_cvt_pk_bf16_f32 v127, v38, v39
s_nop 1
v_mfma_f32_16x16x32_bf16 v[32:35], v[124:127], v[112:115], 0
v_mfma_f32_16x16x32_bf16 v[36:39], v[124:127], v[116:119], 0
v_cvt_pk_bf16_f32 v120, v24, v25
v_cvt_pk_bf16_f32 v121, v26, v27
v_cvt_pk_bf16_f32 v122, v28, v29
v_cvt_pk_bf16_f32 v123, v30, v31
s_nop 1
v_mfma_f32_16x16x32_bf16 v[24:27], v[120:123], v[112:115], 0
v_mfma_f32_16x16x32_bf16 v[28:31], v[120:123], v[116:119], 0
v_cvt_pk_bf16_f32 v124, v40, v41
v_cvt_pk_bf16_f32 v125, v42, v43
v_cvt_pk_bf16_f32 v126, v44, v45
v_cvt_pk_bf16_f32 v127, v46, v47
s_nop 1
v_mfma_f32_16x16x32_bf16 v[40:43], v[124:127], v[112:115], 0
v_mfma_f32_16x16x32_bf16 v[44:47], v[124:127], v[116:119], 0
s_lshl_b32 s14, s36, 5
s_add_u32 s14, s14, s11
s_lshl_b32 s14, s14, 2
s_add_u32 s14, s14, s10
s_lshl_b32 s15, s14, 11
s_lshl_b32 s14, s14, 12
s_mul_i32 s16, s13, 0x2400000
s_add_u32 s14, s14, s16
s_add_u32 s24, s8, s14
s_addc_u32 s25, s9, 0
s_add_u32 s24, s24, 0x4000000
s_addc_u32 s25, s25, 0
s_add_u32 s26, s8, s15
s_addc_u32 s27, s9, 0
s_add_u32 s26, s26, 0x2800000
s_addc_u32 s27, s27, 0
v_permlane32_swap_b32 v48, v52
v_permlane32_swap_b32 v49, v53
v_permlane32_swap_b32 v50, v54
v_permlane32_swap_b32 v51, v55
v_pk_add_f32 v[48:49], v[48:49], v[52:53]
v_pk_add_f32 v[50:51], v[50:51], v[54:55]
v_cvt_pk_bf16_f32 v48, v48, v49
v_cvt_pk_bf16_f32 v49, v50, v51
v_permlane32_swap_b32 v56, v60
v_permlane32_swap_b32 v57, v61
v_permlane32_swap_b32 v58, v62
v_permlane32_swap_b32 v59, v63
v_pk_add_f32 v[56:57], v[56:57], v[60:61]
v_pk_add_f32 v[58:59], v[58:59], v[62:63]
v_cvt_pk_bf16_f32 v50, v56, v57
v_cvt_pk_bf16_f32 v51, v58, v59
global_store_dwordx4 v4, v[48:51], s[24:25] offset:2048 sc1
v_permlane32_swap_b32 v64, v68
v_permlane32_swap_b32 v65, v69
v_permlane32_swap_b32 v66, v70
v_permlane32_swap_b32 v67, v71
v_pk_add_f32 v[64:65], v[64:65], v[68:69]
v_pk_add_f32 v[66:67], v[66:67], v[70:71]
v_cvt_pk_bf16_f32 v64, v64, v65
v_cvt_pk_bf16_f32 v65, v66, v67
v_permlane32_swap_b32 v72, v76
v_permlane32_swap_b32 v73, v77
v_permlane32_swap_b32 v74, v78
v_permlane32_swap_b32 v75, v79
v_pk_add_f32 v[72:73], v[72:73], v[76:77]
v_pk_add_f32 v[74:75], v[74:75], v[78:79]
v_cvt_pk_bf16_f32 v66, v72, v73
v_cvt_pk_bf16_f32 v67, v74, v75
global_store_dwordx4 v4, v[64:67], s[24:25] offset:3072 sc1
v_cvt_pk_bf16_f32 v20, v20, v21
v_cvt_pk_bf16_f32 v21, v22, v23
v_cvt_pk_bf16_f32 v22, v36, v37
v_cvt_pk_bf16_f32 v23, v38, v39
global_store_dwordx4 v4, v[20:23], s[24:25] offset:0 sc1
v_cvt_pk_bf16_f32 v28, v28, v29
v_cvt_pk_bf16_f32 v29, v30, v31
v_cvt_pk_bf16_f32 v30, v44, v45
v_cvt_pk_bf16_f32 v31, v46, v47
global_store_dwordx4 v4, v[28:31], s[24:25] offset:1024 sc1
v_cvt_pk_bf16_f32 v16, v16, v17
v_cvt_pk_bf16_f32 v17, v18, v19
v_cvt_pk_bf16_f32 v18, v32, v33
v_cvt_pk_bf16_f32 v19, v34, v35
global_store_dwordx4 v4, v[16:19], s[26:27] offset:0
v_cvt_pk_bf16_f32 v24, v24, v25
v_cvt_pk_bf16_f32 v25, v26, v27
v_cvt_pk_bf16_f32 v26, v40, v41
v_cvt_pk_bf16_f32 v27, v42, v43
global_store_dwordx4 v4, v[24:27], s[26:27] offset:1024
s_lshl_b32 s68, s11, 6
s_add_u32 s68, s68, s36
s_add_u32 s36, s36, 7
s_cmp_lt_u32 s36, s67
s_cbranch_scc1 Fw_F2
s_waitcnt vmcnt(0)
s_barrier
s_cmp_eq_u32 s10, 0
s_cbranch_scc0 Fw_f
s_lshl_b32 s22, s68, 2
s_add_u32 s20, s8, s22
s_addc_u32 s21, s9, 0
s_add_u32 s20, s20, 0x2000
s_addc_u32 s21, s21, 0
s_add_u32 s22, s13, 1
v_mov_b32 v126, 0
v_mov_b32 v127, s22
s_mov_b64 exec, 1
global_store_dword v126, v127, s[20:21] sc1
s_mov_b64 exec, -1
Fw_f:
s_mov_b32 s68, -1
s_mov_b32 s66, s36
s_cmp_lt_u32 s36, 14
s_cselect_b32 s67, 28, 64
s_cmp_lt_u32 s36, 64
s_cbranch_scc1 Fw_F
s_sub_u32 s36, s12, 1
s_lshl_b32 s14, s36, 5
s_add_u32 s14, s14, s11
s_lshl_b32 s14, s14, 2
s_add_u32 s14, s14, s10
s_lshl_b32 s15, s14, 11
s_lshl_b32 s14, s14, 12
s_mul_i32 s16, s13, 0x2400000
s_add_u32 s14, s14, s16
s_add_u32 s24, s8, s14
s_addc_u32 s25, s9, 0
s_add_u32 s24, s24, 0x4000000
s_addc_u32 s25, s25, 0
s_add_u32 s26, s8, s15
s_addc_u32 s27, s9, 0
s_add_u32 s26, s26, 0x2800000
s_addc_u32 s27, s27, 0
global_load_dwordx4 v[96:99], v4, s[26:27] offset:0 sc1
global_load_dwordx4 v[100:103], v4, s[26:27] offset:1024 sc1
global_load_dwordx4 v[104:107], v4, s[24:25] offset:0 sc1
global_load_dwordx4 v[108:111], v4, s[24:25] offset:1024 sc1
global_load_dwordx4 v[112:115], v4, s[24:25] offset:2048 sc1
global_load_dwordx4 v[116:119], v4, s[24:25] offset:3072 sc1
Fw_B:
v_lshlrev_b32 v4, 4, v0
v_mov_b32 v122, 0x4444
v_mov_b32 v123, 0xeeee
s_mov_b32 s20, 0xff00ff00
s_mov_b32 s21, 0xff00ff00
v_cndmask_b32 v1, v122, v123, s[20:21]
s_lshl_b32 s20, s10, 15
s_add_u32 s20, s20, 32768
v_add_u32 v13, s20, v4
s_add_u32 s20, s10, 0
s_and_b32 s20, s20, 3
s_lshl_b32 s20, s20, 11
v_add_u32 v5, s20, v4
v_xor_b32 v9, 0x80, v5
s_add_u32 s20, s10, 1
s_and_b32 s20, s20, 3
s_lshl_b32 s20, s20, 11
v_add_u32 v6, s20, v4
v_xor_b32 v10, 0x80, v6
s_add_u32 s20, s10, 2
s_and_b32 s20, s20, 3
s_lshl_b32 s20, s20, 11
v_add_u32 v7, s20, v4
v_xor_b32 v11, 0x80, v7
s_add_u32 s20, s10, 3
s_and_b32 s20, s20, 3
s_lshl_b32 s20, s20, 11
v_add_u32 v8, s20, v4
v_xor_b32 v12, 0x80, v8
s_lshl_b32 s14, s13, 6
s_add_u32 s14, s14, s36
s_lshl_b32 s14, s14, 13
s_lshl_b32 s15, s10, 11
s_add_u32 s14, s14, s15
s_mov_b32 m0, s15
s_mov_b32 s16, 0xff81ff81
s_mov_b32 s19, 0
s_add_u32 s24, s8, s14
s_addc_u32 s25, s9, 0
s_add_u32 s24, s24, 0x100000
s_addc_u32 s25, s25, 0
global_load_lds_dwordx4 v4, s[24:25] sc1
global_load_lds_dwordx4 v4, s[24:25] offset:1024 sc1
v_and_b32 v120, 15, v0
v_lshrrev_b32 v121, 4, v0
v_lshlrev_b32 v124, 2, v121
v_sub_u32 v124, v120, v124
v_mov_b32 v122, 0x3f80
v_mov_b32 v123, 0x3f800000
v_cmp_eq_u32 vcc, 0, v124
s_nop 1
v_cndmask_b32 v2, 0, v122, vcc
v_cmp_eq_u32 vcc, 1, v124
s_nop 1
v_cndmask_b32 v2, v2, v123, vcc
v_cmp_eq_u32 vcc, 2, v124
s_nop 1
v_cndmask_b32 v3, 0, v122, vcc
v_cmp_eq_u32 vcc, 3, v124
s_nop 1
v_cndmask_b32 v3, v3, v123, vcc
v_cmp_le_i32 s[40:41], 0, v124
v_cmp_le_i32 s[42:43], 1, v124
v_cmp_le_i32 s[44:45], 2, v124
v_cmp_le_i32 s[46:47], 3, v124
s_mov_b32 s48, 0
s_mov_b32 s49, -1
v_and_b32 v122, 7, v0
v_lshlrev_b32 v122, 4, v122
v_lshl_add_u32 v122, v121, 7, v122
v_lshrrev_b32 v123, 3, v120
s_lshl_b32 s20, s10, 9
v_add_u32 v19, s20, v122
v_lshl_add_u32 v14, v123, 3, v19
v_xor_b32 v15, 8, v14
v_lshl_add_u32 v19, v123, 11, v19
s_add_u32 s20, s10, 1
s_and_b32 s20, s20, 3
s_lshl_b32 s20, s20, 9
v_add_u32 v16, s20, v122
s_add_u32 s20, s10, 2
s_and_b32 s20, s20, 3
s_lshl_b32 s20, s20, 9
v_add_u32 v17, s20, v122
s_add_u32 s20, s10, 3
s_and_b32 s20, s20, 3
s_lshl_b32 s20, s20, 9
v_add_u32 v18, s20, v122
v_mov_b64 v[64:65], 0
v_mov_b64 v[66:67], 0
v_mov_b64 v[68:69], 0
v_mov_b64 v[70:71], 0
v_mov_b64 v[72:73], 0
v_mov_b64 v[74:75], 0
v_mov_b64 v[76:77], 0
v_mov_b64 v[78:79], 0
s_waitcnt vmcnt(2)
v_mfma_f32_16x16x32_bf16 v[44:47], v[104:107], v[96:99], 0
v_mfma_f32_16x16x32_bf16 v[52:55], v[104:107], v[100:103], 0
v_mfma_f32_16x16x32_bf16 v[56:59], v[108:111], v[100:103], 0
ds_write_b128 v5, v[44:47] offset:8192
s_nop 2
ds_write_b128 v5, v[52:55] offset:16384
s_nop 2
ds_write_b128 v5, v[56:59] offset:17408
ds_read_b128 v[20:23], v13 offset:8192
ds_read_b128 v[24:27], v13 offset:9216
ds_read_b128 v[28:31], v13 offset:10240
ds_read_b128 v[32:35], v13 offset:11264
ds_read_b128 v[36:39], v13 offset:16384
ds_read_b128 v[40:43], v13 offset:17408
Fw_B_mp:
s_waitcnt vmcnt(0)
ds_read_b128 v[80:83], v5
ds_read_b128 v[84:87], v5 offset:1024
s_waitcnt lgkmcnt(0)
v_cmp_eq_u32 vcc, s16, v80
v_cmp_eq_u32 s[22:23], s16, v84
s_or_b64 vcc, vcc, s[22:23]
s_cbranch_scc0 Fw_B_mo
s_sleep 2
global_load_lds_dwordx4 v4, s[24:25] sc1
global_load_lds_dwordx4 v4, s[24:25] offset:1024 sc1
s_add_u32 s19, s19, 1
s_cmp_gt_u32 s19, 400000
s_cbranch_scc1 KB_fail
s_branch Fw_B_mp
Fw_B_mo:
s_barrier
ds_read_b128 v[88:91], v9 offset:0
ds_read_b128 v[92:95], v9 offset:1024
v_smfmac_f32_16x16x64_bf16 v[64:67], v[80:83], v[20:27], v1
ds_read_b128 v[20:23], v13 offset:18432
ds_read_b128 v[24:27], v13 offset:19456
v_smfmac_f32_16x16x64_bf16 v[68:71], v[80:83], v[28:35], v1
ds_read_b128 v[28:31], v13 offset:12288
ds_read_b128 v[32:35], v13 offset:13312
v_smfmac_f32_16x16x64_bf16 v[72:75], v[80:83], v[36:43], v1
ds_read_b128 v[36:39], v13 offset:14336
ds_read_b128 v[40:43], v13 offset:15360
s_waitcnt lgkmcnt(4)
v_smfmac_f32_16x16x64_bf16 v[76:79], v[80:83], v[20:27], v1
ds_read_b128 v[80:83], v6 offset:0
ds_read_b128 v[20:23], v13 offset:20480
ds_read_b128 v[24:27], v13 offset:21504
v_smfmac_f32_16x16x64_bf16 v[64:67], v[88:91], a[200:207], v1
v_smfmac_f32_16x16x64_bf16 v[68:71], v[88:91], a[208:215], v1
ds_read_b128 v[88:91], v10 offset:0
s_waitcnt lgkmcnt(6)
v_smfmac_f32_16x16x64_bf16 v[64:67], v[84:87], v[28:35], v1
ds_read_b128 v[28:31], v13 offset:22528
ds_read_b128 v[32:35], v13 offset:23552
s_waitcnt lgkmcnt(6)
v_smfmac_f32_16x16x64_bf16 v[68:71], v[84:87], v[36:43], v1
ds_read_b128 v[36:39], v13 offset:24576
ds_read_b128 v[40:43], v13 offset:25600
v_smfmac_f32_16x16x64_bf16 v[72:75], v[84:87], a[232:239], v1
v_smfmac_f32_16x16x64_bf16 v[76:79], v[84:87], a[240:247], v1
ds_read_b128 v[84:87], v6 offset:1024
v_smfmac_f32_16x16x64_bf16 v[64:67], v[92:95], a[216:223], v1
v_smfmac_f32_16x16x64_bf16 v[68:71], v[92:95], a[224:231], v1
ds_read_b128 v[92:95], v10 offset:1024
s_waitcnt lgkmcnt(9)
v_smfmac_f32_16x16x64_bf16 v[64:67], v[80:83], v[232:239], v1
v_smfmac_f32_16x16x64_bf16 v[68:71], v[80:83], v[240:247], v1
s_waitcnt lgkmcnt(7)
v_smfmac_f32_16x16x64_bf16 v[72:75], v[80:83], v[20:27], v1
ds_read_b128 v[20:23], v13 offset:0
ds_read_b128 v[24:27], v13 offset:1024
s_waitcnt lgkmcnt(6)
v_smfmac_f32_16x16x64_bf16 v[76:79], v[80:83], v[28:35], v1
ds_read_b128 v[80:83], v7 offset:0
ds_read_b128 v[28:31], v13 offset:2048
ds_read_b128 v[32:35], v13 offset:3072
v_smfmac_f32_16x16x64_bf16 v[64:67], v[88:91], v[248:255], v1
v_smfmac_f32_16x16x64_bf16 v[68:71], v[88:91], a[0:7], v1
ds_read_b128 v[88:91], v11 offset:0
s_waitcnt lgkmcnt(7)
v_smfmac_f32_16x16x64_bf16 v[64:67], v[84:87], a[104:111], v1
v_smfmac_f32_16x16x64_bf16 v[68:71], v[84:87], a[112:119], v1
v_smfmac_f32_16x16x64_bf16 v[72:75], v[84:87], v[36:43], v1
ds_read_b128 v[36:39], v13 offset:4096
ds_read_b128 v[40:43], v13 offset:5120
v_smfmac_f32_16x16x64_bf16 v[76:79], v[84:87], a[248:255], v1
ds_read_b128 v[84:87], v7 offset:1024
s_waitcnt lgkmcnt(9)
v_smfmac_f32_16x16x64_bf16 v[64:67], v[92:95], a[120:127], v1
s_waitcnt lgkmcnt(7)
v_smfmac_f32_16x16x64_bf16 v[68:71], v[92:95], v[20:27], v1
ds_read_b128 v[92:95], v11 offset:1024
ds_read_b128 v[20:23], v13 offset:6144
ds_read_b128 v[24:27], v13 offset:7168
s_waitcnt lgkmcnt(9)
v_smfmac_f32_16x16x64_bf16 v[64:67], v[80:83], a[128:135], v1
v_smfmac_f32_16x16x64_bf16 v[68:71], v[80:83], a[136:143], v1
v_smfmac_f32_16x16x64_bf16 v[72:75], v[80:83], a[40:47], v1
v_smfmac_f32_16x16x64_bf16 v[76:79], v[80:83], a[48:55], v1
ds_read_b128 v[80:83], v8 offset:0
s_waitcnt lgkmcnt(7)
v_smfmac_f32_16x16x64_bf16 v[64:67], v[88:91], a[144:151], v1
v_smfmac_f32_16x16x64_bf16 v[68:71], v[88:91], v[28:35], v1
ds_read_b128 v[88:91], v12 offset:0
ds_read_b128 v[28:31], v13 offset:26624
ds_read_b128 v[32:35], v13 offset:27648
s_waitcnt lgkmcnt(7)
v_smfmac_f32_16x16x64_bf16 v[64:67], v[84:87], a[152:159], v1
v_smfmac_f32_16x16x64_bf16 v[68:71], v[84:87], a[160:167], v1
v_smfmac_f32_16x16x64_bf16 v[72:75], v[84:87], a[56:63], v1
v_smfmac_f32_16x16x64_bf16 v[76:79], v[84:87], a[64:71], v1
ds_read_b128 v[84:87], v8 offset:1024
s_waitcnt lgkmcnt(7)
v_smfmac_f32_16x16x64_bf16 v[64:67], v[92:95], a[168:175], v1
v_smfmac_f32_16x16x64_bf16 v[68:71], v[92:95], v[36:43], v1
ds_read_b128 v[92:95], v12 offset:1024
ds_read_b128 v[36:39], v13 offset:28672
ds_read_b128 v[40:43], v13 offset:29696
s_waitcnt lgkmcnt(7)
v_smfmac_f32_16x16x64_bf16 v[64:67], v[80:83], a[8:15], v1
v_smfmac_f32_16x16x64_bf16 v[68:71], v[80:83], a[16:23], v1
v_smfmac_f32_16x16x64_bf16 v[72:75], v[80:83], a[72:79], v1
v_smfmac_f32_16x16x64_bf16 v[76:79], v[80:83], a[80:87], v1
s_waitcnt lgkmcnt(6)
v_smfmac_f32_16x16x64_bf16 v[64:67], v[88:91], a[24:31], v1
v_smfmac_f32_16x16x64_bf16 v[68:71], v[88:91], a[32:39], v1
s_waitcnt lgkmcnt(3)
v_smfmac_f32_16x16x64_bf16 v[64:67], v[84:87], a[176:183], v1
v_smfmac_f32_16x16x64_bf16 v[68:71], v[84:87], a[184:191], v1
v_smfmac_f32_16x16x64_bf16 v[72:75], v[84:87], a[88:95], v1
v_smfmac_f32_16x16x64_bf16 v[76:79], v[84:87], a[96:103], v1
s_waitcnt lgkmcnt(2)
v_smfmac_f32_16x16x64_bf16 v[64:67], v[92:95], v[20:27], v1
ds_read_b128 v[20:23], v13 offset:30720
ds_read_b128 v[24:27], v13 offset:31744
v_smfmac_f32_16x16x64_bf16 v[68:71], v[92:95], a[192:199], v1
s_nop 3
v_cvt_pk_bf16_f32 v64, v64, v65
v_cvt_pk_bf16_f32 v65, v66, v67
s_nop 1
v_mfma_f32_16x16x16_bf16 v[88:91], v[64:65], v[2:3], 0
v_cvt_pk_bf16_f32 v68, v68, v69
v_cvt_pk_bf16_f32 v69, v70, v71
s_nop 1
v_mfma_f32_16x16x16_bf16 v[92:95], v[68:69], v[2:3], 0
v_mov_b32 v122, v72
s_nop 1
v_permlane32_swap_b32 v122, v72
v_add_f32 v72, v72, v122
v_mov_b32 v122, v73
s_nop 1
v_permlane32_swap_b32 v122, v73
v_add_f32 v73, v73, v122
v_mov_b32 v122, v74
s_nop 1
v_permlane32_swap_b32 v122, v74
v_add_f32 v74, v74, v122
v_mov_b32 v122, v75
s_nop 1
v_permlane32_swap_b32 v122, v75
v_add_f32 v75, v75, v122
v_cvt_pk_bf16_f32 v104, v72, v73
v_cvt_pk_bf16_f32 v105, v74, v75
v_mov_b32 v122, v76
s_nop 1
v_permlane32_swap_b32 v122, v76
v_add_f32 v76, v76, v122
v_mov_b32 v122, v77
s_nop 1
v_permlane32_swap_b32 v122, v77
v_add_f32 v77, v77, v122
v_mov_b32 v122, v78
s_nop 1
v_permlane32_swap_b32 v122, v78
v_add_f32 v78, v78, v122
v_mov_b32 v122, v79
s_nop 1
v_permlane32_swap_b32 v122, v79
v_add_f32 v79, v79, v122
v_cvt_pk_bf16_f32 v106, v76, v77
v_cvt_pk_bf16_f32 v107, v78, v79
v_cvt_pk_bf16_f32 v80, v88, v89
v_cvt_pk_bf16_f32 v81, v90, v91
v_cvt_pk_bf16_f32 v82, v92, v93
v_cvt_pk_bf16_f32 v83, v94, v95
s_nop 1
v_mfma_f32_16x16x32_bf16 v[48:51], v[80:83], v[96:99], 0
v_mfma_f32_16x16x32_bf16 v[60:63], v[80:83], v[100:103], 0
v_mov_b32 v108, 0x3f803f80
v_mov_b32 v109, 0x3f803f80
v_mov_b32 v110, 0x3f803f80
v_mov_b32 v111, 0x3f803f80
ds_write_b128 v5, v[48:51] offset:9216
s_nop 2
ds_write_b128 v5, v[60:63] offset:24576
s_waitcnt lgkmcnt(0)
s_barrier
ds_read_b128 v[64:67], v6 offset:8192
ds_read_b128 v[68:71], v7 offset:8192
ds_read_b128 v[72:75], v8 offset:8192
ds_read_b128 v[76:79], v6 offset:9216
ds_read_b128 v[80:83], v7 offset:9216
ds_read_b128 v[84:87], v8 offset:9216
ds_read_b128 v[88:91], v6 offset:16384
ds_read_b128 v[92:95], v7 offset:16384
s_waitcnt lgkmcnt(7)
v_pk_add_f32 v[44:45], v[44:45], v[64:65]
v_pk_add_f32 v[46:47], v[46:47], v[66:67]
ds_read_b128 v[64:67], v8 offset:16384
s_waitcnt lgkmcnt(7)
v_pk_add_f32 v[44:45], v[44:45], v[68:69]
v_pk_add_f32 v[46:47], v[46:47], v[70:71]
ds_read_b128 v[68:71], v6 offset:17408
s_waitcnt lgkmcnt(7)
v_pk_add_f32 v[44:45], v[44:45], v[72:73]
v_pk_add_f32 v[46:47], v[46:47], v[74:75]
ds_read_b128 v[72:75], v7 offset:17408
s_waitcnt lgkmcnt(7)
v_pk_add_f32 v[48:49], v[48:49], v[76:77]
v_pk_add_f32 v[50:51], v[50:51], v[78:79]
ds_read_b128 v[76:79], v8 offset:17408
s_waitcnt lgkmcnt(7)
v_pk_add_f32 v[48:49], v[48:49], v[80:81]
v_pk_add_f32 v[50:51], v[50:51], v[82:83]
ds_read_b128 v[80:83], v6 offset:24576
s_waitcnt lgkmcnt(7)
v_pk_add_f32 v[48:49], v[48:49], v[84:85]
v_pk_add_f32 v[50:51], v[50:51], v[86:87]
ds_read_b128 v[84:87], v7 offset:24576
s_waitcnt lgkmcnt(7)
v_pk_add_f32 v[52:53], v[52:53], v[88:89]
v_pk_add_f32 v[54:55], v[54:55], v[90:91]
ds_read_b128 v[88:91], v8 offset:24576
s_waitcnt lgkmcnt(7)
v_pk_add_f32 v[52:53], v[52:53], v[92:93]
v_pk_add_f32 v[54:55], v[54:55], v[94:95]
s_waitcnt lgkmcnt(6)
v_pk_add_f32 v[52:53], v[52:53], v[64:65]
v_pk_add_f32 v[54:55], v[54:55], v[66:67]
s_waitcnt lgkmcnt(5)
v_pk_add_f32 v[56:57], v[56:57], v[68:69]
v_pk_add_f32 v[58:59], v[58:59], v[70:71]
s_waitcnt lgkmcnt(4)
v_pk_add_f32 v[56:57], v[56:57], v[72:73]
v_pk_add_f32 v[58:59], v[58:59], v[74:75]
s_waitcnt lgkmcnt(3)
v_pk_add_f32 v[56:57], v[56:57], v[76:77]
v_pk_add_f32 v[58:59], v[58:59], v[78:79]
s_waitcnt lgkmcnt(2)
v_pk_add_f32 v[60:61], v[60:61], v[80:81]
v_pk_add_f32 v[62:63], v[62:63], v[82:83]
s_waitcnt lgkmcnt(1)
v_pk_add_f32 v[60:61], v[60:61], v[84:85]
v_pk_add_f32 v[62:63], v[62:63], v[86:87]
s_waitcnt lgkmcnt(0)
v_pk_add_f32 v[60:61], v[60:61], v[88:89]
v_pk_add_f32 v[62:63], v[62:63], v[90:91]
v_mov_b32 v122, 0xff7fffff
s_mov_b32 s14, 0x3e0293ee
v_cndmask_b32 v44, v122, v44, s[40:41]
v_cndmask_b32 v56, v122, v56, s[40:41]
v_cndmask_b32 v48, v122, v48, s[48:49]
v_cndmask_b32 v60, v122, v60, s[48:49]
v_cndmask_b32 v45, v122, v45, s[42:43]
v_cndmask_b32 v57, v122, v57, s[42:43]
v_cndmask_b32 v49, v122, v49, s[48:49]
v_cndmask_b32 v61, v122, v61, s[48:49]
v_cndmask_b32 v46, v122, v46, s[44:45]
v_cndmask_b32 v58, v122, v58, s[44:45]
v_cndmask_b32 v50, v122, v50, s[48:49]
v_cndmask_b32 v62, v122, v62, s[48:49]
v_cndmask_b32 v47, v122, v47, s[46:47]
v_cndmask_b32 v59, v122, v59, s[46:47]
v_cndmask_b32 v51, v122, v51, s[48:49]
v_cndmask_b32 v63, v122, v63, s[48:49]
v_max_f32 v123, v44, v45
v_max3_f32 v123, v46, v47, v123
v_max3_f32 v123, v48, v49, v123
v_max3_f32 v123, v50, v51, v123
v_mov_b32 v125, v123
s_nop 1
v_permlane16_swap_b32 v123, v125
v_max_f32 v123, v123, v125
v_mov_b32 v125, v123
s_nop 1
v_permlane32_swap_b32 v123, v125
v_max_f32 v123, v123, v125
v_sub_f32 v44, v44, v123
v_mul_f32 v44, s14, v44
v_exp_f32 v44, v44
v_sub_f32 v45, v45, v123
v_mul_f32 v45, s14, v45
v_exp_f32 v45, v45
v_sub_f32 v46, v46, v123
v_mul_f32 v46, s14, v46
v_exp_f32 v46, v46
v_sub_f32 v47, v47, v123
v_mul_f32 v47, s14, v47
v_exp_f32 v47, v47
v_sub_f32 v48, v48, v123
v_mul_f32 v48, s14, v48
v_exp_f32 v48, v48
v_sub_f32 v49, v49, v123
v_mul_f32 v49, s14, v49
v_exp_f32 v49, v49
v_sub_f32 v50, v50, v123
v_mul_f32 v50, s14, v50
v_exp_f32 v50, v50
v_sub_f32 v51, v51, v123
v_mul_f32 v51, s14, v51
v_exp_f32 v51, v51
v_max_f32 v124, v52, v53
v_max3_f32 v124, v54, v55, v124
v_max3_f32 v124, v56, v57, v124
v_max3_f32 v124, v58, v59, v124
v_max3_f32 v124, v60, v61, v124
v_max3_f32 v124, v62, v63, v124
v_mov_b32 v125, v124
s_nop 1
v_permlane16_swap_b32 v124, v125
v_max_f32 v124, v124, v125
v_mov_b32 v125, v124
s_nop 1
v_permlane32_swap_b32 v124, v125
v_max_f32 v124, v124, v125
v_sub_f32 v52, v52, v124
v_mul_f32 v52, s14, v52
v_exp_f32 v52, v52
v_sub_f32 v53, v53, v124
v_mul_f32 v53, s14, v53
v_exp_f32 v53, v53
v_sub_f32 v54, v54, v124
v_mul_f32 v54, s14, v54
v_exp_f32 v54, v54
v_sub_f32 v55, v55, v124
v_mul_f32 v55, s14, v55
v_exp_f32 v55, v55
v_sub_f32 v56, v56, v124
v_mul_f32 v56, s14, v56
v_exp_f32 v56, v56
v_sub_f32 v57, v57, v124
v_mul_f32 v57, s14, v57
v_exp_f32 v57, v57
v_sub_f32 v58, v58, v124
v_mul_f32 v58, s14, v58
v_exp_f32 v58, v58
v_sub_f32 v59, v59, v124
v_mul_f32 v59, s14, v59
v_exp_f32 v59, v59
v_sub_f32 v60, v60, v124
v_mul_f32 v60, s14, v60
v_exp_f32 v60, v60
v_sub_f32 v61, v61, v124
v_mul_f32 v61, s14, v61
v_exp_f32 v61, v61
v_sub_f32 v62, v62, v124
v_mul_f32 v62, s14, v62
v_exp_f32 v62, v62
v_sub_f32 v63, v63, v124
v_mul_f32 v63, s14, v63
v_exp_f32 v63, v63
v_cvt_pk_bf16_f32 v64, v44, v45
v_cvt_pk_bf16_f32 v65, v46, v47
v_mov_b64 v[66:67], 0
v_cvt_pk_bf16_f32 v68, v52, v53
v_cvt_pk_bf16_f32 v69, v54, v55
v_cvt_pk_bf16_f32 v70, v56, v57
v_cvt_pk_bf16_f32 v71, v58, v59
v_cvt_pk_bf16_f32 v72, v48, v49
v_cvt_pk_bf16_f32 v73, v50, v51
v_cvt_pk_bf16_f32 v74, v60, v61
v_cvt_pk_bf16_f32 v75, v62, v63
v_mfma_f32_16x16x32_bf16 v[76:79], v[108:111], v[64:67], 0
v_mfma_f32_16x16x32_bf16 v[44:47], v[112:115], v[64:67], 0
v_mfma_f32_16x16x32_bf16 v[48:51], v[116:119], v[64:67], 0
v_mfma_f32_16x16x16_bf16 v[76:79], v[108:109], v[72:73], v[76:79]
v_mfma_f32_16x16x16_bf16 v[44:47], v[104:105], v[72:73], v[44:47]
v_mfma_f32_16x16x16_bf16 v[48:51], v[106:107], v[72:73], v[48:51]
v_mfma_f32_16x16x32_bf16 v[80:83], v[108:111], v[68:71], 0
v_mfma_f32_16x16x32_bf16 v[52:55], v[112:115], v[68:71], 0
v_mfma_f32_16x16x32_bf16 v[56:59], v[116:119], v[68:71], 0
v_mfma_f32_16x16x16_bf16 v[80:83], v[108:109], v[74:75], v[80:83]
v_mfma_f32_16x16x16_bf16 v[52:55], v[104:105], v[74:75], v[52:55]
v_mfma_f32_16x16x16_bf16 v[56:59], v[106:107], v[74:75], v[56:59]
v_rcp_f32 v76, v76
s_nop 0
v_pk_mul_f32 v[44:45], v[44:45], v[76:77] op_sel_hi:[1,0]
v_pk_mul_f32 v[46:47], v[46:47], v[76:77] op_sel_hi:[1,0]
v_pk_mul_f32 v[48:49], v[48:49], v[76:77] op_sel_hi:[1,0]
v_pk_mul_f32 v[50:51], v[50:51], v[76:77] op_sel_hi:[1,0]
v_cvt_pk_bf16_f32 v44, v44, v45
v_cvt_pk_bf16_f32 v45, v46, v47
v_cvt_pk_bf16_f32 v46, v48, v49
v_cvt_pk_bf16_f32 v47, v50, v51
ds_write_b128 v19, v[44:47] offset:0
v_rcp_f32 v80, v80
s_nop 0
v_pk_mul_f32 v[52:53], v[52:53], v[80:81] op_sel_hi:[1,0]
v_pk_mul_f32 v[54:55], v[54:55], v[80:81] op_sel_hi:[1,0]
v_pk_mul_f32 v[56:57], v[56:57], v[80:81] op_sel_hi:[1,0]
v_pk_mul_f32 v[58:59], v[58:59], v[80:81] op_sel_hi:[1,0]
v_cvt_pk_bf16_f32 v52, v52, v53
v_cvt_pk_bf16_f32 v53, v54, v55
v_cvt_pk_bf16_f32 v54, v56, v57
v_cvt_pk_bf16_f32 v55, v58, v59
ds_write_b128 v19, v[52:55] offset:4096
v_lshrrev_b32 v122, 5, v0
v_lshlrev_b32 v122, 3, v122
v_bfe_u32 v123, v0, 2, 2
v_lshl_add_u32 v122, v123, 1, v122
v_bfe_u32 v123, v0, 4, 1
v_add_u32 v122, v122, v123
v_lshlrev_b32 v122, 11, v122
v_and_b32 v123, 3, v0
v_lshl_add_u32 v120, v123, 4, v122
s_lshl_b32 s14, s12, 21
s_add_u32 s14, s14, s37
s_lshl_b32 s15, s10, 15
s_lshl_b32 s16, s11, 6
s_add_u32 s15, s15, s16
s_add_u32 s28, s8, s14
s_addc_u32 s29, s9, 0
s_add_u32 s28, s28, 0x1400000
s_addc_u32 s29, s29, 0
s_add_u32 s24, s28, s15
s_addc_u32 s25, s29, 0
s_waitcnt lgkmcnt(0)
s_barrier
ds_read_b64 v[44:45], v14 offset:0
ds_read_b64 v[46:47], v15 offset:0
ds_read_b128 v[48:51], v16 offset:0
ds_read_b128 v[52:55], v17 offset:0
ds_read_b128 v[56:59], v18 offset:0
v_mov_b64 v[60:61], 0
v_mov_b64 v[62:63], 0
v_mov_b64 v[64:65], 0
v_mov_b64 v[66:67], 0
v_mov_b64 v[68:69], 0
v_mov_b64 v[70:71], 0
v_mov_b64 v[72:73], 0
v_mov_b64 v[74:75], 0
ds_read_b64 v[96:97], v14 offset:2048
ds_read_b64 v[98:99], v15 offset:2048
ds_read_b128 v[100:103], v16 offset:2048
ds_read_b128 v[104:107], v17 offset:2048
ds_read_b128 v[108:111], v18 offset:2048
s_waitcnt lgkmcnt(8)
v_smfmac_f32_16x16x64_bf16 v[60:63], v[44:47], v[28:35], v1
v_smfmac_f32_16x16x64_bf16 v[64:67], v[44:47], v[36:43], v1
v_smfmac_f32_16x16x64_bf16 v[68:71], v[44:47], v[20:27], v1
v_smfmac_f32_16x16x64_bf16 v[72:75], v[44:47], v[224:231], v1
s_waitcnt lgkmcnt(7)
v_smfmac_f32_16x16x64_bf16 v[60:63], v[48:51], v[128:135], v1
v_smfmac_f32_16x16x64_bf16 v[64:67], v[48:51], v[136:143], v1
v_smfmac_f32_16x16x64_bf16 v[68:71], v[48:51], v[144:151], v1
v_smfmac_f32_16x16x64_bf16 v[72:75], v[48:51], v[152:159], v1
s_waitcnt lgkmcnt(6)
v_smfmac_f32_16x16x64_bf16 v[60:63], v[52:55], v[160:167], v1
v_smfmac_f32_16x16x64_bf16 v[64:67], v[52:55], v[168:175], v1
v_smfmac_f32_16x16x64_bf16 v[68:71], v[52:55], v[176:183], v1
v_smfmac_f32_16x16x64_bf16 v[72:75], v[52:55], v[184:191], v1
s_waitcnt lgkmcnt(5)
v_smfmac_f32_16x16x64_bf16 v[60:63], v[56:59], v[192:199], v1
v_smfmac_f32_16x16x64_bf16 v[64:67], v[56:59], v[200:207], v1
v_smfmac_f32_16x16x64_bf16 v[68:71], v[56:59], v[208:215], v1
v_smfmac_f32_16x16x64_bf16 v[72:75], v[56:59], v[216:223], v1
v_mov_b64 v[76:77], 0
v_mov_b64 v[78:79], 0
v_mov_b64 v[80:81], 0
v_mov_b64 v[82:83], 0
v_mov_b64 v[84:85], 0
v_mov_b64 v[86:87], 0
v_mov_b64 v[88:89], 0
v_mov_b64 v[90:91], 0
ds_read_b64 v[44:45], v14 offset:4096
ds_read_b64 v[46:47], v15 offset:4096
ds_read_b128 v[48:51], v16 offset:4096
ds_read_b128 v[52:55], v17 offset:4096
ds_read_b128 v[56:59], v18 offset:4096
s_waitcnt lgkmcnt(8)
v_smfmac_f32_16x16x64_bf16 v[76:79], v[96:99], v[28:35], v1
v_smfmac_f32_16x16x64_bf16 v[80:83], v[96:99], v[36:43], v1
v_smfmac_f32_16x16x64_bf16 v[84:87], v[96:99], v[20:27], v1
v_smfmac_f32_16x16x64_bf16 v[88:91], v[96:99], v[224:231], v1
v_cvt_pk_bf16_f32 v60, v60, v61
v_cvt_pk_bf16_f32 v61, v62, v63
v_cvt_pk_bf16_f32 v62, v64, v65
v_cvt_pk_bf16_f32 v63, v66, v67
global_store_dwordx4 v120, v[60:63], s[24:25]
s_add_u32 s24, s24, 0x20000
s_addc_u32 s25, s25, 0
v_cvt_pk_bf16_f32 v68, v68, v69
v_cvt_pk_bf16_f32 v69, v70, v71
v_cvt_pk_bf16_f32 v70, v72, v73
v_cvt_pk_bf16_f32 v71, v74, v75
global_store_dwordx4 v120, v[68:71], s[24:25]
s_add_u32 s24, s24, 0x20000
s_addc_u32 s25, s25, 0
s_waitcnt lgkmcnt(7)
v_smfmac_f32_16x16x64_bf16 v[76:79], v[100:103], v[128:135], v1
v_smfmac_f32_16x16x64_bf16 v[80:83], v[100:103], v[136:143], v1
v_smfmac_f32_16x16x64_bf16 v[84:87], v[100:103], v[144:151], v1
v_smfmac_f32_16x16x64_bf16 v[88:91], v[100:103], v[152:159], v1
s_waitcnt lgkmcnt(6)
v_smfmac_f32_16x16x64_bf16 v[76:79], v[104:107], v[160:167], v1
v_smfmac_f32_16x16x64_bf16 v[80:83], v[104:107], v[168:175], v1
v_smfmac_f32_16x16x64_bf16 v[84:87], v[104:107], v[176:183], v1
v_smfmac_f32_16x16x64_bf16 v[88:91], v[104:107], v[184:191], v1
s_waitcnt lgkmcnt(5)
v_smfmac_f32_16x16x64_bf16 v[76:79], v[108:111], v[192:199], v1
v_smfmac_f32_16x16x64_bf16 v[80:83], v[108:111], v[200:207], v1
v_smfmac_f32_16x16x64_bf16 v[84:87], v[108:111], v[208:215], v1
v_smfmac_f32_16x16x64_bf16 v[88:91], v[108:111], v[216:223], v1
v_mov_b64 v[60:61], 0
v_mov_b64 v[62:63], 0
v_mov_b64 v[64:65], 0
v_mov_b64 v[66:67], 0
v_mov_b64 v[68:69], 0
v_mov_b64 v[70:71], 0
v_mov_b64 v[72:73], 0
v_mov_b64 v[74:75], 0
ds_read_b64 v[96:97], v14 offset:6144
ds_read_b64 v[98:99], v15 offset:6144
ds_read_b128 v[100:103], v16 offset:6144
ds_read_b128 v[104:107], v17 offset:6144
ds_read_b128 v[108:111], v18 offset:6144
s_waitcnt lgkmcnt(8)
v_smfmac_f32_16x16x64_bf16 v[60:63], v[44:47], v[28:35], v1
v_smfmac_f32_16x16x64_bf16 v[64:67], v[44:47], v[36:43], v1
v_smfmac_f32_16x16x64_bf16 v[68:71], v[44:47], v[20:27], v1
v_smfmac_f32_16x16x64_bf16 v[72:75], v[44:47], v[224:231], v1
v_cvt_pk_bf16_f32 v76, v76, v77
v_cvt_pk_bf16_f32 v77, v78, v79
v_cvt_pk_bf16_f32 v78, v80, v81
v_cvt_pk_bf16_f32 v79, v82, v83
global_store_dwordx4 v120, v[76:79], s[24:25]
s_add_u32 s24, s24, 0x20000
s_addc_u32 s25, s25, 0
v_cvt_pk_bf16_f32 v84, v84, v85
v_cvt_pk_bf16_f32 v85, v86, v87
v_cvt_pk_bf16_f32 v86, v88, v89
v_cvt_pk_bf16_f32 v87, v90, v91
global_store_dwordx4 v120, v[84:87], s[24:25]
s_add_u32 s24, s24, 0x20000
s_addc_u32 s25, s25, 0
s_waitcnt lgkmcnt(7)
v_smfmac_f32_16x16x64_bf16 v[60:63], v[48:51], v[128:135], v1
v_smfmac_f32_16x16x64_bf16 v[64:67], v[48:51], v[136:143], v1
v_smfmac_f32_16x16x64_bf16 v[68:71], v[48:51], v[144:151], v1
v_smfmac_f32_16x16x64_bf16 v[72:75], v[48:51], v[152:159], v1
s_waitcnt lgkmcnt(6)
v_smfmac_f32_16x16x64_bf16 v[60:63], v[52:55], v[160:167], v1
v_smfmac_f32_16x16x64_bf16 v[64:67], v[52:55], v[168:175], v1
v_smfmac_f32_16x16x64_bf16 v[68:71], v[52:55], v[176:183], v1
v_smfmac_f32_16x16x64_bf16 v[72:75], v[52:55], v[184:191], v1
s_waitcnt lgkmcnt(5)
v_smfmac_f32_16x16x64_bf16 v[60:63], v[56:59], v[192:199], v1
v_smfmac_f32_16x16x64_bf16 v[64:67], v[56:59], v[200:207], v1
v_smfmac_f32_16x16x64_bf16 v[68:71], v[56:59], v[208:215], v1
v_smfmac_f32_16x16x64_bf16 v[72:75], v[56:59], v[216:223], v1
v_mov_b64 v[76:77], 0
v_mov_b64 v[78:79], 0
v_mov_b64 v[80:81], 0
v_mov_b64 v[82:83], 0
v_mov_b64 v[84:85], 0
v_mov_b64 v[86:87], 0
v_mov_b64 v[88:89], 0
v_mov_b64 v[90:91], 0
s_waitcnt lgkmcnt(3)
v_smfmac_f32_16x16x64_bf16 v[76:79], v[96:99], v[28:35], v1
v_smfmac_f32_16x16x64_bf16 v[80:83], v[96:99], v[36:43], v1
v_smfmac_f32_16x16x64_bf16 v[84:87], v[96:99], v[20:27], v1
v_smfmac_f32_16x16x64_bf16 v[88:91], v[96:99], v[224:231], v1
v_cvt_pk_bf16_f32 v60, v60, v61
v_cvt_pk_bf16_f32 v61, v62, v63
v_cvt_pk_bf16_f32 v62, v64, v65
v_cvt_pk_bf16_f32 v63, v66, v67
global_store_dwordx4 v120, v[60:63], s[24:25]
s_add_u32 s24, s24, 0x20000
s_addc_u32 s25, s25, 0
v_cvt_pk_bf16_f32 v68, v68, v69
v_cvt_pk_bf16_f32 v69, v70, v71
v_cvt_pk_bf16_f32 v70, v72, v73
v_cvt_pk_bf16_f32 v71, v74, v75
global_store_dwordx4 v120, v[68:71], s[24:25]
s_add_u32 s24, s24, 0x20000
s_addc_u32 s25, s25, 0
s_waitcnt lgkmcnt(2)
v_smfmac_f32_16x16x64_bf16 v[76:79], v[100:103], v[128:135], v1
v_smfmac_f32_16x16x64_bf16 v[80:83], v[100:103], v[136:143], v1
v_smfmac_f32_16x16x64_bf16 v[84:87], v[100:103], v[144:151], v1
v_smfmac_f32_16x16x64_bf16 v[88:91], v[100:103], v[152:159], v1
s_waitcnt lgkmcnt(1)
v_smfmac_f32_16x16x64_bf16 v[76:79], v[104:107], v[160:167], v1
v_smfmac_f32_16x16x64_bf16 v[80:83], v[104:107], v[168:175], v1
v_smfmac_f32_16x16x64_bf16 v[84:87], v[104:107], v[176:183], v1
v_smfmac_f32_16x16x64_bf16 v[88:91], v[104:107], v[184:191], v1
s_waitcnt lgkmcnt(0)
v_smfmac_f32_16x16x64_bf16 v[76:79], v[108:111], v[192:199], v1
v_smfmac_f32_16x16x64_bf16 v[80:83], v[108:111], v[200:207], v1
v_smfmac_f32_16x16x64_bf16 v[84:87], v[108:111], v[208:215], v1
v_smfmac_f32_16x16x64_bf16 v[88:91], v[108:111], v[216:223], v1
v_cvt_pk_bf16_f32 v76, v76, v77
v_cvt_pk_bf16_f32 v77, v78, v79
v_cvt_pk_bf16_f32 v78, v80, v81
v_cvt_pk_bf16_f32 v79, v82, v83
global_store_dwordx4 v120, v[76:79], s[24:25]
s_add_u32 s24, s24, 0x20000
s_addc_u32 s25, s25, 0
v_cvt_pk_bf16_f32 v84, v84, v85
v_cvt_pk_bf16_f32 v85, v86, v87
v_cvt_pk_bf16_f32 v86, v88, v89
v_cvt_pk_bf16_f32 v87, v90, v91
global_store_dwordx4 v120, v[84:87], s[24:25]
s_add_u32 s24, s24, 0x20000
s_addc_u32 s25, s25, 0
v_and_b32 v26, 15, v0
v_lshrrev_b32 v27, 4, v0
v_and_b32 v122, 3, v26
v_lshlrev_b32 v122, 2, v122
v_lshrrev_b32 v123, 2, v26
v_add_u32 v124, v122, v123
v_mov_b32 v122, 0x3f80
v_mov_b32 v123, 0x3f800000
v_cmp_eq_u32 vcc, 0, v124
s_nop 1
v_cndmask_b32 v20, 0, v122, vcc
v_cmp_eq_u32 vcc, 1, v124
s_nop 1
v_cndmask_b32 v20, v20, v123, vcc
v_cmp_eq_u32 vcc, 2, v124
s_nop 1
v_cndmask_b32 v21, 0, v122, vcc
v_cmp_eq_u32 vcc, 3, v124
s_nop 1
v_cndmask_b32 v21, v21, v123, vcc
v_cmp_eq_u32 vcc, 4, v124
s_nop 1
v_cndmask_b32 v22, 0, v122, vcc
v_cmp_eq_u32 vcc, 5, v124
s_nop 1
v_cndmask_b32 v22, v22, v123, vcc
v_cmp_eq_u32 vcc, 6, v124
s_nop 1
v_cndmask_b32 v23, 0, v122, vcc
v_cmp_eq_u32 vcc, 7, v124
s_nop 1
v_cndmask_b32 v23, v23, v123, vcc
s_and_b32 s17, s11, 3
s_lshl_b32 s15, s17, 16
s_lshl_b32 s16, s10, 14
s_add_u32 s15, s15, s16
s_lshr_b32 s16, s11, 3
s_lshl_b32 s16, s16, 18
s_add_u32 s15, s15, s16
s_bfe_u32 s16, s11, 0x10002
s_lshl_b32 s16, s16, 11
s_add_u32 s15, s15, s16
s_xor_b32 s37, s37, 0x100000
s_add_u32 s28, s28, s15
s_addc_u32 s29, s29, 0
v_and_b32 v122, 3, v26
v_lshlrev_b32 v122, 2, v122
v_lshl_add_u32 v122, v27, 4, v122
v_lshrrev_b32 v123, 2, v26
v_lshl_add_u32 v25, v123, 7, v122
s_lshl_b32 s14, s36, 15
s_lshr_b32 s15, s15, 5
s_add_u32 s15, s15, s14
s_lshl_b32 s16, s13, 21
s_add_u32 s15, s15, s16
s_add_u32 s24, s8, s15
s_addc_u32 s25, s9, 0
s_add_u32 s24, s24, 0xe00000
s_addc_u32 s25, s25, 0
global_load_dword v25, v25, s[24:25] sc1
s_cmp_eq_u32 s13, 0
s_cbranch_scc0 Fw_B_o1
v_lshl_add_u32 v24, v123, 8, v122
s_lshl_b32 s15, s17, 13
s_lshr_b32 s16, s11, 4
s_lshl_b32 s16, s16, 12
s_add_u32 s15, s15, s16
s_lshl_b32 s16, s10, 10
s_add_u32 s15, s15, s16
s_bfe_u32 s16, s11, 0x20002
s_lshl_b32 s16, s16, 6
s_add_u32 s15, s15, s16
s_add_u32 s15, s15, s14
s_add_u32 s26, s8, s15
s_addc_u32 s27, s9, 0
s_add_u32 s26, s26, 0x1200000
s_addc_u32 s27, s27, 0
s_branch Fw_B_o2
Fw_B_o1:
v_lshlrev_b32 v24, 10, v27
v_lshl_add_u32 v24, v26, 2, v24
s_lshr_b32 s15, s11, 2
s_lshl_b32 s15, s15, 12
s_lshl_b32 s16, s17, 8
s_add_u32 s15, s15, s16
s_lshl_b32 s16, s10, 6
s_add_u32 s15, s15, s16
s_add_u32 s15, s15, s14
s_add_u32 s26, s6, s15
s_addc_u32 s27, s7, 0
Fw_B_o2:
s_add_u32 s18, s18, 1
s_waitcnt vmcnt(0)
s_barrier
s_cmp_eq_u32 s10, 0
s_cbranch_scc0 Fw_B_g2_d
s_lshl_b32 s22, s12, 8
s_add_u32 s20, s8, s22
s_addc_u32 s21, s9, 0
s_add_u32 s20, s20, 0x1000
s_addc_u32 s21, s21, 0
v_mov_b32 v127, s18
v_and_b32 v126, 31, v0
v_lshlrev_b32 v126, 2, v126
v_cmp_eq_u32 vcc, s11, v0
s_mov_b64 exec, vcc
global_store_dword v126, v127, s[20:21]
s_mov_b64 exec, -1
s_mov_b32 s19, 0
Fw_B_g2_p:
global_load_dword v127, v126, s[20:21] sc1
s_add_u32 s19, s19, 1
s_cmp_gt_u32 s19, 400000
s_cbranch_scc1 KB_fail
s_waitcnt vmcnt(0)
v_cmp_gt_u32 vcc, s18, v127
s_cbranch_vccnz Fw_B_g2_p
Fw_B_g2_d:
s_barrier
global_load_dwordx4 v[28:31], v4, s[28:29] offset:0 sc1
global_load_dwordx4 v[32:35], v4, s[28:29] offset:1024 sc1
s_add_u32 s28, s28, 0x1000
s_addc_u32 s29, s29, 0
global_load_dwordx4 v[36:39], v4, s[28:29] offset:0 sc1
global_load_dwordx4 v[40:43], v4, s[28:29] offset:1024 sc1
s_add_u32 s28, s28, 0x1000
s_addc_u32 s29, s29, 0
global_load_dwordx4 v[44:47], v4, s[28:29] offset:0 sc1
global_load_dwordx4 v[48:51], v4, s[28:29] offset:1024 sc1
s_add_u32 s28, s28, 0x1000
s_addc_u32 s29, s29, 0
global_load_dwordx4 v[52:55], v4, s[28:29] offset:0 sc1
global_load_dwordx4 v[56:59], v4, s[28:29] offset:1024 sc1
s_add_u32 s17, s36, 7
s_min_u32 s17, s17, 63
s_cmp_lt_u32 s36, 57
s_cselect_b64 exec, -1, 0
s_lshl_b32 s14, s17, 5
s_add_u32 s14, s14, s11
s_lshl_b32 s14, s14, 2
s_add_u32 s14, s14, s10
s_lshl_b32 s15, s14, 11
s_lshl_b32 s14, s14, 12
s_mul_i32 s16, s13, 0x2400000
s_add_u32 s14, s14, s16
s_add_u32 s28, s8, s14
s_addc_u32 s29, s9, 0
s_add_u32 s28, s28, 0x4000000
s_addc_u32 s29, s29, 0
s_add_u32 s30, s8, s15
s_addc_u32 s31, s9, 0
s_add_u32 s30, s30, 0x2800000
s_addc_u32 s31, s31, 0
global_load_dwordx4 v[96:99], v4, s[30:31] offset:0 sc1
global_load_dwordx4 v[100:103], v4, s[30:31] offset:1024 sc1
global_load_dwordx4 v[104:107], v4, s[28:29] offset:0 sc1
global_load_dwordx4 v[108:111], v4, s[28:29] offset:1024 sc1
global_load_dwordx4 v[112:115], v4, s[28:29] offset:2048 sc1
global_load_dwordx4 v[116:119], v4, s[28:29] offset:3072 sc1
s_mov_b64 exec, -1
s_waitcnt vmcnt(13)
v_mfma_f32_16x16x32_bf16 v[64:67], v[20:23], v[28:31], 0
s_waitcnt vmcnt(12)
v_mfma_f32_16x16x32_bf16 v[64:67], v[20:23], v[32:35], v[64:67]
s_waitcnt vmcnt(11)
v_mfma_f32_16x16x32_bf16 v[68:71], v[20:23], v[36:39], 0
s_waitcnt vmcnt(10)
v_mfma_f32_16x16x32_bf16 v[68:71], v[20:23], v[40:43], v[68:71]
s_waitcnt vmcnt(9)
v_mfma_f32_16x16x32_bf16 v[72:75], v[20:23], v[44:47], 0
s_waitcnt vmcnt(8)
v_mfma_f32_16x16x32_bf16 v[72:75], v[20:23], v[48:51], v[72:75]
s_waitcnt vmcnt(7)
v_mfma_f32_16x16x32_bf16 v[76:79], v[20:23], v[52:55], 0
s_waitcnt vmcnt(6)
v_mfma_f32_16x16x32_bf16 v[76:79], v[20:23], v[56:59], v[76:79]
v_add_f32_dpp v64, v64, v64 row_ror:8 row_mask:0xf bank_mask:0xf
v_add_f32_dpp v65, v65, v65 row_ror:8 row_mask:0xf bank_mask:0xf
v_add_f32_dpp v68, v68, v68 row_ror:8 row_mask:0xf bank_mask:0xf
v_add_f32_dpp v69, v69, v69 row_ror:8 row_mask:0xf bank_mask:0xf
v_add_f32_dpp v72, v72, v72 row_ror:8 row_mask:0xf bank_mask:0xf
v_add_f32_dpp v73, v73, v73 row_ror:8 row_mask:0xf bank_mask:0xf
s_nop 1
v_add_f32_dpp v76, v76, v76 row_ror:8 row_mask:0xf bank_mask:0xf
v_add_f32_dpp v77, v77, v77 row_ror:8 row_mask:0xf bank_mask:0xf
v_add_f32_dpp v80, v64, v64 row_ror:4 row_mask:0xf bank_mask:0x1
v_add_f32_dpp v81, v65, v65 row_ror:4 row_mask:0xf bank_mask:0x1
s_nop 0
v_add_f32_dpp v80, v68, v68 row_ror:4 row_mask:0xf bank_mask:0x2
v_add_f32_dpp v81, v69, v69 row_ror:4 row_mask:0xf bank_mask:0x2
s_nop 0
v_add_f32_dpp v80, v72, v72 row_ror:4 row_mask:0xf bank_mask:0x4
v_add_f32_dpp v81, v73, v73 row_ror:4 row_mask:0xf bank_mask:0x4
s_nop 0
v_add_f32_dpp v80, v76, v76 row_ror:4 row_mask:0xf bank_mask:0x8
v_add_f32_dpp v81, v77, v77 row_ror:4 row_mask:0xf bank_mask:0x8
v_cvt_pk_bf16_f32 v80, v80, v81
v_lshlrev_b32 v82, 16, v80
v_and_b32 v83, 0xffff0000, v80
v_lshlrev_b32 v84, 16, v25
v_and_b32 v85, 0xffff0000, v25
v_pk_add_f32 v[82:83], v[82:83], v[84:85]
v_cvt_pk_bf16_f32 v80, v82, v83
global_store_dword v24, v80, s[26:27]
s_cmp_eq_u32 s13, 0
s_cbranch_scc0 Fw_B_e
v_lshlrev_b32 v90, 4, v0
s_lshl_b32 s14, s11, 14
s_lshl_b32 s15, s10, 12
s_add_u32 s14, s14, s15
s_add_u32 s20, s8, s14
s_addc_u32 s21, s9, 0
s_add_u32 s20, s20, 0x200000
s_addc_u32 s21, s21, 0
global_load_dwordx4 v[8:11], v90, s[20:21] offset:0
global_load_dwordx4 v[12:15], v90, s[20:21] offset:1024
global_load_dwordx4 v[16:19], v90, s[20:21] offset:2048
global_load_dwordx4 v[20:23], v90, s[20:21] offset:3072
v_and_b32 v68, 15, v0
v_lshrrev_b32 v69, 4, v0
v_lshlrev_b32 v1, 10, v68
v_lshl_add_u32 v1, v69, 4, v1
s_lshl_b32 s14, s10, 8
v_add_u32 v1, s14, v1
v_lshlrev_b32 v70, 4, v0
s_lshl_b32 s14, s10, 11
v_add_u32 v2, s14, v70
s_lshl_b32 s14, s10, 2
v_add_u32 v3, s14, v70
v_and_b32 v70, 1, v69
v_lshlrev_b32 v4, 10, v70
v_lshl_add_u32 v4, v68, 4, v4
s_lshl_b32 s14, s10, 8
v_add_u32 v4, s14, v4
v_lshlrev_b32 v5, 9, v70
v_lshl_add_u32 v5, v68, 4, v5
v_lshrrev_b32 v70, 5, v0
v_lshl_add_u32 v4, v70, 3, v4
v_lshlrev_b32 v6, 13, v70
v_and_b32 v70, 31, v0
v_lshl_add_u32 v6, v70, 2, v6
s_lshl_b32 s14, s10, 14
v_add_u32 v6, s14, v6
v_mov_b32 v7, 0x3f803f80
s_lshl_b32 s14, s36, 15
s_lshl_b32 s15, s10, 13
s_add_u32 s14, s14, s15
s_add_u32 s24, s8, s14
s_addc_u32 s25, s9, 0
s_add_u32 s24, s24, 0x1201000
s_addc_u32 s25, s25, 0
s_lshl_b32 s14, s11, 16
s_lshl_b32 s15, s36, 7
s_add_u32 s14, s14, s15
s_add_u32 s28, s8, s14
s_addc_u32 s29, s9, 0
s_add_u32 s28, s28, 0x800000
s_addc_u32 s29, s29, 0
s_add_u32 s18, s18, 1
s_waitcnt vmcnt(0)
s_barrier
s_cmp_eq_u32 s10, 0
s_cbranch_scc0 Fw_B_g3_d
s_lshl_b32 s22, s12, 8
s_add_u32 s20, s8, s22
s_addc_u32 s21, s9, 0
s_add_u32 s20, s20, 0x1000
s_addc_u32 s21, s21, 0
v_mov_b32 v127, s18
v_and_b32 v126, 31, v0
v_lshlrev_b32 v126, 2, v126
v_cmp_eq_u32 vcc, s11, v0
s_mov_b64 exec, vcc
global_store_dword v126, v127, s[20:21]
s_mov_b64 exec, -1
s_mov_b32 s19, 0
Fw_B_g3_p:
global_load_dword v127, v126, s[20:21] sc1
s_add_u32 s19, s19, 1
s_cmp_gt_u32 s19, 400000
s_cbranch_scc1 KB_fail
s_waitcnt vmcnt(0)
v_cmp_gt_u32 vcc, s18, v127
s_cbranch_vccnz Fw_B_g3_p
Fw_B_g3_d:
s_barrier
global_load_dwordx4 v[24:27], v90, s[24:25] offset:-4096 sc1
global_load_dwordx4 v[40:43], v90, s[24:25] offset:0 sc1
global_load_dwordx4 v[28:31], v90, s[24:25] offset:-3072 sc1
global_load_dwordx4 v[44:47], v90, s[24:25] offset:1024 sc1
global_load_dwordx4 v[32:35], v90, s[24:25] offset:-2048 sc1
global_load_dwordx4 v[48:51], v90, s[24:25] offset:2048 sc1
global_load_dwordx4 v[36:39], v90, s[24:25] offset:-1024 sc1
global_load_dwordx4 v[52:55], v90, s[24:25] offset:3072 sc1
v_mov_b32 v64, 0
v_mov_b32 v65, 0
v_mov_b32 v66, 0
v_mov_b32 v67, 0
s_waitcnt vmcnt(7)
v_mfma_f32_16x16x32_bf16 v[56:59], v[8:11], v[24:27], 0
v_dot2c_f32_bf16 v64, v24, v7
v_dot2c_f32_bf16 v66, v24, v24
v_dot2c_f32_bf16 v64, v25, v7
v_dot2c_f32_bf16 v66, v25, v25
v_dot2c_f32_bf16 v64, v26, v7
v_dot2c_f32_bf16 v66, v26, v26
v_dot2c_f32_bf16 v64, v27, v7
v_dot2c_f32_bf16 v66, v27, v27
s_waitcnt vmcnt(6)
v_mfma_f32_16x16x32_bf16 v[60:63], v[8:11], v[40:43], 0
v_dot2c_f32_bf16 v65, v40, v7
v_dot2c_f32_bf16 v67, v40, v40
v_dot2c_f32_bf16 v65, v41, v7
v_dot2c_f32_bf16 v67, v41, v41
v_dot2c_f32_bf16 v65, v42, v7
v_dot2c_f32_bf16 v67, v42, v42
v_dot2c_f32_bf16 v65, v43, v7
v_dot2c_f32_bf16 v67, v43, v43
s_waitcnt vmcnt(5)
v_mfma_f32_16x16x32_bf16 v[56:59], v[12:15], v[28:31], v[56:59]
v_dot2c_f32_bf16 v64, v28, v7
v_dot2c_f32_bf16 v66, v28, v28
v_dot2c_f32_bf16 v64, v29, v7
v_dot2c_f32_bf16 v66, v29, v29
v_dot2c_f32_bf16 v64, v30, v7
v_dot2c_f32_bf16 v66, v30, v30
v_dot2c_f32_bf16 v64, v31, v7
v_dot2c_f32_bf16 v66, v31, v31
s_waitcnt vmcnt(4)
v_mfma_f32_16x16x32_bf16 v[60:63], v[12:15], v[44:47], v[60:63]
v_dot2c_f32_bf16 v65, v44, v7
v_dot2c_f32_bf16 v67, v44, v44
v_dot2c_f32_bf16 v65, v45, v7
v_dot2c_f32_bf16 v67, v45, v45
v_dot2c_f32_bf16 v65, v46, v7
v_dot2c_f32_bf16 v67, v46, v46
v_dot2c_f32_bf16 v65, v47, v7
v_dot2c_f32_bf16 v67, v47, v47
s_waitcnt vmcnt(3)
v_mfma_f32_16x16x32_bf16 v[56:59], v[16:19], v[32:35], v[56:59]
v_dot2c_f32_bf16 v64, v32, v7
v_dot2c_f32_bf16 v66, v32, v32
v_dot2c_f32_bf16 v64, v33, v7
v_dot2c_f32_bf16 v66, v33, v33
v_dot2c_f32_bf16 v64, v34, v7
v_dot2c_f32_bf16 v66, v34, v34
v_dot2c_f32_bf16 v64, v35, v7
v_dot2c_f32_bf16 v66, v35, v35
s_waitcnt vmcnt(2)
v_mfma_f32_16x16x32_bf16 v[60:63], v[16:19], v[48:51], v[60:63]
v_dot2c_f32_bf16 v65, v48, v7
v_dot2c_f32_bf16 v67, v48, v48
v_dot2c_f32_bf16 v65, v49, v7
v_dot2c_f32_bf16 v67, v49, v49
v_dot2c_f32_bf16 v65, v50, v7
v_dot2c_f32_bf16 v67, v50, v50
v_dot2c_f32_bf16 v65, v51, v7
v_dot2c_f32_bf16 v67, v51, v51
s_waitcnt vmcnt(1)
v_mfma_f32_16x16x32_bf16 v[56:59], v[20:23], v[36:39], v[56:59]
v_dot2c_f32_bf16 v64, v36, v7
v_dot2c_f32_bf16 v66, v36, v36
v_dot2c_f32_bf16 v64, v37, v7
v_dot2c_f32_bf16 v66, v37, v37
v_dot2c_f32_bf16 v64, v38, v7
v_dot2c_f32_bf16 v66, v38, v38
v_dot2c_f32_bf16 v64, v39, v7
v_dot2c_f32_bf16 v66, v39, v39
s_waitcnt vmcnt(0)
v_mfma_f32_16x16x32_bf16 v[60:63], v[20:23], v[52:55], v[60:63]
v_dot2c_f32_bf16 v65, v52, v7
v_dot2c_f32_bf16 v67, v52, v52
v_dot2c_f32_bf16 v65, v53, v7
v_dot2c_f32_bf16 v67, v53, v53
v_dot2c_f32_bf16 v65, v54, v7
v_dot2c_f32_bf16 v67, v54, v54
v_dot2c_f32_bf16 v65, v55, v7
v_dot2c_f32_bf16 v67, v55, v55
ds_write_b128 v2, v[56:59] offset:0
ds_write_b128 v2, v[60:63] offset:1024
v_permlane32_swap_b32 v64, v65
v_permlane32_swap_b32 v66, v67
v_add_f32 v64, v64, v65
v_add_f32 v66, v66, v67
s_nop 1
v_permlane16_swap_b32 v64, v66
v_add_f32 v64, v64, v66
ds_write_b32 v3, v64 offset:8192
s_waitcnt lgkmcnt(0)
s_barrier
ds_read_b128 v[76:79], v5 offset:8192
ds_read_b128 v[80:83], v5 offset:8448
ds_read_b64 v[68:69], v4 offset:0
ds_read_b64 v[70:71], v4 offset:2048
ds_read_b64 v[72:73], v4 offset:4096
ds_read_b64 v[74:75], v4 offset:6144
s_waitcnt lgkmcnt(4)
v_pk_add_f32 v[76:77], v[76:77], v[78:79]
v_pk_add_f32 v[80:81], v[80:81], v[82:83]
v_add_f32 v76, v76, v77
v_add_f32 v80, v80, v81
v_mul_f32 v76, 0x3b000000, v76
v_mul_f32 v80, 0x3b000000, v80
v_fma_f32 v80, -v76, v76, v80
v_max_f32 v80, 0, v80
v_add_f32 v80, 0x3727c5ac, v80
v_rsq_f32 v80, v80
s_waitcnt lgkmcnt(0)
s_barrier
v_pk_add_f32 v[68:69], v[68:69], v[70:71]
v_pk_add_f32 v[72:73], v[72:73], v[74:75]
v_pk_add_f32 v[68:69], v[68:69], v[72:73]
v_pk_mul_f32 v[68:69], v[68:69], v[80:81] op_sel_hi:[1,0]
v_cvt_pk_bf16_f32 v68, v68, v69
global_store_dword v6, v68, s[28:29] sc1
s_lshl_b32 s14, s11, 6
s_add_u32 s14, s14, s36
s_waitcnt vmcnt(0)
s_barrier
s_cmp_eq_u32 s10, 0
s_cbranch_scc0 Fw_B_f
s_lshl_b32 s22, s14, 2
s_add_u32 s20, s8, s22
s_addc_u32 s21, s9, 0
s_add_u32 s20, s20, 0x5000
s_addc_u32 s21, s21, 0
s_add_u32 s22, s13, 1
v_mov_b32 v126, 0
v_mov_b32 v127, s22
s_mov_b64 exec, 1
global_store_dword v126, v127, s[20:21] sc1
s_mov_b64 exec, -1
Fw_B_f:
Fw_B_e:
s_add_u32 s36, s36, 7
s_cmp_lt_u32 s36, 64
s_cbranch_scc1 Fw_B
s_branch KB_next
KB_slow:
s_cmp_eq_u32 s12, 0
s_cbranch_scc0 S_worker
v_and_b32 v40, 15, v0
v_lshrrev_b32 v41, 4, v0
v_lshlrev_b32 v4, 4, v0
s_lshl_b32 s20, s10, 15
s_add_u32 s20, s20, 32768
v_add_u32 v16, s20, v4
v_lshrrev_b32 v42, 3, v40
v_and_b32 v43, 7, v0
v_mov_b32 v44, 0x4444
v_mov_b32 v45, 0xeeee
v_cmp_eq_u32 vcc, 1, v42
s_nop 1
v_cndmask_b32 v1, v44, v45, vcc
v_lshlrev_b32 v46, 2, v41
v_sub_u32 v46, v40, v46
v_mov_b32 v44, 0x3f80
v_mov_b32 v45, 0x3f800000
v_cmp_eq_u32 vcc, 0, v46
s_nop 1
v_cndmask_b32 v18, 0, v44, vcc
v_cmp_eq_u32 vcc, 1, v46
s_nop 1
v_cndmask_b32 v18, v18, v45, vcc
v_cmp_eq_u32 vcc, 2, v46
s_nop 1
v_cndmask_b32 v19, 0, v44, vcc
v_cmp_eq_u32 vcc, 3, v46
s_nop 1
v_cndmask_b32 v19, v19, v45, vcc
v_and_b32 v44, 3, v40
v_lshlrev_b32 v44, 2, v44
v_lshrrev_b32 v45, 2, v40
v_add_u32 v46, v44, v45
v_mov_b32 v44, 0x3f80
v_mov_b32 v45, 0x3f800000
v_cmp_eq_u32 vcc, 0, v46
s_nop 1
v_cndmask_b32 v52, 0, v44, vcc
v_cmp_eq_u32 vcc, 1, v46
s_nop 1
v_cndmask_b32 v52, v52, v45, vcc
v_cmp_eq_u32 vcc, 2, v46
s_nop 1
v_cndmask_b32 v53, 0, v44, vcc
v_cmp_eq_u32 vcc, 3, v46
s_nop 1
v_cndmask_b32 v53, v53, v45, vcc
v_cmp_eq_u32 vcc, 4, v46
s_nop 1
v_cndmask_b32 v54, 0, v44, vcc
v_cmp_eq_u32 vcc, 5, v46
s_nop 1
v_cndmask_b32 v54, v54, v45, vcc
v_cmp_eq_u32 vcc, 6, v46
s_nop 1
v_cndmask_b32 v55, 0, v44, vcc
v_cmp_eq_u32 vcc, 7, v46
s_nop 1
v_cndmask_b32 v55, v55, v45, vcc
ds_write_b128 v4, v[52:55] offset:24576
v_lshrrev_b32 v44, 1, v41
v_lshlrev_b32 v44, 3, v44
v_lshrrev_b32 v45, 2, v40
v_lshl_add_u32 v44, v45, 1, v44
v_and_b32 v45, 1, v41
v_add_u32 v44, v44, v45
s_lshl_b32 s20, s10, 4
v_add_u32 v44, s20, v44
v_lshlrev_b32 v44, 11, v44
v_and_b32 v45, 3, v0
v_lshl_add_u32 v44, v45, 4, v44
s_lshl_b32 s20, s11, 6
v_add_u32 v74, s20, v44
v_lshlrev_b32 v46, 4, v41
v_lshl_add_u32 v46, v45, 2, v46
s_lshl_b32 s20, s10, 5
s_add_u32 s20, s20, s11
s_lshl_b32 s21, s20, 6
v_add_u32 v2, s21, v46
s_lshl_b32 s21, s20, 11
s_add_u32 s34, s8, s21
s_addc_u32 s35, s9, 0
s_add_u32 s34, s34, 0x40000
s_addc_u32 s35, s35, 0
s_add_u32 s30, s8, 0x40000
s_addc_u32 s31, s9, 0
s_add_u32 s32, s8, 0x60000
s_addc_u32 s33, s9, 0
s_add_u32 s60, s8, 0x80000
s_addc_u32 s61, s9, 0
s_lshl_b32 s20, s10, 11
v_add_u32 v7, s20, v4
s_mov_b32 m0, s20
s_lshl_b32 s20, s10, 2
v_add_u32 v11, s20, v4
v_lshlrev_b32 v44, 7, v41
v_lshl_add_u32 v44, v43, 4, v44
v_lshl_add_u32 v45, v42, 3, v44
s_lshl_b32 s20, s10, 9
v_add_u32 v12, s20, v45
s_add_u32 s21, s10, 1
s_and_b32 s21, s21, 3
s_lshl_b32 s20, s21, 11
v_add_u32 v8, s20, v4
s_lshl_b32 s20, s21, 9
v_add_u32 v13, s20, v44
s_add_u32 s21, s10, 2
s_and_b32 s21, s21, 3
s_lshl_b32 s20, s21, 11
v_add_u32 v9, s20, v4
s_lshl_b32 s20, s21, 9
v_add_u32 v14, s20, v44
s_add_u32 s21, s10, 3
s_and_b32 s21, s21, 3
s_lshl_b32 s20, s21, 11
v_add_u32 v10, s20, v4
s_lshl_b32 s20, s21, 9
v_add_u32 v15, s20, v44
v_xor_b32 v3, 0x80, v10
v_xor_b32 v6, 0x80, v9
v_xor_b32 v5, 0x80, v8
v_xor_b32 v17, 0x80, v7
ds_write_b32 v7, v74 offset:25600
s_lshl_b32 s20, s11, 2
s_add_u32 s20, s20, s10
s_lshl_b32 s20, s20, 12
s_mul_i32 s21, s13, 0x2400000
s_add_u32 s20, s20, s21
s_add_u32 s24, s8, s20
s_addc_u32 s25, s9, 0
s_add_u32 s24, s24, 0x4000000
s_addc_u32 s25, s25, 0
s_add_u32 s26, s24, 0x80000
s_addc_u32 s27, s25, 0
s_lshl_b32 s20, s13, 19
s_add_u32 s28, s8, s20
s_addc_u32 s29, s9, 0
s_add_u32 s28, s28, 0x100000
s_addc_u32 s29, s29, 0
s_lshl_b32 s20, s10, 11
s_add_u32 s44, s28, s20
s_addc_u32 s45, s29, 0
s_lshl_b32 s20, s11, 8
s_add_u32 s54, s8, s20
s_addc_u32 s55, s9, 0
s_add_u32 s54, s54, 0x2000
s_addc_u32 s55, s55, 0
s_add_u32 s42, s60, s39
s_addc_u32 s43, s61, 0
s_xor_b32 s39, s39, 0x2000
s_add_u32 s46, s60, s39
s_addc_u32 s47, s61, 0
s_mov_b32 s40, 0x3f803f80
s_mov_b32 s41, 0x3f803f80
s_mov_b32 s48, 0x000f000f
s_mov_b32 s49, 0x000f000f
s_mov_b32 s50, 0x11111111
s_mov_b32 s51, 0x11111111
s_mov_b32 s52, 0x3e0293ee
s_mov_b32 s53, 0x3e0293ee
s_mov_b32 s62, 0x42700000
s_mov_b32 s63, 0xff81ff81
s_mov_b32 s64, 0
s_mov_b64 s[56:57], 0
s_waitcnt lgkmcnt(0)
global_load_lds_dwordx4 v4, s[44:45] sc1
global_load_lds_dwordx4 v4, s[44:45] offset:1024 sc1
v_mov_b32 v88, 0
v_mov_b32 v89, 0
v_mov_b32 v90, 0
v_mov_b32 v91, 0
v_mov_b32 v92, 0
v_mov_b32 v93, 0
v_mov_b32 v94, 0
v_mov_b32 v95, 0
v_mov_b32 v96, 0
v_mov_b32 v97, 0
v_mov_b32 v98, 0
v_mov_b32 v99, 0
v_mov_b32 v100, 0
v_mov_b32 v101, 0
v_mov_b32 v102, 0
v_mov_b32 v103, 0
v_mov_b64 v[64:65], 0
v_mov_b64 v[66:67], 0
v_mov_b64 v[68:69], 0
v_mov_b64 v[70:71], 0
v_mov_b64 v[72:73], 0
v_mov_b64 v[74:75], 0
v_mov_b64 v[76:77], 0
v_mov_b64 v[78:79], 0
ds_read_b128 v[28:31], v16 offset:8192
ds_read_b128 v[32:35], v16 offset:9216
ds_read_b128 v[36:39], v16 offset:10240
ds_read_b128 v[40:43], v16 offset:11264
ds_read_b128 v[44:47], v16 offset:12288
ds_read_b128 v[48:51], v16 offset:13312
ds_read_b128 v[104:107], v16 offset:14336
ds_read_b128 v[108:111], v16 offset:15360
ds_read_b128 v[112:115], v16 offset:16384
ds_read_b128 v[116:119], v16 offset:17408
ds_read_b128 v[120:123], v16 offset:18432
ds_read_b128 v[124:127], v16 offset:19456
s_mov_b32 s19, 0
Sr_k0:
global_load_dwordx2 v[80:81], v88, s[54:55] sc1
s_add_u32 s19, s19, 1
s_cmp_gt_u32 s19, 400000
s_cbranch_scc1 KB_fail
s_waitcnt vmcnt(0)
v_min_u32 v80, v80, v81
v_cmp_ge_u32 vcc, s13, v80
s_cbranch_vccz Sr_k1
s_sleep 1
s_branch Sr_k0
Sr_k1:
global_load_dwordx4 v[80:83], v4, s[24:25] sc1
global_load_dwordx4 v[84:87], v4, s[24:25] offset:1024 sc1
global_load_dwordx4 v[90:93], v4, s[24:25] offset:2048 sc1
global_load_dwordx4 v[98:101], v4, s[24:25] offset:3072 sc1
s_mov_b32 s19, 0
s_waitcnt vmcnt(0) lgkmcnt(0)
s_barrier
s_add_u32 s54, s54, 0x8
s_addc_u32 s55, s55, 0
s_waitcnt lgkmcnt(0)
s_branch Sr_top
.p2align 6
Sr_top:
s_waitcnt vmcnt(3)
ds_read_b128 v[20:23], v7 offset:0
s_waitcnt vmcnt(2)
ds_read_b128 v[24:27], v7 offset:1024
ds_read_b128 v[52:55], v17 offset:0
ds_read_b128 v[56:59], v17 offset:1024
s_waitcnt lgkmcnt(3)
v_smfmac_f32_16x16x64_bf16 v[64:67], v[20:23], v[28:35], v1
v_cmp_eq_u32 vcc, s63, v20
v_smfmac_f32_16x16x64_bf16 v[68:71], v[20:23], v[36:43], v1
s_waitcnt lgkmcnt(2)
v_cmp_eq_u32 s[58:59], s63, v24
v_smfmac_f32_16x16x64_bf16 v[64:67], v[24:27], v[44:51], v1
s_or_b64 vcc, vcc, s[58:59]
s_cbranch_scc1 Sr_p2retry
v_smfmac_f32_16x16x64_bf16 v[68:71], v[24:27], v[104:111], v1
v_smfmac_f32_16x16x64_bf16 v[72:75], v[20:23], v[112:119], v1
v_smfmac_f32_16x16x64_bf16 v[76:79], v[20:23], v[120:127], v1
s_waitcnt lgkmcnt(0)
v_smfmac_f32_16x16x64_bf16 v[72:75], v[24:27], a[232:239], v1
s_barrier
ds_read_b128 v[28:31], v8 offset:0
v_smfmac_f32_16x16x64_bf16 v[76:79], v[24:27], a[240:247], v1
ds_read_b128 v[60:63], v5 offset:0
v_smfmac_f32_16x16x64_bf16 v[64:67], v[52:55], a[200:207], v1
ds_read_b128 v[32:35], v8 offset:1024
global_load_dwordx4 v[90:93], v4, s[24:25] offset:2048 sc1
v_smfmac_f32_16x16x64_bf16 v[68:71], v[52:55], a[208:215], v1
ds_read_b128 v[104:107], v16 offset:0
v_lshlrev_b32 v0, 2, v4
v_smfmac_f32_16x16x64_bf16 v[64:67], v[56:59], a[216:223], v1
ds_read_b128 v[52:55], v5 offset:1024
v_smfmac_f32_16x16x64_bf16 v[68:71], v[56:59], a[224:231], v1
ds_read_b128 v[108:111], v16 offset:1024
s_waitcnt lgkmcnt(4)
v_smfmac_f32_16x16x64_bf16 v[64:67], v[28:31], v[232:239], v1
ds_read_b128 v[56:59], v6 offset:0
global_load_dwordx4 v[98:101], v4, s[24:25] offset:3072 sc1
v_smfmac_f32_16x16x64_bf16 v[68:71], v[28:31], v[240:247], v1
ds_read_b128 v[36:39], v9 offset:0
v_smfmac_f32_16x16x64_bf16 v[64:67], v[60:63], v[248:255], v1
ds_read_b128 v[112:115], v16 offset:2048
v_smfmac_f32_16x16x64_bf16 v[68:71], v[60:63], a[0:7], v1
ds_read_b128 v[116:119], v16 offset:3072
s_waitcnt lgkmcnt(4)
v_smfmac_f32_16x16x64_bf16 v[64:67], v[32:35], a[104:111], v1
ds_read_b128 v[60:63], v6 offset:1024
global_load_dword v0, v0, s[26:27] sc1
v_smfmac_f32_16x16x64_bf16 v[68:71], v[32:35], a[112:119], v1
ds_read_b128 v[40:43], v9 offset:1024
v_smfmac_f32_16x16x64_bf16 v[64:67], v[52:55], a[120:127], v1
ds_read_b128 v[120:123], v16 offset:4096
global_load_dword v0, v88, s[54:55] sc1
v_smfmac_f32_16x16x64_bf16 v[68:71], v[52:55], v[104:111], v1
ds_read_b128 v[124:127], v16 offset:5120
s_waitcnt lgkmcnt(4)
v_smfmac_f32_16x16x64_bf16 v[64:67], v[36:39], a[128:135], v1
ds_read_b128 v[52:55], v3 offset:0
v_smfmac_f32_16x16x64_bf16 v[68:71], v[36:39], a[136:143], v1
ds_read_b128 v[44:47], v10 offset:0
v_smfmac_f32_16x16x64_bf16 v[64:67], v[56:59], a[144:151], v1
ds_read_b128 v[104:107], v16 offset:6144
v_smfmac_f32_16x16x64_bf16 v[68:71], v[56:59], v[112:119], v1
ds_read_b128 v[108:111], v16 offset:7168
s_waitcnt lgkmcnt(4)
v_smfmac_f32_16x16x64_bf16 v[64:67], v[40:43], a[152:159], v1
ds_read_b128 v[56:59], v3 offset:1024
v_smfmac_f32_16x16x64_bf16 v[68:71], v[40:43], a[160:167], v1
ds_read_b128 v[48:51], v10 offset:1024
v_smfmac_f32_16x16x64_bf16 v[64:67], v[60:63], a[168:175], v1
ds_read_b128 v[112:115], v16 offset:20480
v_smfmac_f32_16x16x64_bf16 v[68:71], v[60:63], v[120:127], v1
ds_read_b128 v[116:119], v16 offset:21504
s_waitcnt lgkmcnt(4)
v_smfmac_f32_16x16x64_bf16 v[64:67], v[44:47], a[8:15], v1
ds_read_b128 v[120:123], v16 offset:22528
v_smfmac_f32_16x16x64_bf16 v[64:67], v[52:55], a[24:31], v1
ds_read_b128 v[124:127], v16 offset:23552
s_waitcnt lgkmcnt(4)
v_smfmac_f32_16x16x64_bf16 v[64:67], v[48:51], a[176:183], v1
s_mov_b64 exec, s[56:57]
global_store_dword v2, v89, s[28:29] sc1
s_mov_b64 exec, -1
v_smfmac_f32_16x16x64_bf16 v[64:67], v[56:59], v[104:111], v1
ds_read_b128 v[104:107], v16 offset:24576
v_smfmac_f32_16x16x64_bf16 v[68:71], v[44:47], a[16:23], v1
v_smfmac_f32_16x16x64_bf16 v[68:71], v[52:55], a[32:39], v1
ds_read_b128 v[108:111], v16 offset:25600
v_cvt_pk_bf16_f32 v64, v64, v65
v_smfmac_f32_16x16x64_bf16 v[68:71], v[48:51], a[184:191], v1
s_waitcnt lgkmcnt(2)
v_cvt_pk_bf16_f32 v65, v66, v67
v_smfmac_f32_16x16x64_bf16 v[68:71], v[56:59], a[192:199], v1
v_smfmac_f32_16x16x64_bf16 v[72:75], v[28:31], v[112:119], v1
v_mfma_f32_16x16x16_bf16 v[60:63], v[64:65], v[18:19], 0
v_cvt_pk_bf16_f32 v68, v68, v69
v_cvt_pk_bf16_f32 v69, v70, v71
v_mov_b32 v20, 0
v_mov_b32 v25, 0
v_mfma_f32_16x16x16_bf16 v[52:55], v[68:69], v[18:19], 0
s_nop 2
v_cvt_pk_bf16_f32 v64, v60, v61
v_cvt_pk_bf16_f32 v65, v62, v63
v_smfmac_f32_16x16x64_bf16 v[76:79], v[28:31], v[120:127], v1
s_nop 1
v_cvt_pk_bf16_f32 v66, v52, v53
v_cvt_pk_bf16_f32 v67, v54, v55
v_mov_b64 v[28:29], s[40:41]
v_mov_b64 v[30:31], s[40:41]
v_mfma_f32_16x16x32_bf16 v[56:59], v[64:67], v[64:67], 0
v_mfma_f32_16x16x32_bf16 v[52:55], v[80:83], v[64:67], 0
s_add_u32 s24, s24, 0x80000
s_addc_u32 s25, s25, 0
s_waitcnt lgkmcnt(0)
v_mfma_f32_16x16x32_bf16 v[68:71], v[84:87], v[64:67], 0
v_mov_b32_dpp v56, v57 row_ror:8 row_mask:0xf bank_mask:0xc
v_mov_b32_dpp v58, v59 row_ror:8 row_mask:0xf bank_mask:0xc
v_smfmac_f32_16x16x64_bf16 v[72:75], v[32:35], v[104:111], v1
s_nop 0
v_permlane32_swap_b32 v58, v56
s_nop 1
v_mov_b32_dpp v52, v68 row_ror:8 row_mask:0xf bank_mask:0xc
v_mov_b32_dpp v53, v69 row_ror:8 row_mask:0xf bank_mask:0xc
v_mov_b32_dpp v54, v70 row_ror:8 row_mask:0xf bank_mask:0xc
v_mov_b32_dpp v55, v71 row_ror:8 row_mask:0xf bank_mask:0xc
ds_write_b128 v7, v[52:55] offset:8192
ds_write_b32 v11, v56 offset:9216
v_smfmac_f32_16x16x64_bf16 v[76:79], v[32:35], a[248:255], v1
global_load_dwordx4 v[80:83], v4, s[24:25] sc1
v_smfmac_f32_16x16x64_bf16 v[72:75], v[36:39], a[40:47], v1
ds_read_b128 v[112:115], v16 offset:26624
v_smfmac_f32_16x16x64_bf16 v[72:75], v[40:43], a[56:63], v1
ds_read_b128 v[116:119], v16 offset:27648
v_smfmac_f32_16x16x64_bf16 v[72:75], v[44:47], a[72:79], v1
global_load_dwordx4 v[84:87], v4, s[24:25] offset:1024 sc1
v_smfmac_f32_16x16x64_bf16 v[72:75], v[48:51], a[88:95], v1
s_waitcnt lgkmcnt(2)
s_barrier
ds_read_b128 v[56:59], v8 offset:8192
ds_read_b128 v[60:63], v9 offset:8192
v_smfmac_f32_16x16x64_bf16 v[76:79], v[36:39], a[48:55], v1
ds_read_b128 v[68:71], v10 offset:8192
ds_read_b128 v[64:67], v4 offset:9216
v_smfmac_f32_16x16x64_bf16 v[76:79], v[40:43], a[64:71], v1
ds_read_b128 v[120:123], v16 offset:28672
v_permlane32_swap_b32 v74, v72
v_smfmac_f32_16x16x64_bf16 v[76:79], v[44:47], a[80:87], v1
ds_read_b128 v[124:127], v16 offset:29696
v_permlane32_swap_b32 v75, v73
v_smfmac_f32_16x16x64_bf16 v[76:79], v[48:51], a[96:103], v1
ds_read_b128 v[104:107], v16 offset:30720
v_pk_add_f32 v[72:73], v[72:73], v[74:75]
s_waitcnt lgkmcnt(6)
v_pk_add_f32 v[52:53], v[52:53], v[56:57]
v_pk_add_f32 v[54:55], v[54:55], v[58:59]
v_cvt_pk_bf16_f32 v94, v73, 0
v_cvt_pk_bf16_f32 v89, v72, 0
s_waitcnt lgkmcnt(4)
v_pk_add_f32 v[60:61], v[60:61], v[68:69]
v_pk_add_f32 v[62:63], v[62:63], v[70:71]
s_waitcnt lgkmcnt(3)
v_pk_add_f32 v[64:65], v[64:65], v[66:67]
v_pk_add_f32 v[52:53], v[52:53], v[60:61]
v_pk_add_f32 v[54:55], v[54:55], v[62:63]
v_add_f32 v56, v64, v65
v_pk_mul_f32 v[52:53], v[52:53], s[52:53]
v_pk_mul_f32 v[54:55], v[54:55], s[52:53]
v_mul_f32 v56, s52, v56
v_exp_f32 v58, v52
v_exp_f32 v59, v53
v_exp_f32 v60, v54
v_exp_f32 v61, v55
v_exp_f32 v62, v56
v_cvt_pk_bf16_f32 v22, v58, v59
v_cvt_pk_bf16_f32 v23, v60, v61
v_cvt_pk_bf16_f32 v24, v62, 0
v_cvt_pk_bf16_f32 v21, v62, 0
s_waitcnt vmcnt(5)
v_mfma_f32_16x16x32_bf16 v[64:67], v[28:31], v[22:25], 0
v_permlane32_swap_b32 v78, v76
v_mfma_f32_16x16x32_bf16 v[68:71], v[92:95], v[22:25], 0
v_permlane32_swap_b32 v79, v77
v_mfma_f32_16x16x32_bf16 v[32:35], v[88:91], v[20:23], 0
v_pk_add_f32 v[76:77], v[76:77], v[78:79]
v_cvt_pk_bf16_f32 v102, v77, 0
v_cvt_pk_bf16_f32 v97, v76, 0
v_add_f32_dpp v64, v64, v64 row_ror:8 row_mask:0xf bank_mask:0xf
v_mfma_f32_16x16x32_bf16 v[36:39], v[100:103], v[22:25], 0
v_rcp_f32 v64, v64
v_mfma_f32_16x16x32_bf16 v[40:43], v[96:99], v[20:23], 0
v_add_f32_dpp v32, v68, v32 row_ror:8 row_mask:0xf bank_mask:0x3
v_add_f32_dpp v33, v69, v33 row_ror:8 row_mask:0xf bank_mask:0x3
v_add_f32_dpp v34, v70, v34 row_ror:8 row_mask:0xf bank_mask:0x3
v_add_f32_dpp v35, v71, v35 row_ror:8 row_mask:0xf bank_mask:0x3
v_max3_f32 v57, abs(v52), abs(v53), abs(v54)
v_max3_f32 v57, abs(v55), abs(v56), v57
v_cmp_nlt_f32 vcc, v57, s62
s_nop 0
v_add_f32_dpp v32, v40, v36 row_ror:8 row_mask:0xf bank_mask:0xc
v_add_f32_dpp v33, v41, v37 row_ror:8 row_mask:0xf bank_mask:0xc
v_add_f32_dpp v34, v42, v38 row_ror:8 row_mask:0xf bank_mask:0xc
v_add_f32_dpp v35, v43, v39 row_ror:8 row_mask:0xf bank_mask:0xc
v_pk_mul_f32 v[32:33], v[32:33], v[64:65] op_sel_hi:[1,0]
v_pk_mul_f32 v[34:35], v[34:35], v[64:65] op_sel_hi:[1,0]
v_cvt_pk_bf16_f32 v20, v32, v33
v_cvt_pk_bf16_f32 v21, v34, v35
ds_write_b64 v12, v[20:21] offset:16384
s_cbranch_vccnz Sr_slowmax
Sr_maxdone:
v_mov_b32_dpp v22, v20 row_ror:8 row_mask:0xf bank_mask:0xf
v_mov_b32_dpp v23, v21 row_ror:8 row_mask:0xf bank_mask:0xf
v_mov_b64 v[48:49], 0
v_mov_b64 v[50:51], 0
v_mov_b64 v[36:37], 0
v_mov_b64 v[38:39], 0
v_mov_b64 v[40:41], 0
s_waitcnt lgkmcnt(0)
s_barrier
ds_read_b128 v[24:27], v13 offset:16384
v_smfmac_f32_16x16x64_bf16 v[48:51], v[20:23], v[224:231], v1
ds_read_b128 v[28:31], v14 offset:16384
v_mov_b64 v[42:43], 0
v_smfmac_f32_16x16x64_bf16 v[36:39], v[20:23], v[112:119], v1
ds_read_b128 v[32:35], v15 offset:16384
v_mov_b64 v[44:45], 0
v_smfmac_f32_16x16x64_bf16 v[40:43], v[20:23], v[120:127], v1
ds_read_b128 v[108:111], v16 offset:31744
v_mov_b64 v[46:47], 0
s_waitcnt lgkmcnt(3)
v_smfmac_f32_16x16x64_bf16 v[36:39], v[24:27], v[128:135], v1
s_waitcnt lgkmcnt(2)
v_smfmac_f32_16x16x64_bf16 v[36:39], v[28:31], v[160:167], v1
s_waitcnt lgkmcnt(1)
v_smfmac_f32_16x16x64_bf16 v[36:39], v[32:35], v[192:199], v1
ds_read_b32 v74, v7 offset:25600
v_smfmac_f32_16x16x64_bf16 v[40:43], v[24:27], v[136:143], v1
v_smfmac_f32_16x16x64_bf16 v[40:43], v[28:31], v[168:175], v1
v_cvt_pk_bf16_f32 v36, v36, v37
v_smfmac_f32_16x16x64_bf16 v[40:43], v[32:35], v[200:207], v1
s_waitcnt lgkmcnt(0)
v_cvt_pk_bf16_f32 v37, v38, v39
v_smfmac_f32_16x16x64_bf16 v[44:47], v[20:23], v[104:111], v1
s_mov_b64 exec, s[50:51]
v_and_or_b32 v36, v36, -2, s38
v_smfmac_f32_16x16x64_bf16 v[44:47], v[24:27], v[144:151], v1
s_mov_b64 exec, -1
v_cvt_pk_bf16_f32 v38, v40, v41
v_smfmac_f32_16x16x64_bf16 v[44:47], v[28:31], v[176:183], v1
v_cvt_pk_bf16_f32 v39, v42, v43
v_smfmac_f32_16x16x64_bf16 v[44:47], v[32:35], v[208:215], v1
global_store_dwordx4 v74, v[36:39], s[30:31] sc1
v_smfmac_f32_16x16x64_bf16 v[48:51], v[24:27], v[152:159], v1
v_smfmac_f32_16x16x64_bf16 v[48:51], v[28:31], v[184:191], v1
v_cvt_pk_bf16_f32 v44, v44, v45
v_smfmac_f32_16x16x64_bf16 v[48:51], v[32:35], v[216:223], v1
v_cvt_pk_bf16_f32 v45, v46, v47
s_mov_b64 exec, s[50:51]
v_and_or_b32 v44, v44, -2, s38
s_mov_b64 exec, -1
s_nop 3
v_cvt_pk_bf16_f32 v46, v48, v49
v_cvt_pk_bf16_f32 v47, v50, v51
global_store_dwordx4 v74, v[44:47], s[32:33] sc1
ds_read_b128 v[20:23], v4 offset:24576
ds_read_b128 v[104:107], v16 offset:14336
ds_read_b128 v[108:111], v16 offset:15360
ds_read_b128 v[112:115], v16 offset:16384
ds_read_b128 v[116:119], v16 offset:17408
ds_read_b128 v[120:123], v16 offset:18432
ds_read_b128 v[124:127], v16 offset:19456
s_nop 15
s_nop 14
s_cmp_lt_u32 s10, 2
s_cbranch_scc1 Sr_p1s
s_nop 15
Sr_p1s:
global_load_dwordx4 v[52:55], v4, s[34:35] sc1
global_load_dwordx4 v[56:59], v4, s[34:35] offset:1024 sc1
v_mov_b32 v25, s63
v_cndmask_b32 v26, 0, 1, s[50:51]
v_mov_b64 v[64:65], 0
v_mov_b64 v[66:67], 0
v_mov_b64 v[68:69], 0
v_mov_b64 v[70:71], 0
v_mov_b64 v[72:73], 0
v_mov_b64 v[74:75], 0
v_mov_b64 v[76:77], 0
v_mov_b64 v[78:79], 0
s_nop 15
s_nop 5
global_load_dwordx4 v[90:93], v4, s[34:35] sc1
global_load_dwordx4 v[98:101], v4, s[34:35] offset:1024 sc1
s_waitcnt lgkmcnt(6)
s_waitcnt vmcnt(3)
v_mfma_f32_16x16x32_bf16 v[60:63], v[20:23], v[52:55], 0
s_waitcnt vmcnt(2)
v_mfma_f32_16x16x32_bf16 v[60:63], v[20:23], v[56:59], v[60:63]
v_bitop3_b32 v24, v52, v56, s38 bitop3:0x7e
v_and_b32 v24, v26, v24
v_cmp_ne_u32 vcc, 0, v24
s_nop 3
s_cbranch_vccnz Sr_p1retry
Sr_p1ok:
v_add_f32_dpp v60, v60, v60 row_ror:8 row_mask:0xf bank_mask:0xf
v_add_f32_dpp v61, v61, v61 row_ror:8 row_mask:0xf bank_mask:0xf
s_nop 0
v_add_f32_dpp v60, v60, v60 row_ror:4 row_mask:0xf bank_mask:0xf
v_add_f32_dpp v61, v61, v61 row_ror:4 row_mask:0xf bank_mask:0xf
s_mov_b64 exec, s[48:49]
v_cvt_pk_bf16_f32 v89, v60, v61
global_store_dword v2, v89, s[42:43] sc1
global_store_dword v2, v25, s[46:47] sc1
s_mov_b64 exec, -1
s_xor_b32 s38, s38, 1
s_add_u32 s64, s64, 1
s_add_u32 s28, s28, 0x2000
s_addc_u32 s29, s29, 0
s_cmp_lt_u32 s64, 63
s_cbranch_scc0 Sr_fin
ds_read_b128 v[28:31], v16 offset:8192
ds_read_b128 v[32:35], v16 offset:9216
ds_read_b128 v[36:39], v16 offset:10240
ds_read_b128 v[40:43], v16 offset:11264
ds_read_b128 v[44:47], v16 offset:12288
ds_read_b128 v[48:51], v16 offset:13312
s_lshl_b32 s20, s10, 11
s_add_u32 s44, s42, s20
s_addc_u32 s45, s43, 0
v_cmp_ge_u32 vcc, s13, v0
s_cbranch_vccnz Sr_kvwait
Sr_kvok:
s_nop 11
global_load_lds_dwordx4 v4, s[44:45] sc1
global_load_lds_dwordx4 v4, s[44:45] offset:1024 sc1
s_add_u32 s42, s60, s39
s_addc_u32 s43, s61, 0
s_xor_b32 s39, s39, 0x2000
s_add_u32 s46, s60, s39
s_addc_u32 s47, s61, 0
s_add_u32 s26, s26, 0x80000
s_addc_u32 s27, s27, 0
s_cmp_lt_u32 s64, 62
s_cselect_b32 s20, 4, 0
s_mov_b64 s[56:57], s[48:49]
s_add_u32 s54, s54, s20
s_addc_u32 s55, s55, 0
s_nop 15
s_nop 8
global_load_lds_dwordx4 v4, s[44:45] sc1
global_load_lds_dwordx4 v4, s[44:45] offset:1024 sc1
s_waitcnt lgkmcnt(0)
s_branch Sr_top
Sr_kvwait:
global_load_dword v0, v88, s[54:55] sc1
s_add_u32 s19, s19, 1
s_cmp_gt_u32 s19, 400000
s_cbranch_scc1 KB_fail
s_waitcnt vmcnt(0)
v_cmp_ge_u32 vcc, s13, v0
s_cbranch_vccz Sr_kvok
s_sleep 1
s_branch Sr_kvwait
Sr_p1retry:
global_load_dwordx4 v[52:55], v4, s[34:35] sc1
global_load_dwordx4 v[56:59], v4, s[34:35] offset:1024 sc1
s_waitcnt vmcnt(3)
v_mfma_f32_16x16x32_bf16 v[60:63], v[20:23], v[90:93], 0
s_waitcnt vmcnt(2)
v_mfma_f32_16x16x32_bf16 v[60:63], v[20:23], v[98:101], v[60:63]
v_bitop3_b32 v24, v90, v98, s38 bitop3:0x7e
v_and_b32 v24, v26, v24
v_cmp_ne_u32 vcc, 0, v24
s_nop 3
s_cbranch_vccz Sr_p1ok
global_load_dwordx4 v[90:93], v4, s[34:35] sc1
global_load_dwordx4 v[98:101], v4, s[34:35] offset:1024 sc1
s_add_u32 s19, s19, 1
s_cmp_gt_u32 s19, 400000
s_cbranch_scc1 KB_fail
s_waitcnt vmcnt(3)
v_mfma_f32_16x16x32_bf16 v[60:63], v[20:23], v[52:55], 0
s_waitcnt vmcnt(2)
v_mfma_f32_16x16x32_bf16 v[60:63], v[20:23], v[56:59], v[60:63]
v_bitop3_b32 v24, v52, v56, s38 bitop3:0x7e
v_and_b32 v24, v26, v24
v_cmp_ne_u32 vcc, 0, v24
s_nop 3
s_cbranch_vccz Sr_p1ok
s_branch Sr_p1retry
Sr_p2retry:
global_load_lds_dwordx4 v4, s[44:45] sc1
global_load_lds_dwordx4 v4, s[44:45] offset:1024 sc1
s_add_u32 s19, s19, 1
s_cmp_gt_u32 s19, 400000
s_cbranch_scc1 KB_fail
s_nop 0
v_mov_b64 v[64:65], 0
v_mov_b64 v[66:67], 0
v_mov_b64 v[68:69], 0
v_mov_b64 v[70:71], 0
s_waitcnt lgkmcnt(0)
s_branch Sr_top
Sr_slowmax:
v_max3_f32 v57, v52, v53, v54
v_max3_f32 v57, v55, v56, v57
s_nop 1
v_max_f32_dpp v57, v57, v57 row_ror:8 row_mask:0xf bank_mask:0xf
v_mov_b32 v58, v57
s_nop 1
v_permlane16_swap_b32 v57, v58
v_max_f32 v57, v57, v58
v_mov_b32 v58, v57
s_nop 1
v_permlane32_swap_b32 v57, v58
v_max_f32 v57, v57, v58
s_waitcnt lgkmcnt(0)
v_mov_b32 v20, 0
v_sub_f32 v52, v52, v57
v_sub_f32 v53, v53, v57
v_sub_f32 v54, v54, v57
v_sub_f32 v55, v55, v57
v_sub_f32 v56, v56, v57
v_exp_f32 v58, v52
v_exp_f32 v59, v53
v_exp_f32 v60, v54
v_exp_f32 v61, v55
v_exp_f32 v62, v56
v_cvt_pk_bf16_f32 v22, v58, v59
v_cvt_pk_bf16_f32 v23, v60, v61
v_cvt_pk_bf16_f32 v24, v62, 0
v_cvt_pk_bf16_f32 v21, v62, 0
s_nop 0
v_mfma_f32_16x16x32_bf16 v[64:67], v[28:31], v[22:25], 0
v_mfma_f32_16x16x32_bf16 v[68:71], v[92:95], v[22:25], 0
v_mfma_f32_16x16x32_bf16 v[32:35], v[88:91], v[20:23], 0
v_add_f32_dpp v64, v64, v64 row_ror:8 row_mask:0xf bank_mask:0xf
v_mfma_f32_16x16x32_bf16 v[36:39], v[100:103], v[22:25], 0
v_rcp_f32 v64, v64
v_mfma_f32_16x16x32_bf16 v[40:43], v[96:99], v[20:23], 0
v_add_f32_dpp v32, v68, v32 row_ror:8 row_mask:0xf bank_mask:0x3
v_add_f32_dpp v33, v69, v33 row_ror:8 row_mask:0xf bank_mask:0x3
v_add_f32_dpp v34, v70, v34 row_ror:8 row_mask:0xf bank_mask:0x3
v_add_f32_dpp v35, v71, v35 row_ror:8 row_mask:0xf bank_mask:0x3
s_nop 3
v_add_f32_dpp v32, v40, v36 row_ror:8 row_mask:0xf bank_mask:0xc
v_add_f32_dpp v33, v41, v37 row_ror:8 row_mask:0xf bank_mask:0xc
v_add_f32_dpp v34, v42, v38 row_ror:8 row_mask:0xf bank_mask:0xc
v_add_f32_dpp v35, v43, v39 row_ror:8 row_mask:0xf bank_mask:0xc
v_pk_mul_f32 v[32:33], v[32:33], v[64:65] op_sel_hi:[1,0]
v_pk_mul_f32 v[34:35], v[34:35], v[64:65] op_sel_hi:[1,0]
v_cvt_pk_bf16_f32 v20, v32, v33
v_cvt_pk_bf16_f32 v21, v34, v35
ds_write_b64 v12, v[20:21] offset:16384
s_branch Sr_maxdone
Sr_fin:
s_mov_b64 exec, s[48:49]
global_store_dword v2, v89, s[28:29] sc1
s_mov_b64 exec, -1
s_waitcnt vmcnt(0) lgkmcnt(0)
v_lshrrev_b32 v0, 4, v4
s_barrier
s_branch KB_next
S_worker:
s_cmp_eq_u32 s10, 0
s_cbranch_scc0 Sw_y2d
v_and_b32 v1, 7, v0
v_lshlrev_b32 v1, 8, v1
s_mov_b32 s19, 0
s_add_u32 s20, s8, 0x7000
s_addc_u32 s21, s9, 0
Sw_y2:
global_load_dword v4, v1, s[20:21] sc1
s_add_u32 s19, s19, 1
s_cmp_gt_u32 s19, 400000
s_cbranch_scc1 KB_fail
s_waitcnt vmcnt(0)
v_cmp_ge_u32 vcc, s13, v4
s_cbranch_vccz Sw_y2d
s_sleep 1
s_branch Sw_y2
Sw_y2d:
s_barrier
s_sub_u32 s36, s12, 1
s_mov_b32 s66, s36
s_add_u32 s67, s36, 1
s_mov_b32 s68, -1
Sw_F:
v_and_b32 v76, 15, v0
v_lshrrev_b32 v77, 4, v0
v_lshlrev_b32 v1, 4, v0
v_lshlrev_b32 v6, 2, v0
s_lshl_b32 s14, s11, 14
s_lshl_b32 s15, s10, 12
s_add_u32 s14, s14, s15
v_lshrrev_b32 v78, 3, v0
v_lshlrev_b32 v2, 13, v78
v_and_b32 v78, 7, v0
v_lshl_add_u32 v2, v78, 4, v2
v_and_b32 v78, 32, v0
v_lshlrev_b32 v78, 1, v78
v_xor_b32 v2, v78, v2
s_lshl_b32 s26, s10, 13
s_mov_b32 s36, s66
s_add_u32 s20, s8, s14
s_addc_u32 s21, s9, 0
s_add_u32 s20, s20, 0x280000
s_addc_u32 s21, s21, 0
s_lshl_b32 s14, s13, 21
s_lshl_b32 s15, s10, 19
s_add_u32 s15, s15, s14
s_lshl_b32 s16, s36, 7
s_add_u32 s15, s15, s16
s_add_u32 s28, s8, s15
s_addc_u32 s29, s9, 0
s_add_u32 s28, s28, 0xa00000
s_addc_u32 s29, s29, 0
global_load_dwordx4 v[8:11], v1, s[20:21] offset:0
global_load_dwordx4 v[12:15], v1, s[20:21] offset:1024
global_load_dwordx4 v[16:19], v1, s[20:21] offset:2048
global_load_dwordx4 v[20:23], v1, s[20:21] offset:3072
s_add_u32 m0, s26, 0
s_add_u32 s30, s28, 0x0
s_addc_u32 s31, s29, 0
global_load_lds_dwordx4 v2, s[30:31] sc1
s_add_u32 m0, s26, 1024
s_add_u32 s30, s28, 0x10000
s_addc_u32 s31, s29, 0
global_load_lds_dwordx4 v2, s[30:31] sc1
s_add_u32 m0, s26, 2048
s_add_u32 s30, s28, 0x20000
s_addc_u32 s31, s29, 0
global_load_lds_dwordx4 v2, s[30:31] sc1
s_add_u32 m0, s26, 3072
s_add_u32 s30, s28, 0x30000
s_addc_u32 s31, s29, 0
global_load_lds_dwordx4 v2, s[30:31] sc1
s_add_u32 m0, s26, 4096
s_add_u32 s30, s28, 0x40000
s_addc_u32 s31, s29, 0
global_load_lds_dwordx4 v2, s[30:31] sc1
s_add_u32 m0, s26, 5120
s_add_u32 s30, s28, 0x50000
s_addc_u32 s31, s29, 0
global_load_lds_dwordx4 v2, s[30:31] sc1
s_add_u32 m0, s26, 6144
s_add_u32 s30, s28, 0x60000
s_addc_u32 s31, s29, 0
global_load_lds_dwordx4 v2, s[30:31] sc1
s_add_u32 m0, s26, 7168
s_add_u32 s30, s28, 0x70000
s_addc_u32 s31, s29, 0
global_load_lds_dwordx4 v2, s[30:31] sc1
v_lshlrev_b32 v7, 9, v77
v_lshl_add_u32 v7, v76, 2, v7
v_and_b32 v78, 1, v77
v_lshl_add_u32 v7, v78, 6, v7
v_add_u32 v7, s26, v7
v_xor_b32 v84, 64, v7
v_lshrrev_b32 v78, 5, v0
v_bfe_u32 v79, v0, 2, 3
v_and_b32 v80, 3, v0
s_lshl_b32 s15, s36, 15
s_cmp_eq_u32 s13, 0
s_cbranch_scc0 Sw_F1_x2
v_lshlrev_b32 v5, 10, v79
v_lshl_add_u32 v5, v78, 4, v5
s_lshl_b32 s16, s10, 13
s_lshl_b32 s17, s11, 5
s_add_u32 s16, s16, s17
s_add_u32 s16, s16, s15
s_add_u32 s22, s4, s16
s_addc_u32 s23, s5, 0
s_branch Sw_F1_x3
Sw_F1_x2:
v_lshlrev_b32 v5, 4, v79
v_lshl_add_u32 v5, v78, 8, v5
s_lshr_b32 s16, s11, 3
s_lshl_b32 s16, s16, 13
s_and_b32 s17, s11, 7
s_lshl_b32 s17, s17, 9
s_add_u32 s16, s16, s17
s_lshr_b32 s17, s10, 1
s_lshl_b32 s17, s17, 12
s_add_u32 s16, s16, s17
s_and_b32 s17, s10, 1
s_lshl_b32 s17, s17, 7
s_add_u32 s16, s16, s17
s_add_u32 s16, s16, s15
s_add_u32 s22, s8, s16
s_addc_u32 s23, s9, 0
s_add_u32 s22, s22, 0x1200000
s_addc_u32 s23, s23, 0
Sw_F1_x3:
v_lshl_add_u32 v5, v80, 2, v5
global_load_dword v72, v5, s[22:23] sc1
global_load_dword v72, v5, s[22:23] sc1
s_lshl_b32 s16, s10, 13
s_lshl_b32 s17, s11, 8
s_add_u32 s16, s16, s17
s_add_u32 s16, s16, s15
s_add_u32 s16, s16, s14
s_add_u32 s24, s8, s16
s_addc_u32 s25, s9, 0
s_add_u32 s24, s24, 0xe00000
s_addc_u32 s25, s25, 0
v_add_u32 v3, s26, v1
v_lshrrev_b32 v4, 1, v80
v_lshl_add_u32 v4, v78, 1, v4
v_lshl_add_u32 v4, v4, 4, v79
v_lshlrev_b32 v4, 4, v4
v_and_b32 v80, 1, v0
v_lshl_add_u32 v4, v80, 3, v4
s_lshr_b32 s14, s10, 1
s_lshl_b32 s14, s14, 10
s_and_b32 s16, s10, 1
s_lshl_b32 s16, s16, 7
s_add_u32 s14, s14, s16
v_add_u32 v4, s14, v4
Sw_F1_l:
s_waitcnt vmcnt(8)
ds_read_b32 v24, v7 offset:0
ds_read_b32 v40, v84 offset:0
ds_read_b32 v25, v7 offset:128
ds_read_b32 v41, v84 offset:128
ds_read_b32 v26, v7 offset:256
ds_read_b32 v42, v84 offset:256
ds_read_b32 v27, v7 offset:384
ds_read_b32 v43, v84 offset:384
s_waitcnt vmcnt(6)
ds_read_b32 v28, v7 offset:2048
ds_read_b32 v44, v84 offset:2048
ds_read_b32 v29, v7 offset:2176
ds_read_b32 v45, v84 offset:2176
ds_read_b32 v30, v7 offset:2304
ds_read_b32 v46, v84 offset:2304
s_waitcnt lgkmcnt(13)
ds_read_b32 v31, v7 offset:2432
ds_read_b32 v47, v84 offset:2432
s_waitcnt lgkmcnt(8)
v_mfma_f32_16x16x32_bf16 v[56:59], v[8:11], v[24:27], 0
v_mfma_f32_16x16x32_bf16 v[60:63], v[8:11], v[40:43], 0
s_waitcnt vmcnt(4)
ds_read_b32 v32, v7 offset:4096
ds_read_b32 v48, v84 offset:4096
ds_read_b32 v33, v7 offset:4224
ds_read_b32 v49, v84 offset:4224
ds_read_b32 v34, v7 offset:4352
ds_read_b32 v50, v84 offset:4352
s_waitcnt lgkmcnt(13)
ds_read_b32 v35, v7 offset:4480
ds_read_b32 v51, v84 offset:4480
s_waitcnt lgkmcnt(8)
v_mfma_f32_16x16x32_bf16 v[56:59], v[12:15], v[28:31], v[56:59]
v_mfma_f32_16x16x32_bf16 v[60:63], v[12:15], v[44:47], v[60:63]
s_waitcnt vmcnt(2)
ds_read_b32 v36, v7 offset:6144
ds_read_b32 v52, v84 offset:6144
ds_read_b32 v37, v7 offset:6272
ds_read_b32 v53, v84 offset:6272
ds_read_b32 v38, v7 offset:6400
ds_read_b32 v54, v84 offset:6400
s_waitcnt lgkmcnt(13)
ds_read_b32 v39, v7 offset:6528
ds_read_b32 v55, v84 offset:6528
s_waitcnt lgkmcnt(8)
v_mfma_f32_16x16x32_bf16 v[56:59], v[16:19], v[32:35], v[56:59]
v_mfma_f32_16x16x32_bf16 v[60:63], v[16:19], v[48:51], v[60:63]
s_waitcnt lgkmcnt(0)
v_mfma_f32_16x16x32_bf16 v[56:59], v[20:23], v[36:39], v[56:59]
v_mfma_f32_16x16x32_bf16 v[60:63], v[20:23], v[52:55], v[60:63]
s_waitcnt vmcnt(1)
v_lshlrev_b32 v74, 16, v72
v_and_b32 v75, 0xffff0000, v72
s_add_u32 s36, s36, 7
s_cmp_lt_u32 s36, s67
s_cbranch_scc0 Sw_F1_nl
s_add_u32 s28, s28, 0x380
s_addc_u32 s29, s29, 0
s_add_u32 s22, s22, 0x38000
s_addc_u32 s23, s23, 0
s_add_u32 m0, s26, 0
s_add_u32 s30, s28, 0x0
s_addc_u32 s31, s29, 0
global_load_lds_dwordx4 v2, s[30:31] sc1
s_add_u32 m0, s26, 1024
s_add_u32 s30, s28, 0x10000
s_addc_u32 s31, s29, 0
global_load_lds_dwordx4 v2, s[30:31] sc1
s_add_u32 m0, s26, 2048
s_add_u32 s30, s28, 0x20000
s_addc_u32 s31, s29, 0
global_load_lds_dwordx4 v2, s[30:31] sc1
s_add_u32 m0, s26, 3072
s_add_u32 s30, s28, 0x30000
s_addc_u32 s31, s29, 0
global_load_lds_dwordx4 v2, s[30:31] sc1
s_add_u32 m0, s26, 4096
s_add_u32 s30, s28, 0x40000
s_addc_u32 s31, s29, 0
global_load_lds_dwordx4 v2, s[30:31] sc1
s_add_u32 m0, s26, 5120
s_add_u32 s30, s28, 0x50000
s_addc_u32 s31, s29, 0
global_load_lds_dwordx4 v2, s[30:31] sc1
Sw_F1_nl:
ds_write_b128 v3, v[56:59] offset:6144
s_nop 0
ds_write_b128 v3, v[60:63] offset:7168
s_waitcnt lgkmcnt(0)
s_barrier
ds_read_b64 v[64:65], v4 offset:6144
ds_read_b64 v[66:67], v4 offset:14336
ds_read_b64 v[68:69], v4 offset:22528
ds_read_b64 v[70:71], v4 offset:30720
s_waitcnt lgkmcnt(0)
s_cmp_lt_u32 s36, s67
s_cbranch_scc0 Sw_F1_n2
s_barrier
s_add_u32 m0, s26, 6144
s_add_u32 s30, s28, 0x60000
s_addc_u32 s31, s29, 0
global_load_lds_dwordx4 v2, s[30:31] sc1
s_add_u32 m0, s26, 7168
s_add_u32 s30, s28, 0x70000
s_addc_u32 s31, s29, 0
global_load_lds_dwordx4 v2, s[30:31] sc1
global_load_dword v72, v5, s[22:23] sc1
Sw_F1_n2:
v_pk_add_f32 v[64:65], v[64:65], v[66:67]
v_pk_add_f32 v[68:69], v[68:69], v[70:71]
v_pk_add_f32 v[64:65], v[64:65], v[68:69]
v_cvt_pk_bf16_f32 v64, v64, v65
v_lshlrev_b32 v66, 16, v64
v_and_b32 v67, 0xffff0000, v64
v_pk_add_f32 v[66:67], v[66:67], v[74:75]
v_cvt_pk_bf16_f32 v64, v66, v67
global_store_dword v6, v64, s[24:25] sc1
s_add_u32 s24, s24, 0x38000
s_addc_u32 s25, s25, 0
s_cmp_lt_u32 s36, s67
s_cbranch_scc1 Sw_F1_l
v_lshlrev_b32 v4, 4, v0
v_mov_b32 v20, 0x4444
v_mov_b32 v21, 0xeeee
s_mov_b32 s20, 0xff00ff00
s_mov_b32 s21, 0xff00ff00
v_cndmask_b32 v1, v20, v21, s[20:21]
s_lshl_b32 s20, s10, 15
s_add_u32 s20, s20, 32768
v_add_u32 v13, s20, v4
s_add_u32 s20, s10, 0
s_and_b32 s20, s20, 3
s_lshl_b32 s20, s20, 11
v_add_u32 v5, s20, v4
v_xor_b32 v9, 0x80, v5
s_add_u32 s20, s10, 1
s_and_b32 s20, s20, 3
s_lshl_b32 s20, s20, 11
v_add_u32 v6, s20, v4
v_xor_b32 v10, 0x80, v6
s_add_u32 s20, s10, 2
s_and_b32 s20, s20, 3
s_lshl_b32 s20, s20, 11
v_add_u32 v7, s20, v4
v_xor_b32 v11, 0x80, v7
s_add_u32 s20, s10, 3
s_and_b32 s20, s20, 3
s_lshl_b32 s20, s20, 11
v_add_u32 v8, s20, v4
v_xor_b32 v12, 0x80, v8
s_add_u32 s18, s18, 1
s_waitcnt vmcnt(0)
s_barrier
s_cmp_eq_u32 s10, 0
s_cbranch_scc0 Sw_g1_d
s_lshl_b32 s22, s12, 8
s_add_u32 s20, s8, s22
s_addc_u32 s21, s9, 0
s_add_u32 s20, s20, 0x1000
s_addc_u32 s21, s21, 0
v_mov_b32 v127, s18
v_and_b32 v126, 31, v0
v_lshlrev_b32 v126, 2, v126
v_cmp_eq_u32 vcc, s11, v0
s_mov_b64 exec, vcc
global_store_dword v126, v127, s[20:21] sc1
s_mov_b64 exec, -1
s_mov_b32 s19, 0
Sw_g1_p:
global_load_dword v127, v126, s[20:21] sc1
s_add_u32 s19, s19, 1
s_cmp_gt_u32 s19, 400000
s_cbranch_scc1 KB_fail
s_waitcnt vmcnt(0)
v_cmp_gt_u32 vcc, s18, v127
s_cbranch_vccnz Sw_g1_p
Sw_g1_d:
s_barrier
s_mov_b32 s36, s66
s_lshl_b32 s20, s36, 15
s_lshl_b32 s21, s13, 21
s_add_u32 s20, s20, s21
s_lshl_b32 s21, s10, 13
s_add_u32 s20, s20, s21
s_add_u32 s22, s8, s20
s_addc_u32 s23, s9, 0
s_add_u32 s22, s22, 0xe01000
s_addc_u32 s23, s23, 0
global_load_dwordx4 v[80:83], v4, s[22:23] offset:-4096 sc1
global_load_dwordx4 v[84:87], v4, s[22:23] offset:-3072 sc1
global_load_dwordx4 v[88:91], v4, s[22:23] offset:-2048 sc1
global_load_dwordx4 v[92:95], v4, s[22:23] offset:-1024 sc1
global_load_dwordx4 v[96:99], v4, s[22:23] offset:0 sc1
global_load_dwordx4 v[100:103], v4, s[22:23] offset:1024 sc1
global_load_dwordx4 v[104:107], v4, s[22:23] offset:2048 sc1
global_load_dwordx4 v[108:111], v4, s[22:23] offset:3072 sc1
Sw_F2:
v_mov_b64 v[16:17], 0
v_mov_b64 v[18:19], 0
v_mov_b64 v[20:21], 0
v_mov_b64 v[22:23], 0
v_mov_b64 v[24:25], 0
v_mov_b64 v[26:27], 0
v_mov_b64 v[28:29], 0
v_mov_b64 v[30:31], 0
v_mov_b64 v[32:33], 0
v_mov_b64 v[34:35], 0
v_mov_b64 v[36:37], 0
v_mov_b64 v[38:39], 0
v_mov_b64 v[40:41], 0
v_mov_b64 v[42:43], 0
v_mov_b64 v[44:45], 0
v_mov_b64 v[46:47], 0
v_mov_b64 v[48:49], 0
v_mov_b64 v[50:51], 0
v_mov_b64 v[52:53], 0
v_mov_b64 v[54:55], 0
v_mov_b64 v[56:57], 0
v_mov_b64 v[58:59], 0
v_mov_b64 v[60:61], 0
v_mov_b64 v[62:63], 0
v_mov_b64 v[64:65], 0
v_mov_b64 v[66:67], 0
v_mov_b64 v[68:69], 0
v_mov_b64 v[70:71], 0
v_mov_b64 v[72:73], 0
v_mov_b64 v[74:75], 0
v_mov_b64 v[76:77], 0
v_mov_b64 v[78:79], 0
v_mov_b32 v112, 0
v_mov_b32 v113, 0
v_mov_b32 v114, 0x3f803f80
s_lshl_b32 s20, s10, 13
v_add_u32 v14, s20, v4
s_cmp_eq_u32 s68, -1
s_cbranch_scc0 Sw_F2_st
s_waitcnt vmcnt(7)
v_dot2c_f32_bf16 v112, v80, v114
v_dot2c_f32_bf16 v113, v80, v80
v_dot2c_f32_bf16 v112, v81, v114
v_dot2c_f32_bf16 v113, v81, v81
v_dot2c_f32_bf16 v112, v82, v114
v_dot2c_f32_bf16 v113, v82, v82
v_dot2c_f32_bf16 v112, v83, v114
v_dot2c_f32_bf16 v113, v83, v83
s_waitcnt vmcnt(6)
v_dot2c_f32_bf16 v112, v84, v114
v_dot2c_f32_bf16 v113, v84, v84
v_dot2c_f32_bf16 v112, v85, v114
v_dot2c_f32_bf16 v113, v85, v85
v_dot2c_f32_bf16 v112, v86, v114
v_dot2c_f32_bf16 v113, v86, v86
v_dot2c_f32_bf16 v112, v87, v114
v_dot2c_f32_bf16 v113, v87, v87
s_waitcnt vmcnt(5)
v_dot2c_f32_bf16 v112, v88, v114
v_dot2c_f32_bf16 v113, v88, v88
v_dot2c_f32_bf16 v112, v89, v114
v_dot2c_f32_bf16 v113, v89, v89
v_dot2c_f32_bf16 v112, v90, v114
v_dot2c_f32_bf16 v113, v90, v90
v_dot2c_f32_bf16 v112, v91, v114
v_dot2c_f32_bf16 v113, v91, v91
s_waitcnt vmcnt(4)
v_dot2c_f32_bf16 v112, v92, v114
v_dot2c_f32_bf16 v113, v92, v92
v_dot2c_f32_bf16 v112, v93, v114
v_dot2c_f32_bf16 v113, v93, v93
v_dot2c_f32_bf16 v112, v94, v114
v_dot2c_f32_bf16 v113, v94, v94
v_dot2c_f32_bf16 v112, v95, v114
v_dot2c_f32_bf16 v113, v95, v95
s_waitcnt vmcnt(3)
v_dot2c_f32_bf16 v112, v96, v114
v_dot2c_f32_bf16 v113, v96, v96
v_dot2c_f32_bf16 v112, v97, v114
v_dot2c_f32_bf16 v113, v97, v97
v_dot2c_f32_bf16 v112, v98, v114
v_dot2c_f32_bf16 v113, v98, v98
v_dot2c_f32_bf16 v112, v99, v114
v_dot2c_f32_bf16 v113, v99, v99
s_waitcnt vmcnt(2)
v_dot2c_f32_bf16 v112, v100, v114
v_dot2c_f32_bf16 v113, v100, v100
v_dot2c_f32_bf16 v112, v101, v114
v_dot2c_f32_bf16 v113, v101, v101
v_dot2c_f32_bf16 v112, v102, v114
v_dot2c_f32_bf16 v113, v102, v102
v_dot2c_f32_bf16 v112, v103, v114
v_dot2c_f32_bf16 v113, v103, v103
s_waitcnt vmcnt(1)
v_dot2c_f32_bf16 v112, v104, v114
v_dot2c_f32_bf16 v113, v104, v104
v_dot2c_f32_bf16 v112, v105, v114
v_dot2c_f32_bf16 v113, v105, v105
v_dot2c_f32_bf16 v112, v106, v114
v_dot2c_f32_bf16 v113, v106, v106
v_dot2c_f32_bf16 v112, v107, v114
v_dot2c_f32_bf16 v113, v107, v107
s_waitcnt vmcnt(0)
v_dot2c_f32_bf16 v112, v108, v114
v_dot2c_f32_bf16 v113, v108, v108
v_dot2c_f32_bf16 v112, v109, v114
v_dot2c_f32_bf16 v113, v109, v109
v_dot2c_f32_bf16 v112, v110, v114
v_dot2c_f32_bf16 v113, v110, v110
v_dot2c_f32_bf16 v112, v111, v114
v_dot2c_f32_bf16 v113, v111, v111
s_branch Sw_F2_sd
Sw_F2_st:
s_waitcnt vmcnt(6)
v_dot2c_f32_bf16 v112, v80, v114
v_dot2c_f32_bf16 v113, v80, v80
v_dot2c_f32_bf16 v112, v81, v114
v_dot2c_f32_bf16 v113, v81, v81
v_dot2c_f32_bf16 v112, v82, v114
v_dot2c_f32_bf16 v113, v82, v82
v_dot2c_f32_bf16 v112, v83, v114
v_dot2c_f32_bf16 v113, v83, v83
v_dot2c_f32_bf16 v112, v84, v114
v_dot2c_f32_bf16 v113, v84, v84
v_dot2c_f32_bf16 v112, v85, v114
v_dot2c_f32_bf16 v113, v85, v85
v_dot2c_f32_bf16 v112, v86, v114
v_dot2c_f32_bf16 v113, v86, v86
v_dot2c_f32_bf16 v112, v87, v114
v_dot2c_f32_bf16 v113, v87, v87
v_dot2c_f32_bf16 v112, v88, v114
v_dot2c_f32_bf16 v113, v88, v88
v_dot2c_f32_bf16 v112, v89, v114
v_dot2c_f32_bf16 v113, v89, v89
v_dot2c_f32_bf16 v112, v90, v114
v_dot2c_f32_bf16 v113, v90, v90
v_dot2c_f32_bf16 v112, v91, v114
v_dot2c_f32_bf16 v113, v91, v91
v_dot2c_f32_bf16 v112, v92, v114
v_dot2c_f32_bf16 v113, v92, v92
v_dot2c_f32_bf16 v112, v93, v114
v_dot2c_f32_bf16 v113, v93, v93
v_dot2c_f32_bf16 v112, v94, v114
v_dot2c_f32_bf16 v113, v94, v94
v_dot2c_f32_bf16 v112, v95, v114
v_dot2c_f32_bf16 v113, v95, v95
v_dot2c_f32_bf16 v112, v96, v114
v_dot2c_f32_bf16 v113, v96, v96
v_dot2c_f32_bf16 v112, v97, v114
v_dot2c_f32_bf16 v113, v97, v97
v_dot2c_f32_bf16 v112, v98, v114
v_dot2c_f32_bf16 v113, v98, v98
v_dot2c_f32_bf16 v112, v99, v114
v_dot2c_f32_bf16 v113, v99, v99
v_dot2c_f32_bf16 v112, v100, v114
v_dot2c_f32_bf16 v113, v100, v100
v_dot2c_f32_bf16 v112, v101, v114
v_dot2c_f32_bf16 v113, v101, v101
v_dot2c_f32_bf16 v112, v102, v114
v_dot2c_f32_bf16 v113, v102, v102
v_dot2c_f32_bf16 v112, v103, v114
v_dot2c_f32_bf16 v113, v103, v103
v_dot2c_f32_bf16 v112, v104, v114
v_dot2c_f32_bf16 v113, v104, v104
v_dot2c_f32_bf16 v112, v105, v114
v_dot2c_f32_bf16 v113, v105, v105
v_dot2c_f32_bf16 v112, v106, v114
v_dot2c_f32_bf16 v113, v106, v106
v_dot2c_f32_bf16 v112, v107, v114
v_dot2c_f32_bf16 v113, v107, v107
v_dot2c_f32_bf16 v112, v108, v114
v_dot2c_f32_bf16 v113, v108, v108
v_dot2c_f32_bf16 v112, v109, v114
v_dot2c_f32_bf16 v113, v109, v109
v_dot2c_f32_bf16 v112, v110, v114
v_dot2c_f32_bf16 v113, v110, v110
v_dot2c_f32_bf16 v112, v111, v114
v_dot2c_f32_bf16 v113, v111, v111
Sw_F2_sd:
s_nop 1
v_add_f32_dpp v112, v112, v112 row_ror:8 row_mask:0xf bank_mask:0xf
v_mov_b32 v116, v112
s_nop 1
v_permlane16_swap_b32 v112, v116
v_add_f32 v112, v112, v116
v_mov_b32 v116, v112
s_nop 1
v_permlane32_swap_b32 v112, v116
v_add_f32 v112, v112, v116
v_add_f32_dpp v113, v113, v113 row_ror:8 row_mask:0xf bank_mask:0xf
v_mov_b32 v116, v113
s_nop 1
v_permlane16_swap_b32 v113, v116
v_add_f32 v113, v113, v116
v_mov_b32 v116, v113
s_nop 1
v_permlane32_swap_b32 v113, v116
v_add_f32 v113, v113, v116
v_mul_f32 v112, 0x3b000000, v112
v_mul_f32 v113, 0x3b000000, v113
v_fma_f32 v113, -v112, v112, v113
v_max_f32 v113, 0, v113
v_add_f32 v113, 0x3727c5ac, v113
v_rsq_f32 v113, v113
s_nop 0
v_mul_f32 v112, -v112, v113
v_lshlrev_b32 v116, 16, v80
v_and_b32 v117, 0xffff0000, v80
v_pk_fma_f32 v[116:117], v[116:117], v[112:113], v[112:113] op_sel:[0,1,0] op_sel_hi:[1,1,0]
v_cvt_pk_bf16_f32 v80, v116, v117
v_lshlrev_b32 v116, 16, v81
v_and_b32 v117, 0xffff0000, v81
v_pk_fma_f32 v[116:117], v[116:117], v[112:113], v[112:113] op_sel:[0,1,0] op_sel_hi:[1,1,0]
v_cvt_pk_bf16_f32 v81, v116, v117
v_lshlrev_b32 v116, 16, v82
v_and_b32 v117, 0xffff0000, v82
v_pk_fma_f32 v[116:117], v[116:117], v[112:113], v[112:113] op_sel:[0,1,0] op_sel_hi:[1,1,0]
v_cvt_pk_bf16_f32 v82, v116, v117
v_lshlrev_b32 v116, 16, v83
v_and_b32 v117, 0xffff0000, v83
v_pk_fma_f32 v[116:117], v[116:117], v[112:113], v[112:113] op_sel:[0,1,0] op_sel_hi:[1,1,0]
v_cvt_pk_bf16_f32 v83, v116, v117
ds_write_b128 v14, v[80:83] offset:0
v_lshlrev_b32 v116, 16, v84
v_and_b32 v117, 0xffff0000, v84
v_pk_fma_f32 v[116:117], v[116:117], v[112:113], v[112:113] op_sel:[0,1,0] op_sel_hi:[1,1,0]
v_cvt_pk_bf16_f32 v84, v116, v117
v_lshlrev_b32 v116, 16, v85
v_and_b32 v117, 0xffff0000, v85
v_pk_fma_f32 v[116:117], v[116:117], v[112:113], v[112:113] op_sel:[0,1,0] op_sel_hi:[1,1,0]
v_cvt_pk_bf16_f32 v85, v116, v117
v_lshlrev_b32 v116, 16, v86
v_and_b32 v117, 0xffff0000, v86
v_pk_fma_f32 v[116:117], v[116:117], v[112:113], v[112:113] op_sel:[0,1,0] op_sel_hi:[1,1,0]
v_cvt_pk_bf16_f32 v86, v116, v117
v_lshlrev_b32 v116, 16, v87
v_and_b32 v117, 0xffff0000, v87
v_pk_fma_f32 v[116:117], v[116:117], v[112:113], v[112:113] op_sel:[0,1,0] op_sel_hi:[1,1,0]
v_cvt_pk_bf16_f32 v87, v116, v117
ds_write_b128 v14, v[84:87] offset:1024
v_lshlrev_b32 v116, 16, v88
v_and_b32 v117, 0xffff0000, v88
v_pk_fma_f32 v[116:117], v[116:117], v[112:113], v[112:113] op_sel:[0,1,0] op_sel_hi:[1,1,0]
v_cvt_pk_bf16_f32 v88, v116, v117
v_lshlrev_b32 v116, 16, v89
v_and_b32 v117, 0xffff0000, v89
v_pk_fma_f32 v[116:117], v[116:117], v[112:113], v[112:113] op_sel:[0,1,0] op_sel_hi:[1,1,0]
v_cvt_pk_bf16_f32 v89, v116, v117
v_lshlrev_b32 v116, 16, v90
v_and_b32 v117, 0xffff0000, v90
v_pk_fma_f32 v[116:117], v[116:117], v[112:113], v[112:113] op_sel:[0,1,0] op_sel_hi:[1,1,0]
v_cvt_pk_bf16_f32 v90, v116, v117
v_lshlrev_b32 v116, 16, v91
v_and_b32 v117, 0xffff0000, v91
v_pk_fma_f32 v[116:117], v[116:117], v[112:113], v[112:113] op_sel:[0,1,0] op_sel_hi:[1,1,0]
v_cvt_pk_bf16_f32 v91, v116, v117
ds_write_b128 v14, v[88:91] offset:2048
v_lshlrev_b32 v116, 16, v92
v_and_b32 v117, 0xffff0000, v92
v_pk_fma_f32 v[116:117], v[116:117], v[112:113], v[112:113] op_sel:[0,1,0] op_sel_hi:[1,1,0]
v_cvt_pk_bf16_f32 v92, v116, v117
v_lshlrev_b32 v116, 16, v93
v_and_b32 v117, 0xffff0000, v93
v_pk_fma_f32 v[116:117], v[116:117], v[112:113], v[112:113] op_sel:[0,1,0] op_sel_hi:[1,1,0]
v_cvt_pk_bf16_f32 v93, v116, v117
v_lshlrev_b32 v116, 16, v94
v_and_b32 v117, 0xffff0000, v94
v_pk_fma_f32 v[116:117], v[116:117], v[112:113], v[112:113] op_sel:[0,1,0] op_sel_hi:[1,1,0]
v_cvt_pk_bf16_f32 v94, v116, v117
v_lshlrev_b32 v116, 16, v95
v_and_b32 v117, 0xffff0000, v95
v_pk_fma_f32 v[116:117], v[116:117], v[112:113], v[112:113] op_sel:[0,1,0] op_sel_hi:[1,1,0]
v_cvt_pk_bf16_f32 v95, v116, v117
ds_write_b128 v14, v[92:95] offset:3072
v_lshlrev_b32 v116, 16, v96
v_and_b32 v117, 0xffff0000, v96
v_pk_fma_f32 v[116:117], v[116:117], v[112:113], v[112:113] op_sel:[0,1,0] op_sel_hi:[1,1,0]
v_cvt_pk_bf16_f32 v96, v116, v117
v_lshlrev_b32 v116, 16, v97
v_and_b32 v117, 0xffff0000, v97
v_pk_fma_f32 v[116:117], v[116:117], v[112:113], v[112:113] op_sel:[0,1,0] op_sel_hi:[1,1,0]
v_cvt_pk_bf16_f32 v97, v116, v117
v_lshlrev_b32 v116, 16, v98
v_and_b32 v117, 0xffff0000, v98
v_pk_fma_f32 v[116:117], v[116:117], v[112:113], v[112:113] op_sel:[0,1,0] op_sel_hi:[1,1,0]
v_cvt_pk_bf16_f32 v98, v116, v117
v_lshlrev_b32 v116, 16, v99
v_and_b32 v117, 0xffff0000, v99
v_pk_fma_f32 v[116:117], v[116:117], v[112:113], v[112:113] op_sel:[0,1,0] op_sel_hi:[1,1,0]
v_cvt_pk_bf16_f32 v99, v116, v117
ds_write_b128 v14, v[96:99] offset:4096
v_lshlrev_b32 v116, 16, v100
v_and_b32 v117, 0xffff0000, v100
v_pk_fma_f32 v[116:117], v[116:117], v[112:113], v[112:113] op_sel:[0,1,0] op_sel_hi:[1,1,0]
v_cvt_pk_bf16_f32 v100, v116, v117
v_lshlrev_b32 v116, 16, v101
v_and_b32 v117, 0xffff0000, v101
v_pk_fma_f32 v[116:117], v[116:117], v[112:113], v[112:113] op_sel:[0,1,0] op_sel_hi:[1,1,0]
v_cvt_pk_bf16_f32 v101, v116, v117
v_lshlrev_b32 v116, 16, v102
v_and_b32 v117, 0xffff0000, v102
v_pk_fma_f32 v[116:117], v[116:117], v[112:113], v[112:113] op_sel:[0,1,0] op_sel_hi:[1,1,0]
v_cvt_pk_bf16_f32 v102, v116, v117
v_lshlrev_b32 v116, 16, v103
v_and_b32 v117, 0xffff0000, v103
v_pk_fma_f32 v[116:117], v[116:117], v[112:113], v[112:113] op_sel:[0,1,0] op_sel_hi:[1,1,0]
v_cvt_pk_bf16_f32 v103, v116, v117
ds_write_b128 v14, v[100:103] offset:5120
v_lshlrev_b32 v116, 16, v104
v_and_b32 v117, 0xffff0000, v104
v_pk_fma_f32 v[116:117], v[116:117], v[112:113], v[112:113] op_sel:[0,1,0] op_sel_hi:[1,1,0]
v_cvt_pk_bf16_f32 v104, v116, v117
v_lshlrev_b32 v116, 16, v105
v_and_b32 v117, 0xffff0000, v105
v_pk_fma_f32 v[116:117], v[116:117], v[112:113], v[112:113] op_sel:[0,1,0] op_sel_hi:[1,1,0]
v_cvt_pk_bf16_f32 v105, v116, v117
v_lshlrev_b32 v116, 16, v106
v_and_b32 v117, 0xffff0000, v106
v_pk_fma_f32 v[116:117], v[116:117], v[112:113], v[112:113] op_sel:[0,1,0] op_sel_hi:[1,1,0]
v_cvt_pk_bf16_f32 v106, v116, v117
v_lshlrev_b32 v116, 16, v107
v_and_b32 v117, 0xffff0000, v107
v_pk_fma_f32 v[116:117], v[116:117], v[112:113], v[112:113] op_sel:[0,1,0] op_sel_hi:[1,1,0]
v_cvt_pk_bf16_f32 v107, v116, v117
ds_write_b128 v14, v[104:107] offset:6144
v_lshlrev_b32 v116, 16, v108
v_and_b32 v117, 0xffff0000, v108
v_pk_fma_f32 v[116:117], v[116:117], v[112:113], v[112:113] op_sel:[0,1,0] op_sel_hi:[1,1,0]
v_cvt_pk_bf16_f32 v108, v116, v117
v_lshlrev_b32 v116, 16, v109
v_and_b32 v117, 0xffff0000, v109
v_pk_fma_f32 v[116:117], v[116:117], v[112:113], v[112:113] op_sel:[0,1,0] op_sel_hi:[1,1,0]
v_cvt_pk_bf16_f32 v109, v116, v117
v_lshlrev_b32 v116, 16, v110
v_and_b32 v117, 0xffff0000, v110
v_pk_fma_f32 v[116:117], v[116:117], v[112:113], v[112:113] op_sel:[0,1,0] op_sel_hi:[1,1,0]
v_cvt_pk_bf16_f32 v110, v116, v117
v_lshlrev_b32 v116, 16, v111
v_and_b32 v117, 0xffff0000, v111
v_pk_fma_f32 v[116:117], v[116:117], v[112:113], v[112:113] op_sel:[0,1,0] op_sel_hi:[1,1,0]
v_cvt_pk_bf16_f32 v111, v116, v117
ds_write_b128 v14, v[108:111] offset:7168
s_waitcnt lgkmcnt(0)
s_barrier
ds_read_b128 v[112:115], v13 offset:8192
ds_read_b128 v[116:119], v13 offset:9216
ds_read_b128 v[80:83], v5 offset:0
ds_read_b128 v[84:87], v5 offset:8192
ds_read_b128 v[88:91], v5 offset:16384
ds_read_b128 v[92:95], v5 offset:24576
ds_read_b128 v[120:123], v13 offset:10240
ds_read_b128 v[124:127], v13 offset:11264
s_waitcnt lgkmcnt(5)
v_smfmac_f32_16x16x64_bf16 v[16:19], v[80:83], v[112:119], v1
s_waitcnt lgkmcnt(4)
v_smfmac_f32_16x16x64_bf16 v[20:23], v[84:87], v[112:119], v1
s_waitcnt lgkmcnt(3)
v_smfmac_f32_16x16x64_bf16 v[24:27], v[88:91], v[112:119], v1
s_waitcnt lgkmcnt(2)
v_smfmac_f32_16x16x64_bf16 v[28:31], v[92:95], v[112:119], v1
ds_read_b128 v[112:115], v13 offset:16384
ds_read_b128 v[116:119], v13 offset:17408
s_waitcnt lgkmcnt(2)
v_smfmac_f32_16x16x64_bf16 v[32:35], v[80:83], v[120:127], v1
ds_read_b128 v[96:99], v9 offset:0
v_smfmac_f32_16x16x64_bf16 v[36:39], v[84:87], v[120:127], v1
ds_read_b128 v[100:103], v9 offset:8192
v_smfmac_f32_16x16x64_bf16 v[40:43], v[88:91], v[120:127], v1
ds_read_b128 v[104:107], v9 offset:16384
v_smfmac_f32_16x16x64_bf16 v[44:47], v[92:95], v[120:127], v1
ds_read_b128 v[108:111], v9 offset:24576
ds_read_b128 v[120:123], v13 offset:18432
ds_read_b128 v[124:127], v13 offset:19456
s_waitcnt lgkmcnt(6)
v_smfmac_f32_16x16x64_bf16 v[48:51], v[80:83], v[112:119], v1
v_smfmac_f32_16x16x64_bf16 v[52:55], v[84:87], v[112:119], v1
v_smfmac_f32_16x16x64_bf16 v[56:59], v[88:91], v[112:119], v1
v_smfmac_f32_16x16x64_bf16 v[60:63], v[92:95], v[112:119], v1
ds_read_b128 v[112:115], v13 offset:12288
ds_read_b128 v[116:119], v13 offset:13312
s_waitcnt lgkmcnt(2)
v_smfmac_f32_16x16x64_bf16 v[64:67], v[80:83], v[120:127], v1
ds_read_b128 v[80:83], v5 offset:1024
v_smfmac_f32_16x16x64_bf16 v[68:71], v[84:87], v[120:127], v1
ds_read_b128 v[84:87], v5 offset:9216
v_smfmac_f32_16x16x64_bf16 v[72:75], v[88:91], v[120:127], v1
ds_read_b128 v[88:91], v5 offset:17408
v_smfmac_f32_16x16x64_bf16 v[76:79], v[92:95], v[120:127], v1
ds_read_b128 v[92:95], v5 offset:25600
ds_read_b128 v[120:123], v13 offset:14336
ds_read_b128 v[124:127], v13 offset:15360
v_smfmac_f32_16x16x64_bf16 v[16:19], v[96:99], a[200:207], v1
v_smfmac_f32_16x16x64_bf16 v[20:23], v[100:103], a[200:207], v1
v_smfmac_f32_16x16x64_bf16 v[24:27], v[104:107], a[200:207], v1
v_smfmac_f32_16x16x64_bf16 v[28:31], v[108:111], a[200:207], v1
v_smfmac_f32_16x16x64_bf16 v[32:35], v[96:99], a[208:215], v1
v_smfmac_f32_16x16x64_bf16 v[36:39], v[100:103], a[208:215], v1
v_smfmac_f32_16x16x64_bf16 v[40:43], v[104:107], a[208:215], v1
v_smfmac_f32_16x16x64_bf16 v[44:47], v[108:111], a[208:215], v1
s_waitcnt lgkmcnt(5)
v_smfmac_f32_16x16x64_bf16 v[16:19], v[80:83], v[112:119], v1
s_waitcnt lgkmcnt(4)
v_smfmac_f32_16x16x64_bf16 v[20:23], v[84:87], v[112:119], v1
s_waitcnt lgkmcnt(3)
v_smfmac_f32_16x16x64_bf16 v[24:27], v[88:91], v[112:119], v1
s_waitcnt lgkmcnt(2)
v_smfmac_f32_16x16x64_bf16 v[28:31], v[92:95], v[112:119], v1
ds_read_b128 v[112:115], v13 offset:20480
ds_read_b128 v[116:119], v13 offset:21504
s_waitcnt lgkmcnt(2)
v_smfmac_f32_16x16x64_bf16 v[32:35], v[80:83], v[120:127], v1
ds_read_b128 v[96:99], v9 offset:1024
v_smfmac_f32_16x16x64_bf16 v[36:39], v[84:87], v[120:127], v1
ds_read_b128 v[100:103], v9 offset:9216
v_smfmac_f32_16x16x64_bf16 v[40:43], v[88:91], v[120:127], v1
ds_read_b128 v[104:107], v9 offset:17408
v_smfmac_f32_16x16x64_bf16 v[44:47], v[92:95], v[120:127], v1
ds_read_b128 v[108:111], v9 offset:25600
ds_read_b128 v[120:123], v13 offset:22528
ds_read_b128 v[124:127], v13 offset:23552
v_smfmac_f32_16x16x64_bf16 v[48:51], v[80:83], a[232:239], v1
v_smfmac_f32_16x16x64_bf16 v[52:55], v[84:87], a[232:239], v1
v_smfmac_f32_16x16x64_bf16 v[56:59], v[88:91], a[232:239], v1
v_smfmac_f32_16x16x64_bf16 v[60:63], v[92:95], a[232:239], v1
v_smfmac_f32_16x16x64_bf16 v[64:67], v[80:83], a[240:247], v1
ds_read_b128 v[80:83], v6 offset:0
v_smfmac_f32_16x16x64_bf16 v[68:71], v[84:87], a[240:247], v1
ds_read_b128 v[84:87], v6 offset:8192
v_smfmac_f32_16x16x64_bf16 v[72:75], v[88:91], a[240:247], v1
ds_read_b128 v[88:91], v6 offset:16384
v_smfmac_f32_16x16x64_bf16 v[76:79], v[92:95], a[240:247], v1
ds_read_b128 v[92:95], v6 offset:24576
s_waitcnt lgkmcnt(9)
v_smfmac_f32_16x16x64_bf16 v[16:19], v[96:99], a[216:223], v1
s_waitcnt lgkmcnt(8)
v_smfmac_f32_16x16x64_bf16 v[20:23], v[100:103], a[216:223], v1
s_waitcnt lgkmcnt(7)
v_smfmac_f32_16x16x64_bf16 v[24:27], v[104:107], a[216:223], v1
s_waitcnt lgkmcnt(6)
v_smfmac_f32_16x16x64_bf16 v[28:31], v[108:111], a[216:223], v1
v_smfmac_f32_16x16x64_bf16 v[32:35], v[96:99], a[224:231], v1
v_smfmac_f32_16x16x64_bf16 v[36:39], v[100:103], a[224:231], v1
v_smfmac_f32_16x16x64_bf16 v[40:43], v[104:107], a[224:231], v1
v_smfmac_f32_16x16x64_bf16 v[44:47], v[108:111], a[224:231], v1
s_waitcnt lgkmcnt(3)
v_smfmac_f32_16x16x64_bf16 v[16:19], v[80:83], v[232:239], v1
s_waitcnt lgkmcnt(2)
v_smfmac_f32_16x16x64_bf16 v[20:23], v[84:87], v[232:239], v1
s_waitcnt lgkmcnt(1)
v_smfmac_f32_16x16x64_bf16 v[24:27], v[88:91], v[232:239], v1
s_waitcnt lgkmcnt(0)
v_smfmac_f32_16x16x64_bf16 v[28:31], v[92:95], v[232:239], v1
v_smfmac_f32_16x16x64_bf16 v[32:35], v[80:83], v[240:247], v1
ds_read_b128 v[96:99], v10 offset:0
v_smfmac_f32_16x16x64_bf16 v[36:39], v[84:87], v[240:247], v1
ds_read_b128 v[100:103], v10 offset:8192
v_smfmac_f32_16x16x64_bf16 v[40:43], v[88:91], v[240:247], v1
ds_read_b128 v[104:107], v10 offset:16384
v_smfmac_f32_16x16x64_bf16 v[44:47], v[92:95], v[240:247], v1
ds_read_b128 v[108:111], v10 offset:24576
v_smfmac_f32_16x16x64_bf16 v[48:51], v[80:83], v[112:119], v1
v_smfmac_f32_16x16x64_bf16 v[52:55], v[84:87], v[112:119], v1
v_smfmac_f32_16x16x64_bf16 v[56:59], v[88:91], v[112:119], v1
v_smfmac_f32_16x16x64_bf16 v[60:63], v[92:95], v[112:119], v1
ds_read_b128 v[112:115], v13 offset:24576
ds_read_b128 v[116:119], v13 offset:25600
v_smfmac_f32_16x16x64_bf16 v[64:67], v[80:83], v[120:127], v1
ds_read_b128 v[80:83], v6 offset:1024
v_smfmac_f32_16x16x64_bf16 v[68:71], v[84:87], v[120:127], v1
ds_read_b128 v[84:87], v6 offset:9216
v_smfmac_f32_16x16x64_bf16 v[72:75], v[88:91], v[120:127], v1
ds_read_b128 v[88:91], v6 offset:17408
v_smfmac_f32_16x16x64_bf16 v[76:79], v[92:95], v[120:127], v1
ds_read_b128 v[92:95], v6 offset:25600
ds_read_b128 v[120:123], v13 offset:0
ds_read_b128 v[124:127], v13 offset:1024
s_waitcnt lgkmcnt(11)
v_smfmac_f32_16x16x64_bf16 v[16:19], v[96:99], v[248:255], v1
s_waitcnt lgkmcnt(10)
v_smfmac_f32_16x16x64_bf16 v[20:23], v[100:103], v[248:255], v1
s_waitcnt lgkmcnt(9)
v_smfmac_f32_16x16x64_bf16 v[24:27], v[104:107], v[248:255], v1
s_waitcnt lgkmcnt(8)
v_smfmac_f32_16x16x64_bf16 v[28:31], v[108:111], v[248:255], v1
v_smfmac_f32_16x16x64_bf16 v[32:35], v[96:99], a[0:7], v1
v_smfmac_f32_16x16x64_bf16 v[36:39], v[100:103], a[0:7], v1
v_smfmac_f32_16x16x64_bf16 v[40:43], v[104:107], a[0:7], v1
v_smfmac_f32_16x16x64_bf16 v[44:47], v[108:111], a[0:7], v1
s_waitcnt lgkmcnt(5)
v_smfmac_f32_16x16x64_bf16 v[16:19], v[80:83], a[104:111], v1
s_waitcnt lgkmcnt(4)
v_smfmac_f32_16x16x64_bf16 v[20:23], v[84:87], a[104:111], v1
s_waitcnt lgkmcnt(3)
v_smfmac_f32_16x16x64_bf16 v[24:27], v[88:91], a[104:111], v1
s_waitcnt lgkmcnt(2)
v_smfmac_f32_16x16x64_bf16 v[28:31], v[92:95], a[104:111], v1
v_smfmac_f32_16x16x64_bf16 v[32:35], v[80:83], a[112:119], v1
ds_read_b128 v[96:99], v10 offset:1024
v_smfmac_f32_16x16x64_bf16 v[36:39], v[84:87], a[112:119], v1
ds_read_b128 v[100:103], v10 offset:9216
v_smfmac_f32_16x16x64_bf16 v[40:43], v[88:91], a[112:119], v1
ds_read_b128 v[104:107], v10 offset:17408
v_smfmac_f32_16x16x64_bf16 v[44:47], v[92:95], a[112:119], v1
ds_read_b128 v[108:111], v10 offset:25600
v_smfmac_f32_16x16x64_bf16 v[48:51], v[80:83], v[112:119], v1
v_smfmac_f32_16x16x64_bf16 v[52:55], v[84:87], v[112:119], v1
v_smfmac_f32_16x16x64_bf16 v[56:59], v[88:91], v[112:119], v1
v_smfmac_f32_16x16x64_bf16 v[60:63], v[92:95], v[112:119], v1
ds_read_b128 v[112:115], v13 offset:2048
ds_read_b128 v[116:119], v13 offset:3072
v_smfmac_f32_16x16x64_bf16 v[64:67], v[80:83], a[248:255], v1
ds_read_b128 v[80:83], v7 offset:0
v_smfmac_f32_16x16x64_bf16 v[68:71], v[84:87], a[248:255], v1
ds_read_b128 v[84:87], v7 offset:8192
v_smfmac_f32_16x16x64_bf16 v[72:75], v[88:91], a[248:255], v1
ds_read_b128 v[88:91], v7 offset:16384
v_smfmac_f32_16x16x64_bf16 v[76:79], v[92:95], a[248:255], v1
ds_read_b128 v[92:95], v7 offset:24576
s_waitcnt lgkmcnt(9)
v_smfmac_f32_16x16x64_bf16 v[16:19], v[96:99], a[120:127], v1
s_waitcnt lgkmcnt(8)
v_smfmac_f32_16x16x64_bf16 v[20:23], v[100:103], a[120:127], v1
s_waitcnt lgkmcnt(7)
v_smfmac_f32_16x16x64_bf16 v[24:27], v[104:107], a[120:127], v1
s_waitcnt lgkmcnt(6)
v_smfmac_f32_16x16x64_bf16 v[28:31], v[108:111], a[120:127], v1
v_smfmac_f32_16x16x64_bf16 v[32:35], v[96:99], v[120:127], v1
v_smfmac_f32_16x16x64_bf16 v[36:39], v[100:103], v[120:127], v1
v_smfmac_f32_16x16x64_bf16 v[40:43], v[104:107], v[120:127], v1
v_smfmac_f32_16x16x64_bf16 v[44:47], v[108:111], v[120:127], v1
ds_read_b128 v[120:123], v13 offset:4096
ds_read_b128 v[124:127], v13 offset:5120
s_waitcnt lgkmcnt(5)
v_smfmac_f32_16x16x64_bf16 v[16:19], v[80:83], a[128:135], v1
s_waitcnt lgkmcnt(4)
v_smfmac_f32_16x16x64_bf16 v[20:23], v[84:87], a[128:135], v1
s_waitcnt lgkmcnt(3)
v_smfmac_f32_16x16x64_bf16 v[24:27], v[88:91], a[128:135], v1
s_waitcnt lgkmcnt(2)
v_smfmac_f32_16x16x64_bf16 v[28:31], v[92:95], a[128:135], v1
v_smfmac_f32_16x16x64_bf16 v[32:35], v[80:83], a[136:143], v1
ds_read_b128 v[96:99], v11 offset:0
v_smfmac_f32_16x16x64_bf16 v[36:39], v[84:87], a[136:143], v1
ds_read_b128 v[100:103], v11 offset:8192
v_smfmac_f32_16x16x64_bf16 v[40:43], v[88:91], a[136:143], v1
ds_read_b128 v[104:107], v11 offset:16384
v_smfmac_f32_16x16x64_bf16 v[44:47], v[92:95], a[136:143], v1
ds_read_b128 v[108:111], v11 offset:24576
v_smfmac_f32_16x16x64_bf16 v[48:51], v[80:83], a[40:47], v1
v_smfmac_f32_16x16x64_bf16 v[52:55], v[84:87], a[40:47], v1
v_smfmac_f32_16x16x64_bf16 v[56:59], v[88:91], a[40:47], v1
v_smfmac_f32_16x16x64_bf16 v[60:63], v[92:95], a[40:47], v1
v_smfmac_f32_16x16x64_bf16 v[64:67], v[80:83], a[48:55], v1
ds_read_b128 v[80:83], v7 offset:1024
v_smfmac_f32_16x16x64_bf16 v[68:71], v[84:87], a[48:55], v1
ds_read_b128 v[84:87], v7 offset:9216
v_smfmac_f32_16x16x64_bf16 v[72:75], v[88:91], a[48:55], v1
ds_read_b128 v[88:91], v7 offset:17408
v_smfmac_f32_16x16x64_bf16 v[76:79], v[92:95], a[48:55], v1
ds_read_b128 v[92:95], v7 offset:25600
s_waitcnt lgkmcnt(7)
v_smfmac_f32_16x16x64_bf16 v[16:19], v[96:99], a[144:151], v1
s_waitcnt lgkmcnt(6)
v_smfmac_f32_16x16x64_bf16 v[20:23], v[100:103], a[144:151], v1
s_waitcnt lgkmcnt(5)
v_smfmac_f32_16x16x64_bf16 v[24:27], v[104:107], a[144:151], v1
s_waitcnt lgkmcnt(4)
v_smfmac_f32_16x16x64_bf16 v[28:31], v[108:111], a[144:151], v1
v_smfmac_f32_16x16x64_bf16 v[32:35], v[96:99], v[112:119], v1
v_smfmac_f32_16x16x64_bf16 v[36:39], v[100:103], v[112:119], v1
v_smfmac_f32_16x16x64_bf16 v[40:43], v[104:107], v[112:119], v1
v_smfmac_f32_16x16x64_bf16 v[44:47], v[108:111], v[112:119], v1
ds_read_b128 v[112:115], v13 offset:6144
ds_read_b128 v[116:119], v13 offset:7168
s_waitcnt lgkmcnt(5)
v_smfmac_f32_16x16x64_bf16 v[16:19], v[80:83], a[152:159], v1
s_waitcnt lgkmcnt(4)
v_smfmac_f32_16x16x64_bf16 v[20:23], v[84:87], a[152:159], v1
s_waitcnt lgkmcnt(3)
v_smfmac_f32_16x16x64_bf16 v[24:27], v[88:91], a[152:159], v1
s_waitcnt lgkmcnt(2)
v_smfmac_f32_16x16x64_bf16 v[28:31], v[92:95], a[152:159], v1
v_smfmac_f32_16x16x64_bf16 v[32:35], v[80:83], a[160:167], v1
ds_read_b128 v[96:99], v11 offset:1024
v_smfmac_f32_16x16x64_bf16 v[36:39], v[84:87], a[160:167], v1
ds_read_b128 v[100:103], v11 offset:9216
v_smfmac_f32_16x16x64_bf16 v[40:43], v[88:91], a[160:167], v1
ds_read_b128 v[104:107], v11 offset:17408
v_smfmac_f32_16x16x64_bf16 v[44:47], v[92:95], a[160:167], v1
ds_read_b128 v[108:111], v11 offset:25600
v_smfmac_f32_16x16x64_bf16 v[48:51], v[80:83], a[56:63], v1
v_smfmac_f32_16x16x64_bf16 v[52:55], v[84:87], a[56:63], v1
v_smfmac_f32_16x16x64_bf16 v[56:59], v[88:91], a[56:63], v1
v_smfmac_f32_16x16x64_bf16 v[60:63], v[92:95], a[56:63], v1
v_smfmac_f32_16x16x64_bf16 v[64:67], v[80:83], a[64:71], v1
ds_read_b128 v[80:83], v8 offset:0
v_smfmac_f32_16x16x64_bf16 v[68:71], v[84:87], a[64:71], v1
ds_read_b128 v[84:87], v8 offset:8192
v_smfmac_f32_16x16x64_bf16 v[72:75], v[88:91], a[64:71], v1
ds_read_b128 v[88:91], v8 offset:16384
v_smfmac_f32_16x16x64_bf16 v[76:79], v[92:95], a[64:71], v1
ds_read_b128 v[92:95], v8 offset:24576
s_waitcnt lgkmcnt(7)
v_smfmac_f32_16x16x64_bf16 v[16:19], v[96:99], a[168:175], v1
s_waitcnt lgkmcnt(6)
v_smfmac_f32_16x16x64_bf16 v[20:23], v[100:103], a[168:175], v1
s_waitcnt lgkmcnt(5)
v_smfmac_f32_16x16x64_bf16 v[24:27], v[104:107], a[168:175], v1
s_waitcnt lgkmcnt(4)
v_smfmac_f32_16x16x64_bf16 v[28:31], v[108:111], a[168:175], v1
v_smfmac_f32_16x16x64_bf16 v[32:35], v[96:99], v[120:127], v1
v_smfmac_f32_16x16x64_bf16 v[36:39], v[100:103], v[120:127], v1
v_smfmac_f32_16x16x64_bf16 v[40:43], v[104:107], v[120:127], v1
v_smfmac_f32_16x16x64_bf16 v[44:47], v[108:111], v[120:127], v1
s_waitcnt lgkmcnt(3)
v_smfmac_f32_16x16x64_bf16 v[16:19], v[80:83], a[8:15], v1
s_waitcnt lgkmcnt(2)
v_smfmac_f32_16x16x64_bf16 v[20:23], v[84:87], a[8:15], v1
s_waitcnt lgkmcnt(1)
v_smfmac_f32_16x16x64_bf16 v[24:27], v[88:91], a[8:15], v1
s_waitcnt lgkmcnt(0)
v_smfmac_f32_16x16x64_bf16 v[28:31], v[92:95], a[8:15], v1
v_smfmac_f32_16x16x64_bf16 v[32:35], v[80:83], a[16:23], v1
ds_read_b128 v[96:99], v12 offset:0
v_smfmac_f32_16x16x64_bf16 v[36:39], v[84:87], a[16:23], v1
ds_read_b128 v[100:103], v12 offset:8192
v_smfmac_f32_16x16x64_bf16 v[40:43], v[88:91], a[16:23], v1
ds_read_b128 v[104:107], v12 offset:16384
v_smfmac_f32_16x16x64_bf16 v[44:47], v[92:95], a[16:23], v1
ds_read_b128 v[108:111], v12 offset:24576
v_smfmac_f32_16x16x64_bf16 v[48:51], v[80:83], a[72:79], v1
v_smfmac_f32_16x16x64_bf16 v[52:55], v[84:87], a[72:79], v1
v_smfmac_f32_16x16x64_bf16 v[56:59], v[88:91], a[72:79], v1
v_smfmac_f32_16x16x64_bf16 v[60:63], v[92:95], a[72:79], v1
v_smfmac_f32_16x16x64_bf16 v[64:67], v[80:83], a[80:87], v1
ds_read_b128 v[80:83], v8 offset:1024
v_smfmac_f32_16x16x64_bf16 v[68:71], v[84:87], a[80:87], v1
ds_read_b128 v[84:87], v8 offset:9216
v_smfmac_f32_16x16x64_bf16 v[72:75], v[88:91], a[80:87], v1
ds_read_b128 v[88:91], v8 offset:17408
v_smfmac_f32_16x16x64_bf16 v[76:79], v[92:95], a[80:87], v1
ds_read_b128 v[92:95], v8 offset:25600
s_waitcnt lgkmcnt(7)
v_smfmac_f32_16x16x64_bf16 v[16:19], v[96:99], a[24:31], v1
s_waitcnt lgkmcnt(6)
v_smfmac_f32_16x16x64_bf16 v[20:23], v[100:103], a[24:31], v1
s_waitcnt lgkmcnt(5)
v_smfmac_f32_16x16x64_bf16 v[24:27], v[104:107], a[24:31], v1
s_waitcnt lgkmcnt(4)
v_smfmac_f32_16x16x64_bf16 v[28:31], v[108:111], a[24:31], v1
v_smfmac_f32_16x16x64_bf16 v[32:35], v[96:99], a[32:39], v1
v_smfmac_f32_16x16x64_bf16 v[36:39], v[100:103], a[32:39], v1
v_smfmac_f32_16x16x64_bf16 v[40:43], v[104:107], a[32:39], v1
v_smfmac_f32_16x16x64_bf16 v[44:47], v[108:111], a[32:39], v1
s_waitcnt lgkmcnt(3)
v_smfmac_f32_16x16x64_bf16 v[16:19], v[80:83], a[176:183], v1
s_waitcnt lgkmcnt(2)
v_smfmac_f32_16x16x64_bf16 v[20:23], v[84:87], a[176:183], v1
s_waitcnt lgkmcnt(1)
v_smfmac_f32_16x16x64_bf16 v[24:27], v[88:91], a[176:183], v1
s_waitcnt lgkmcnt(0)
v_smfmac_f32_16x16x64_bf16 v[28:31], v[92:95], a[176:183], v1
v_smfmac_f32_16x16x64_bf16 v[32:35], v[80:83], a[184:191], v1
ds_read_b128 v[96:99], v12 offset:1024
v_smfmac_f32_16x16x64_bf16 v[36:39], v[84:87], a[184:191], v1
ds_read_b128 v[100:103], v12 offset:9216
v_smfmac_f32_16x16x64_bf16 v[40:43], v[88:91], a[184:191], v1
ds_read_b128 v[104:107], v12 offset:17408
v_smfmac_f32_16x16x64_bf16 v[44:47], v[92:95], a[184:191], v1
ds_read_b128 v[108:111], v12 offset:25600
v_smfmac_f32_16x16x64_bf16 v[48:51], v[80:83], a[88:95], v1
v_smfmac_f32_16x16x64_bf16 v[52:55], v[84:87], a[88:95], v1
v_smfmac_f32_16x16x64_bf16 v[56:59], v[88:91], a[88:95], v1
v_smfmac_f32_16x16x64_bf16 v[60:63], v[92:95], a[88:95], v1
v_smfmac_f32_16x16x64_bf16 v[64:67], v[80:83], a[96:103], v1
v_smfmac_f32_16x16x64_bf16 v[68:71], v[84:87], a[96:103], v1
v_smfmac_f32_16x16x64_bf16 v[72:75], v[88:91], a[96:103], v1
v_smfmac_f32_16x16x64_bf16 v[76:79], v[92:95], a[96:103], v1
s_waitcnt lgkmcnt(3)
v_smfmac_f32_16x16x64_bf16 v[16:19], v[96:99], v[112:119], v1
s_waitcnt lgkmcnt(2)
v_smfmac_f32_16x16x64_bf16 v[20:23], v[100:103], v[112:119], v1
s_waitcnt lgkmcnt(1)
v_smfmac_f32_16x16x64_bf16 v[24:27], v[104:107], v[112:119], v1
s_waitcnt lgkmcnt(0)
v_smfmac_f32_16x16x64_bf16 v[28:31], v[108:111], v[112:119], v1
v_smfmac_f32_16x16x64_bf16 v[32:35], v[96:99], a[192:199], v1
v_smfmac_f32_16x16x64_bf16 v[36:39], v[100:103], a[192:199], v1
v_smfmac_f32_16x16x64_bf16 v[40:43], v[104:107], a[192:199], v1
v_smfmac_f32_16x16x64_bf16 v[44:47], v[108:111], a[192:199], v1
s_waitcnt vmcnt(0)
s_barrier
s_cmp_eq_u32 s68, -1
s_cbranch_scc1 Sw_F2_np
s_cmp_eq_u32 s10, 0
s_cbranch_scc0 Sw_F2_pf
s_lshl_b32 s22, s68, 2
s_add_u32 s20, s8, s22
s_addc_u32 s21, s9, 0
s_add_u32 s20, s20, 0x2000
s_addc_u32 s21, s21, 0
s_add_u32 s22, s13, 1
v_mov_b32 v126, 0
v_mov_b32 v127, s22
s_mov_b64 exec, 1
global_store_dword v126, v127, s[20:21] sc1
s_mov_b64 exec, -1
Sw_F2_pf:
Sw_F2_np:
s_add_u32 s17, s36, 7
s_cmp_lt_u32 s17, s67
s_cbranch_scc0 Sw_F2_nx
s_lshl_b32 s20, s17, 15
s_lshl_b32 s21, s13, 21
s_add_u32 s20, s20, s21
s_lshl_b32 s21, s10, 13
s_add_u32 s20, s20, s21
s_add_u32 s22, s8, s20
s_addc_u32 s23, s9, 0
s_add_u32 s22, s22, 0xe01000
s_addc_u32 s23, s23, 0
global_load_dwordx4 v[80:83], v4, s[22:23] offset:-4096 sc1
global_load_dwordx4 v[84:87], v4, s[22:23] offset:-3072 sc1
global_load_dwordx4 v[88:91], v4, s[22:23] offset:-2048 sc1
global_load_dwordx4 v[92:95], v4, s[22:23] offset:-1024 sc1
global_load_dwordx4 v[96:99], v4, s[22:23] offset:0 sc1
global_load_dwordx4 v[100:103], v4, s[22:23] offset:1024 sc1
global_load_dwordx4 v[104:107], v4, s[22:23] offset:2048 sc1
global_load_dwordx4 v[108:111], v4, s[22:23] offset:3072 sc1
Sw_F2_nx:
v_and_b32 v124, 15, v0
v_lshrrev_b32 v125, 4, v0
v_lshlrev_b32 v120, 2, v125
v_sub_u32 v120, v124, v120
v_cmp_gt_u32 vcc, 2, v125
s_nop 1
v_cndmask_b32 v121, 64, v120, vcc
v_add_u32 v120, 8, v120
v_cndmask_b32 v122, v120, 64, vcc
v_mov_b32 v126, 0x3f80
v_mov_b32 v127, 0x3f800000
v_cmp_eq_u32 vcc, 0, v121
s_nop 1
v_cndmask_b32 v112, 0, v126, vcc
v_cmp_eq_u32 vcc, 1, v121
s_nop 1
v_cndmask_b32 v112, v112, v127, vcc
v_cmp_eq_u32 vcc, 2, v121
s_nop 1
v_cndmask_b32 v113, 0, v126, vcc
v_cmp_eq_u32 vcc, 3, v121
s_nop 1
v_cndmask_b32 v113, v113, v127, vcc
v_mov_b32 v126, 0x3f80
v_mov_b32 v127, 0x3f800000
v_cmp_eq_u32 vcc, 8, v121
s_nop 1
v_cndmask_b32 v114, 0, v126, vcc
v_cmp_eq_u32 vcc, 9, v121
s_nop 1
v_cndmask_b32 v114, v114, v127, vcc
v_cmp_eq_u32 vcc, 10, v121
s_nop 1
v_cndmask_b32 v115, 0, v126, vcc
v_cmp_eq_u32 vcc, 11, v121
s_nop 1
v_cndmask_b32 v115, v115, v127, vcc
v_mov_b32 v126, 0x3f80
v_mov_b32 v127, 0x3f800000
v_cmp_eq_u32 vcc, 0, v122
s_nop 1
v_cndmask_b32 v116, 0, v126, vcc
v_cmp_eq_u32 vcc, 1, v122
s_nop 1
v_cndmask_b32 v116, v116, v127, vcc
v_cmp_eq_u32 vcc, 2, v122
s_nop 1
v_cndmask_b32 v117, 0, v126, vcc
v_cmp_eq_u32 vcc, 3, v122
s_nop 1
v_cndmask_b32 v117, v117, v127, vcc
v_mov_b32 v126, 0x3f80
v_mov_b32 v127, 0x3f800000
v_cmp_eq_u32 vcc, 8, v122
s_nop 1
v_cndmask_b32 v118, 0, v126, vcc
v_cmp_eq_u32 vcc, 9, v122
s_nop 1
v_cndmask_b32 v118, v118, v127, vcc
v_cmp_eq_u32 vcc, 10, v122
s_nop 1
v_cndmask_b32 v119, 0, v126, vcc
v_cmp_eq_u32 vcc, 11, v122
s_nop 1
v_cndmask_b32 v119, v119, v127, vcc
v_cvt_pk_bf16_f32 v120, v16, v17
v_cvt_pk_bf16_f32 v121, v18, v19
v_cvt_pk_bf16_f32 v122, v20, v21
v_cvt_pk_bf16_f32 v123, v22, v23
s_nop 1
v_mfma_f32_16x16x32_bf16 v[16:19], v[120:123], v[112:115], 0
v_mfma_f32_16x16x32_bf16 v[20:23], v[120:123], v[116:119], 0
v_cvt_pk_bf16_f32 v124, v32, v33
v_cvt_pk_bf16_f32 v125, v34, v35
v_cvt_pk_bf16_f32 v126, v36, v37
v_cvt_pk_bf16_f32 v127, v38, v39
s_nop 1
v_mfma_f32_16x16x32_bf16 v[32:35], v[124:127], v[112:115], 0
v_mfma_f32_16x16x32_bf16 v[36:39], v[124:127], v[116:119], 0
v_cvt_pk_bf16_f32 v120, v24, v25
v_cvt_pk_bf16_f32 v121, v26, v27
v_cvt_pk_bf16_f32 v122, v28, v29
v_cvt_pk_bf16_f32 v123, v30, v31
s_nop 1
v_mfma_f32_16x16x32_bf16 v[24:27], v[120:123], v[112:115], 0
v_mfma_f32_16x16x32_bf16 v[28:31], v[120:123], v[116:119], 0
v_cvt_pk_bf16_f32 v124, v40, v41
v_cvt_pk_bf16_f32 v125, v42, v43
v_cvt_pk_bf16_f32 v126, v44, v45
v_cvt_pk_bf16_f32 v127, v46, v47
s_nop 1
v_mfma_f32_16x16x32_bf16 v[40:43], v[124:127], v[112:115], 0
v_mfma_f32_16x16x32_bf16 v[44:47], v[124:127], v[116:119], 0
s_lshl_b32 s14, s36, 5
s_add_u32 s14, s14, s11
s_lshl_b32 s14, s14, 2
s_add_u32 s14, s14, s10
s_lshl_b32 s15, s14, 11
s_lshl_b32 s14, s14, 12
s_mul_i32 s16, s13, 0x2400000
s_add_u32 s14, s14, s16
s_add_u32 s24, s8, s14
s_addc_u32 s25, s9, 0
s_add_u32 s24, s24, 0x4000000
s_addc_u32 s25, s25, 0
s_add_u32 s26, s8, s15
s_addc_u32 s27, s9, 0
s_add_u32 s26, s26, 0x2800000
s_addc_u32 s27, s27, 0
v_permlane32_swap_b32 v48, v52
v_permlane32_swap_b32 v49, v53
v_permlane32_swap_b32 v50, v54
v_permlane32_swap_b32 v51, v55
v_pk_add_f32 v[48:49], v[48:49], v[52:53]
v_pk_add_f32 v[50:51], v[50:51], v[54:55]
v_cvt_pk_bf16_f32 v48, v48, v49
v_cvt_pk_bf16_f32 v49, v50, v51
v_permlane32_swap_b32 v56, v60
v_permlane32_swap_b32 v57, v61
v_permlane32_swap_b32 v58, v62
v_permlane32_swap_b32 v59, v63
v_pk_add_f32 v[56:57], v[56:57], v[60:61]
v_pk_add_f32 v[58:59], v[58:59], v[62:63]
v_cvt_pk_bf16_f32 v50, v56, v57
v_cvt_pk_bf16_f32 v51, v58, v59
global_store_dwordx4 v4, v[48:51], s[24:25] offset:2048 sc1
v_permlane32_swap_b32 v64, v68
v_permlane32_swap_b32 v65, v69
v_permlane32_swap_b32 v66, v70
v_permlane32_swap_b32 v67, v71
v_pk_add_f32 v[64:65], v[64:65], v[68:69]
v_pk_add_f32 v[66:67], v[66:67], v[70:71]
v_cvt_pk_bf16_f32 v64, v64, v65
v_cvt_pk_bf16_f32 v65, v66, v67
v_permlane32_swap_b32 v72, v76
v_permlane32_swap_b32 v73, v77
v_permlane32_swap_b32 v74, v78
v_permlane32_swap_b32 v75, v79
v_pk_add_f32 v[72:73], v[72:73], v[76:77]
v_pk_add_f32 v[74:75], v[74:75], v[78:79]
v_cvt_pk_bf16_f32 v66, v72, v73
v_cvt_pk_bf16_f32 v67, v74, v75
global_store_dwordx4 v4, v[64:67], s[24:25] offset:3072 sc1
v_cvt_pk_bf16_f32 v20, v20, v21
v_cvt_pk_bf16_f32 v21, v22, v23
v_cvt_pk_bf16_f32 v22, v36, v37
v_cvt_pk_bf16_f32 v23, v38, v39
global_store_dwordx4 v4, v[20:23], s[24:25] offset:0 sc1
v_cvt_pk_bf16_f32 v28, v28, v29
v_cvt_pk_bf16_f32 v29, v30, v31
v_cvt_pk_bf16_f32 v30, v44, v45
v_cvt_pk_bf16_f32 v31, v46, v47
global_store_dwordx4 v4, v[28:31], s[24:25] offset:1024 sc1
v_cvt_pk_bf16_f32 v16, v16, v17
v_cvt_pk_bf16_f32 v17, v18, v19
v_cvt_pk_bf16_f32 v18, v32, v33
v_cvt_pk_bf16_f32 v19, v34, v35
global_store_dwordx4 v4, v[16:19], s[26:27] offset:0
v_cvt_pk_bf16_f32 v24, v24, v25
v_cvt_pk_bf16_f32 v25, v26, v27
v_cvt_pk_bf16_f32 v26, v40, v41
v_cvt_pk_bf16_f32 v27, v42, v43
global_store_dwordx4 v4, v[24:27], s[26:27] offset:1024
s_lshl_b32 s68, s11, 6
s_add_u32 s68, s68, s36
s_add_u32 s36, s36, 7
s_cmp_lt_u32 s36, s67
s_cbranch_scc1 Sw_F2
s_waitcnt vmcnt(0)
s_barrier
s_cmp_eq_u32 s10, 0
s_cbranch_scc0 Sw_f
s_lshl_b32 s22, s68, 2
s_add_u32 s20, s8, s22
s_addc_u32 s21, s9, 0
s_add_u32 s20, s20, 0x2000
s_addc_u32 s21, s21, 0
s_add_u32 s22, s13, 1
v_mov_b32 v126, 0
v_mov_b32 v127, s22
s_mov_b64 exec, 1
global_store_dword v126, v127, s[20:21] sc1
s_mov_b64 exec, -1
Sw_f:
s_mov_b32 s68, -1
s_mov_b32 s66, s36
s_cmp_lt_u32 s36, 14
s_cselect_b32 s67, 28, 64
s_cmp_lt_u32 s36, 64
s_cbranch_scc1 Sw_F
s_sub_u32 s36, s12, 1
s_lshl_b32 s14, s36, 5
s_add_u32 s14, s14, s11
s_lshl_b32 s14, s14, 2
s_add_u32 s14, s14, s10
s_lshl_b32 s15, s14, 11
s_lshl_b32 s14, s14, 12
s_mul_i32 s16, s13, 0x2400000
s_add_u32 s14, s14, s16
s_add_u32 s24, s8, s14
s_addc_u32 s25, s9, 0
s_add_u32 s24, s24, 0x4000000
s_addc_u32 s25, s25, 0
s_add_u32 s26, s8, s15
s_addc_u32 s27, s9, 0
s_add_u32 s26, s26, 0x2800000
s_addc_u32 s27, s27, 0
global_load_dwordx4 v[96:99], v4, s[26:27] offset:0 sc1
global_load_dwordx4 v[100:103], v4, s[26:27] offset:1024 sc1
global_load_dwordx4 v[104:107], v4, s[24:25] offset:0 sc1
global_load_dwordx4 v[108:111], v4, s[24:25] offset:1024 sc1
global_load_dwordx4 v[112:115], v4, s[24:25] offset:2048 sc1
global_load_dwordx4 v[116:119], v4, s[24:25] offset:3072 sc1
Sw_B:
v_lshlrev_b32 v4, 4, v0
v_mov_b32 v122, 0x4444
v_mov_b32 v123, 0xeeee
s_mov_b32 s20, 0xff00ff00
s_mov_b32 s21, 0xff00ff00
v_cndmask_b32 v1, v122, v123, s[20:21]
s_lshl_b32 s20, s10, 15
s_add_u32 s20, s20, 32768
v_add_u32 v13, s20, v4
s_add_u32 s20, s10, 0
s_and_b32 s20, s20, 3
s_lshl_b32 s20, s20, 11
v_add_u32 v5, s20, v4
v_xor_b32 v9, 0x80, v5
s_add_u32 s20, s10, 1
s_and_b32 s20, s20, 3
s_lshl_b32 s20, s20, 11
v_add_u32 v6, s20, v4
v_xor_b32 v10, 0x80, v6
s_add_u32 s20, s10, 2
s_and_b32 s20, s20, 3
s_lshl_b32 s20, s20, 11
v_add_u32 v7, s20, v4
v_xor_b32 v11, 0x80, v7
s_add_u32 s20, s10, 3
s_and_b32 s20, s20, 3
s_lshl_b32 s20, s20, 11
v_add_u32 v8, s20, v4
v_xor_b32 v12, 0x80, v8
s_lshl_b32 s14, s13, 6
s_add_u32 s14, s14, s36
s_lshl_b32 s14, s14, 13
s_lshl_b32 s15, s10, 11
s_add_u32 s14, s14, s15
s_mov_b32 m0, s15
s_mov_b32 s16, 0xff81ff81
s_mov_b32 s19, 0
s_add_u32 s24, s8, s14
s_addc_u32 s25, s9, 0
s_add_u32 s24, s24, 0x100000
s_addc_u32 s25, s25, 0
global_load_lds_dwordx4 v4, s[24:25] sc1
global_load_lds_dwordx4 v4, s[24:25] offset:1024 sc1
v_and_b32 v120, 15, v0
v_lshrrev_b32 v121, 4, v0
v_lshlrev_b32 v124, 2, v121
v_sub_u32 v124, v120, v124
v_mov_b32 v122, 0x3f80
v_mov_b32 v123, 0x3f800000
v_cmp_eq_u32 vcc, 0, v124
s_nop 1
v_cndmask_b32 v2, 0, v122, vcc
v_cmp_eq_u32 vcc, 1, v124
s_nop 1
v_cndmask_b32 v2, v2, v123, vcc
v_cmp_eq_u32 vcc, 2, v124
s_nop 1
v_cndmask_b32 v3, 0, v122, vcc
v_cmp_eq_u32 vcc, 3, v124
s_nop 1
v_cndmask_b32 v3, v3, v123, vcc
v_cmp_le_i32 s[40:41], 0, v124
v_cmp_le_i32 s[42:43], 1, v124
v_cmp_le_i32 s[44:45], 2, v124
v_cmp_le_i32 s[46:47], 3, v124
s_mov_b32 s48, 0
s_mov_b32 s49, -1
v_and_b32 v122, 7, v0
v_lshlrev_b32 v122, 4, v122
v_lshl_add_u32 v122, v121, 7, v122
v_lshrrev_b32 v123, 3, v120
s_lshl_b32 s20, s10, 9
v_add_u32 v19, s20, v122
v_lshl_add_u32 v14, v123, 3, v19
v_xor_b32 v15, 8, v14
v_lshl_add_u32 v19, v123, 11, v19
s_add_u32 s20, s10, 1
s_and_b32 s20, s20, 3
s_lshl_b32 s20, s20, 9
v_add_u32 v16, s20, v122
s_add_u32 s20, s10, 2
s_and_b32 s20, s20, 3
s_lshl_b32 s20, s20, 9
v_add_u32 v17, s20, v122
s_add_u32 s20, s10, 3
s_and_b32 s20, s20, 3
s_lshl_b32 s20, s20, 9
v_add_u32 v18, s20, v122
v_mov_b64 v[64:65], 0
v_mov_b64 v[66:67], 0
v_mov_b64 v[68:69], 0
v_mov_b64 v[70:71], 0
v_mov_b64 v[72:73], 0
v_mov_b64 v[74:75], 0
v_mov_b64 v[76:77], 0
v_mov_b64 v[78:79], 0
s_waitcnt vmcnt(2)
v_mfma_f32_16x16x32_bf16 v[44:47], v[104:107], v[96:99], 0
v_mfma_f32_16x16x32_bf16 v[52:55], v[104:107], v[100:103], 0
v_mfma_f32_16x16x32_bf16 v[56:59], v[108:111], v[100:103], 0
ds_write_b128 v5, v[44:47] offset:8192
s_nop 2
ds_write_b128 v5, v[52:55] offset:16384
s_nop 2
ds_write_b128 v5, v[56:59] offset:17408
ds_read_b128 v[20:23], v13 offset:8192
ds_read_b128 v[24:27], v13 offset:9216
ds_read_b128 v[28:31], v13 offset:10240
ds_read_b128 v[32:35], v13 offset:11264
ds_read_b128 v[36:39], v13 offset:16384
ds_read_b128 v[40:43], v13 offset:17408
Sw_B_mp:
s_waitcnt vmcnt(0)
ds_read_b128 v[80:83], v5
ds_read_b128 v[84:87], v5 offset:1024
s_waitcnt lgkmcnt(0)
v_cmp_eq_u32 vcc, s16, v80
v_cmp_eq_u32 s[22:23], s16, v84
s_or_b64 vcc, vcc, s[22:23]
s_cbranch_scc0 Sw_B_mo
s_sleep 2
global_load_lds_dwordx4 v4, s[24:25] sc1
global_load_lds_dwordx4 v4, s[24:25] offset:1024 sc1
s_add_u32 s19, s19, 1
s_cmp_gt_u32 s19, 400000
s_cbranch_scc1 KB_fail
s_branch Sw_B_mp
Sw_B_mo:
s_barrier
ds_read_b128 v[88:91], v9 offset:0
ds_read_b128 v[92:95], v9 offset:1024
v_smfmac_f32_16x16x64_bf16 v[64:67], v[80:83], v[20:27], v1
ds_read_b128 v[20:23], v13 offset:18432
ds_read_b128 v[24:27], v13 offset:19456
v_smfmac_f32_16x16x64_bf16 v[68:71], v[80:83], v[28:35], v1
ds_read_b128 v[28:31], v13 offset:12288
ds_read_b128 v[32:35], v13 offset:13312
v_smfmac_f32_16x16x64_bf16 v[72:75], v[80:83], v[36:43], v1
ds_read_b128 v[36:39], v13 offset:14336
ds_read_b128 v[40:43], v13 offset:15360
s_waitcnt lgkmcnt(4)
v_smfmac_f32_16x16x64_bf16 v[76:79], v[80:83], v[20:27], v1
ds_read_b128 v[80:83], v6 offset:0
ds_read_b128 v[20:23], v13 offset:20480
ds_read_b128 v[24:27], v13 offset:21504
v_smfmac_f32_16x16x64_bf16 v[64:67], v[88:91], a[200:207], v1
v_smfmac_f32_16x16x64_bf16 v[68:71], v[88:91], a[208:215], v1
ds_read_b128 v[88:91], v10 offset:0
s_waitcnt lgkmcnt(6)
v_smfmac_f32_16x16x64_bf16 v[64:67], v[84:87], v[28:35], v1
ds_read_b128 v[28:31], v13 offset:22528
ds_read_b128 v[32:35], v13 offset:23552
s_waitcnt lgkmcnt(6)
v_smfmac_f32_16x16x64_bf16 v[68:71], v[84:87], v[36:43], v1
ds_read_b128 v[36:39], v13 offset:24576
ds_read_b128 v[40:43], v13 offset:25600
v_smfmac_f32_16x16x64_bf16 v[72:75], v[84:87], a[232:239], v1
v_smfmac_f32_16x16x64_bf16 v[76:79], v[84:87], a[240:247], v1
ds_read_b128 v[84:87], v6 offset:1024
v_smfmac_f32_16x16x64_bf16 v[64:67], v[92:95], a[216:223], v1
v_smfmac_f32_16x16x64_bf16 v[68:71], v[92:95], a[224:231], v1
ds_read_b128 v[92:95], v10 offset:1024
s_waitcnt lgkmcnt(9)
v_smfmac_f32_16x16x64_bf16 v[64:67], v[80:83], v[232:239], v1
v_smfmac_f32_16x16x64_bf16 v[68:71], v[80:83], v[240:247], v1
s_waitcnt lgkmcnt(7)
v_smfmac_f32_16x16x64_bf16 v[72:75], v[80:83], v[20:27], v1
ds_read_b128 v[20:23], v13 offset:0
ds_read_b128 v[24:27], v13 offset:1024
s_waitcnt lgkmcnt(6)
v_smfmac_f32_16x16x64_bf16 v[76:79], v[80:83], v[28:35], v1
ds_read_b128 v[80:83], v7 offset:0
ds_read_b128 v[28:31], v13 offset:2048
ds_read_b128 v[32:35], v13 offset:3072
v_smfmac_f32_16x16x64_bf16 v[64:67], v[88:91], v[248:255], v1
v_smfmac_f32_16x16x64_bf16 v[68:71], v[88:91], a[0:7], v1
ds_read_b128 v[88:91], v11 offset:0
s_waitcnt lgkmcnt(7)
v_smfmac_f32_16x16x64_bf16 v[64:67], v[84:87], a[104:111], v1
v_smfmac_f32_16x16x64_bf16 v[68:71], v[84:87], a[112:119], v1
v_smfmac_f32_16x16x64_bf16 v[72:75], v[84:87], v[36:43], v1
ds_read_b128 v[36:39], v13 offset:4096
ds_read_b128 v[40:43], v13 offset:5120
v_smfmac_f32_16x16x64_bf16 v[76:79], v[84:87], a[248:255], v1
ds_read_b128 v[84:87], v7 offset:1024
s_waitcnt lgkmcnt(9)
v_smfmac_f32_16x16x64_bf16 v[64:67], v[92:95], a[120:127], v1
s_waitcnt lgkmcnt(7)
v_smfmac_f32_16x16x64_bf16 v[68:71], v[92:95], v[20:27], v1
ds_read_b128 v[92:95], v11 offset:1024
ds_read_b128 v[20:23], v13 offset:6144
ds_read_b128 v[24:27], v13 offset:7168
s_waitcnt lgkmcnt(9)
v_smfmac_f32_16x16x64_bf16 v[64:67], v[80:83], a[128:135], v1
v_smfmac_f32_16x16x64_bf16 v[68:71], v[80:83], a[136:143], v1
v_smfmac_f32_16x16x64_bf16 v[72:75], v[80:83], a[40:47], v1
v_smfmac_f32_16x16x64_bf16 v[76:79], v[80:83], a[48:55], v1
ds_read_b128 v[80:83], v8 offset:0
s_waitcnt lgkmcnt(7)
v_smfmac_f32_16x16x64_bf16 v[64:67], v[88:91], a[144:151], v1
v_smfmac_f32_16x16x64_bf16 v[68:71], v[88:91], v[28:35], v1
ds_read_b128 v[88:91], v12 offset:0
ds_read_b128 v[28:31], v13 offset:26624
ds_read_b128 v[32:35], v13 offset:27648
s_waitcnt lgkmcnt(7)
v_smfmac_f32_16x16x64_bf16 v[64:67], v[84:87], a[152:159], v1
v_smfmac_f32_16x16x64_bf16 v[68:71], v[84:87], a[160:167], v1
v_smfmac_f32_16x16x64_bf16 v[72:75], v[84:87], a[56:63], v1
v_smfmac_f32_16x16x64_bf16 v[76:79], v[84:87], a[64:71], v1
ds_read_b128 v[84:87], v8 offset:1024
s_waitcnt lgkmcnt(7)
v_smfmac_f32_16x16x64_bf16 v[64:67], v[92:95], a[168:175], v1
v_smfmac_f32_16x16x64_bf16 v[68:71], v[92:95], v[36:43], v1
ds_read_b128 v[92:95], v12 offset:1024
ds_read_b128 v[36:39], v13 offset:28672
ds_read_b128 v[40:43], v13 offset:29696
s_waitcnt lgkmcnt(7)
v_smfmac_f32_16x16x64_bf16 v[64:67], v[80:83], a[8:15], v1
v_smfmac_f32_16x16x64_bf16 v[68:71], v[80:83], a[16:23], v1
v_smfmac_f32_16x16x64_bf16 v[72:75], v[80:83], a[72:79], v1
v_smfmac_f32_16x16x64_bf16 v[76:79], v[80:83], a[80:87], v1
s_waitcnt lgkmcnt(6)
v_smfmac_f32_16x16x64_bf16 v[64:67], v[88:91], a[24:31], v1
v_smfmac_f32_16x16x64_bf16 v[68:71], v[88:91], a[32:39], v1
s_waitcnt lgkmcnt(3)
v_smfmac_f32_16x16x64_bf16 v[64:67], v[84:87], a[176:183], v1
v_smfmac_f32_16x16x64_bf16 v[68:71], v[84:87], a[184:191], v1
v_smfmac_f32_16x16x64_bf16 v[72:75], v[84:87], a[88:95], v1
v_smfmac_f32_16x16x64_bf16 v[76:79], v[84:87], a[96:103], v1
s_waitcnt lgkmcnt(2)
v_smfmac_f32_16x16x64_bf16 v[64:67], v[92:95], v[20:27], v1
ds_read_b128 v[20:23], v13 offset:30720
ds_read_b128 v[24:27], v13 offset:31744
v_smfmac_f32_16x16x64_bf16 v[68:71], v[92:95], a[192:199], v1
s_nop 3
v_cvt_pk_bf16_f32 v64, v64, v65
v_cvt_pk_bf16_f32 v65, v66, v67
s_nop 1
v_mfma_f32_16x16x16_bf16 v[88:91], v[64:65], v[2:3], 0
v_cvt_pk_bf16_f32 v68, v68, v69
v_cvt_pk_bf16_f32 v69, v70, v71
s_nop 1
v_mfma_f32_16x16x16_bf16 v[92:95], v[68:69], v[2:3], 0
v_mov_b32 v122, v72
s_nop 1
v_permlane32_swap_b32 v122, v72
v_add_f32 v72, v72, v122
v_mov_b32 v122, v73
s_nop 1
v_permlane32_swap_b32 v122, v73
v_add_f32 v73, v73, v122
v_mov_b32 v122, v74
s_nop 1
v_permlane32_swap_b32 v122, v74
v_add_f32 v74, v74, v122
v_mov_b32 v122, v75
s_nop 1
v_permlane32_swap_b32 v122, v75
v_add_f32 v75, v75, v122
v_cvt_pk_bf16_f32 v104, v72, v73
v_cvt_pk_bf16_f32 v105, v74, v75
v_mov_b32 v122, v76
s_nop 1
v_permlane32_swap_b32 v122, v76
v_add_f32 v76, v76, v122
v_mov_b32 v122, v77
s_nop 1
v_permlane32_swap_b32 v122, v77
v_add_f32 v77, v77, v122
v_mov_b32 v122, v78
s_nop 1
v_permlane32_swap_b32 v122, v78
v_add_f32 v78, v78, v122
v_mov_b32 v122, v79
s_nop 1
v_permlane32_swap_b32 v122, v79
v_add_f32 v79, v79, v122
v_cvt_pk_bf16_f32 v106, v76, v77
v_cvt_pk_bf16_f32 v107, v78, v79
v_cvt_pk_bf16_f32 v80, v88, v89
v_cvt_pk_bf16_f32 v81, v90, v91
v_cvt_pk_bf16_f32 v82, v92, v93
v_cvt_pk_bf16_f32 v83, v94, v95
s_nop 1
v_mfma_f32_16x16x32_bf16 v[48:51], v[80:83], v[96:99], 0
v_mfma_f32_16x16x32_bf16 v[60:63], v[80:83], v[100:103], 0
v_mov_b32 v108, 0x3f803f80
v_mov_b32 v109, 0x3f803f80
v_mov_b32 v110, 0x3f803f80
v_mov_b32 v111, 0x3f803f80
ds_write_b128 v5, v[48:51] offset:9216
s_nop 2
ds_write_b128 v5, v[60:63] offset:24576
s_waitcnt lgkmcnt(0)
s_barrier
ds_read_b128 v[64:67], v6 offset:8192
ds_read_b128 v[68:71], v7 offset:8192
ds_read_b128 v[72:75], v8 offset:8192
ds_read_b128 v[76:79], v6 offset:9216
ds_read_b128 v[80:83], v7 offset:9216
ds_read_b128 v[84:87], v8 offset:9216
ds_read_b128 v[88:91], v6 offset:16384
ds_read_b128 v[92:95], v7 offset:16384
s_waitcnt lgkmcnt(7)
v_pk_add_f32 v[44:45], v[44:45], v[64:65]
v_pk_add_f32 v[46:47], v[46:47], v[66:67]
ds_read_b128 v[64:67], v8 offset:16384
s_waitcnt lgkmcnt(7)
v_pk_add_f32 v[44:45], v[44:45], v[68:69]
v_pk_add_f32 v[46:47], v[46:47], v[70:71]
ds_read_b128 v[68:71], v6 offset:17408
s_waitcnt lgkmcnt(7)
v_pk_add_f32 v[44:45], v[44:45], v[72:73]
v_pk_add_f32 v[46:47], v[46:47], v[74:75]
ds_read_b128 v[72:75], v7 offset:17408
s_waitcnt lgkmcnt(7)
v_pk_add_f32 v[48:49], v[48:49], v[76:77]
v_pk_add_f32 v[50:51], v[50:51], v[78:79]
ds_read_b128 v[76:79], v8 offset:17408
s_waitcnt lgkmcnt(7)
v_pk_add_f32 v[48:49], v[48:49], v[80:81]
v_pk_add_f32 v[50:51], v[50:51], v[82:83]
ds_read_b128 v[80:83], v6 offset:24576
s_waitcnt lgkmcnt(7)
v_pk_add_f32 v[48:49], v[48:49], v[84:85]
v_pk_add_f32 v[50:51], v[50:51], v[86:87]
ds_read_b128 v[84:87], v7 offset:24576
s_waitcnt lgkmcnt(7)
v_pk_add_f32 v[52:53], v[52:53], v[88:89]
v_pk_add_f32 v[54:55], v[54:55], v[90:91]
ds_read_b128 v[88:91], v8 offset:24576
s_waitcnt lgkmcnt(7)
v_pk_add_f32 v[52:53], v[52:53], v[92:93]
v_pk_add_f32 v[54:55], v[54:55], v[94:95]
s_waitcnt lgkmcnt(6)
v_pk_add_f32 v[52:53], v[52:53], v[64:65]
v_pk_add_f32 v[54:55], v[54:55], v[66:67]
s_waitcnt lgkmcnt(5)
v_pk_add_f32 v[56:57], v[56:57], v[68:69]
v_pk_add_f32 v[58:59], v[58:59], v[70:71]
s_waitcnt lgkmcnt(4)
v_pk_add_f32 v[56:57], v[56:57], v[72:73]
v_pk_add_f32 v[58:59], v[58:59], v[74:75]
s_waitcnt lgkmcnt(3)
v_pk_add_f32 v[56:57], v[56:57], v[76:77]
v_pk_add_f32 v[58:59], v[58:59], v[78:79]
s_waitcnt lgkmcnt(2)
v_pk_add_f32 v[60:61], v[60:61], v[80:81]
v_pk_add_f32 v[62:63], v[62:63], v[82:83]
s_waitcnt lgkmcnt(1)
v_pk_add_f32 v[60:61], v[60:61], v[84:85]
v_pk_add_f32 v[62:63], v[62:63], v[86:87]
s_waitcnt lgkmcnt(0)
v_pk_add_f32 v[60:61], v[60:61], v[88:89]
v_pk_add_f32 v[62:63], v[62:63], v[90:91]
v_mov_b32 v122, 0xff7fffff
s_mov_b32 s14, 0x3e0293ee
v_cndmask_b32 v44, v122, v44, s[40:41]
v_cndmask_b32 v56, v122, v56, s[40:41]
v_cndmask_b32 v48, v122, v48, s[48:49]
v_cndmask_b32 v60, v122, v60, s[48:49]
v_cndmask_b32 v45, v122, v45, s[42:43]
v_cndmask_b32 v57, v122, v57, s[42:43]
v_cndmask_b32 v49, v122, v49, s[48:49]
v_cndmask_b32 v61, v122, v61, s[48:49]
v_cndmask_b32 v46, v122, v46, s[44:45]
v_cndmask_b32 v58, v122, v58, s[44:45]
v_cndmask_b32 v50, v122, v50, s[48:49]
v_cndmask_b32 v62, v122, v62, s[48:49]
v_cndmask_b32 v47, v122, v47, s[46:47]
v_cndmask_b32 v59, v122, v59, s[46:47]
v_cndmask_b32 v51, v122, v51, s[48:49]
v_cndmask_b32 v63, v122, v63, s[48:49]
v_max_f32 v123, v44, v45
v_max3_f32 v123, v46, v47, v123
v_max3_f32 v123, v48, v49, v123
v_max3_f32 v123, v50, v51, v123
v_mov_b32 v125, v123
s_nop 1
v_permlane16_swap_b32 v123, v125
v_max_f32 v123, v123, v125
v_mov_b32 v125, v123
s_nop 1
v_permlane32_swap_b32 v123, v125
v_max_f32 v123, v123, v125
v_sub_f32 v44, v44, v123
v_mul_f32 v44, s14, v44
v_exp_f32 v44, v44
v_sub_f32 v45, v45, v123
v_mul_f32 v45, s14, v45
v_exp_f32 v45, v45
v_sub_f32 v46, v46, v123
v_mul_f32 v46, s14, v46
v_exp_f32 v46, v46
v_sub_f32 v47, v47, v123
v_mul_f32 v47, s14, v47
v_exp_f32 v47, v47
v_sub_f32 v48, v48, v123
v_mul_f32 v48, s14, v48
v_exp_f32 v48, v48
v_sub_f32 v49, v49, v123
v_mul_f32 v49, s14, v49
v_exp_f32 v49, v49
v_sub_f32 v50, v50, v123
v_mul_f32 v50, s14, v50
v_exp_f32 v50, v50
v_sub_f32 v51, v51, v123
v_mul_f32 v51, s14, v51
v_exp_f32 v51, v51
v_max_f32 v124, v52, v53
v_max3_f32 v124, v54, v55, v124
v_max3_f32 v124, v56, v57, v124
v_max3_f32 v124, v58, v59, v124
v_max3_f32 v124, v60, v61, v124
v_max3_f32 v124, v62, v63, v124
v_mov_b32 v125, v124
s_nop 1
v_permlane16_swap_b32 v124, v125
v_max_f32 v124, v124, v125
v_mov_b32 v125, v124
s_nop 1
v_permlane32_swap_b32 v124, v125
v_max_f32 v124, v124, v125
v_sub_f32 v52, v52, v124
v_mul_f32 v52, s14, v52
v_exp_f32 v52, v52
v_sub_f32 v53, v53, v124
v_mul_f32 v53, s14, v53
v_exp_f32 v53, v53
v_sub_f32 v54, v54, v124
v_mul_f32 v54, s14, v54
v_exp_f32 v54, v54
v_sub_f32 v55, v55, v124
v_mul_f32 v55, s14, v55
v_exp_f32 v55, v55
v_sub_f32 v56, v56, v124
v_mul_f32 v56, s14, v56
v_exp_f32 v56, v56
v_sub_f32 v57, v57, v124
v_mul_f32 v57, s14, v57
v_exp_f32 v57, v57
v_sub_f32 v58, v58, v124
v_mul_f32 v58, s14, v58
v_exp_f32 v58, v58
v_sub_f32 v59, v59, v124
v_mul_f32 v59, s14, v59
v_exp_f32 v59, v59
v_sub_f32 v60, v60, v124
v_mul_f32 v60, s14, v60
v_exp_f32 v60, v60
v_sub_f32 v61, v61, v124
v_mul_f32 v61, s14, v61
v_exp_f32 v61, v61
v_sub_f32 v62, v62, v124
v_mul_f32 v62, s14, v62
v_exp_f32 v62, v62
v_sub_f32 v63, v63, v124
v_mul_f32 v63, s14, v63
v_exp_f32 v63, v63
v_cvt_pk_bf16_f32 v64, v44, v45
v_cvt_pk_bf16_f32 v65, v46, v47
v_mov_b64 v[66:67], 0
v_cvt_pk_bf16_f32 v68, v52, v53
v_cvt_pk_bf16_f32 v69, v54, v55
v_cvt_pk_bf16_f32 v70, v56, v57
v_cvt_pk_bf16_f32 v71, v58, v59
v_cvt_pk_bf16_f32 v72, v48, v49
v_cvt_pk_bf16_f32 v73, v50, v51
v_cvt_pk_bf16_f32 v74, v60, v61
v_cvt_pk_bf16_f32 v75, v62, v63
v_mfma_f32_16x16x32_bf16 v[76:79], v[108:111], v[64:67], 0
v_mfma_f32_16x16x32_bf16 v[44:47], v[112:115], v[64:67], 0
v_mfma_f32_16x16x32_bf16 v[48:51], v[116:119], v[64:67], 0
v_mfma_f32_16x16x16_bf16 v[76:79], v[108:109], v[72:73], v[76:79]
v_mfma_f32_16x16x16_bf16 v[44:47], v[104:105], v[72:73], v[44:47]
v_mfma_f32_16x16x16_bf16 v[48:51], v[106:107], v[72:73], v[48:51]
v_mfma_f32_16x16x32_bf16 v[80:83], v[108:111], v[68:71], 0
v_mfma_f32_16x16x32_bf16 v[52:55], v[112:115], v[68:71], 0
v_mfma_f32_16x16x32_bf16 v[56:59], v[116:119], v[68:71], 0
v_mfma_f32_16x16x16_bf16 v[80:83], v[108:109], v[74:75], v[80:83]
v_mfma_f32_16x16x16_bf16 v[52:55], v[104:105], v[74:75], v[52:55]
v_mfma_f32_16x16x16_bf16 v[56:59], v[106:107], v[74:75], v[56:59]
v_rcp_f32 v76, v76
s_nop 0
v_pk_mul_f32 v[44:45], v[44:45], v[76:77] op_sel_hi:[1,0]
v_pk_mul_f32 v[46:47], v[46:47], v[76:77] op_sel_hi:[1,0]
v_pk_mul_f32 v[48:49], v[48:49], v[76:77] op_sel_hi:[1,0]
v_pk_mul_f32 v[50:51], v[50:51], v[76:77] op_sel_hi:[1,0]
v_cvt_pk_bf16_f32 v44, v44, v45
v_cvt_pk_bf16_f32 v45, v46, v47
v_cvt_pk_bf16_f32 v46, v48, v49
v_cvt_pk_bf16_f32 v47, v50, v51
ds_write_b128 v19, v[44:47] offset:0
v_rcp_f32 v80, v80
s_nop 0
v_pk_mul_f32 v[52:53], v[52:53], v[80:81] op_sel_hi:[1,0]
v_pk_mul_f32 v[54:55], v[54:55], v[80:81] op_sel_hi:[1,0]
v_pk_mul_f32 v[56:57], v[56:57], v[80:81] op_sel_hi:[1,0]
v_pk_mul_f32 v[58:59], v[58:59], v[80:81] op_sel_hi:[1,0]
v_cvt_pk_bf16_f32 v52, v52, v53
v_cvt_pk_bf16_f32 v53, v54, v55
v_cvt_pk_bf16_f32 v54, v56, v57
v_cvt_pk_bf16_f32 v55, v58, v59
ds_write_b128 v19, v[52:55] offset:4096
v_lshrrev_b32 v122, 5, v0
v_lshlrev_b32 v122, 3, v122
v_bfe_u32 v123, v0, 2, 2
v_lshl_add_u32 v122, v123, 1, v122
v_bfe_u32 v123, v0, 4, 1
v_add_u32 v122, v122, v123
v_lshlrev_b32 v122, 11, v122
v_and_b32 v123, 3, v0
v_lshl_add_u32 v120, v123, 4, v122
s_lshl_b32 s14, s12, 21
s_add_u32 s14, s14, s37
s_lshl_b32 s15, s10, 15
s_lshl_b32 s16, s11, 6
s_add_u32 s15, s15, s16
s_add_u32 s28, s8, s14
s_addc_u32 s29, s9, 0
s_add_u32 s28, s28, 0x1400000
s_addc_u32 s29, s29, 0
s_add_u32 s24, s28, s15
s_addc_u32 s25, s29, 0
s_waitcnt lgkmcnt(0)
s_barrier
ds_read_b64 v[44:45], v14 offset:0
ds_read_b64 v[46:47], v15 offset:0
ds_read_b128 v[48:51], v16 offset:0
ds_read_b128 v[52:55], v17 offset:0
ds_read_b128 v[56:59], v18 offset:0
v_mov_b64 v[60:61], 0
v_mov_b64 v[62:63], 0
v_mov_b64 v[64:65], 0
v_mov_b64 v[66:67], 0
v_mov_b64 v[68:69], 0
v_mov_b64 v[70:71], 0
v_mov_b64 v[72:73], 0
v_mov_b64 v[74:75], 0
ds_read_b64 v[96:97], v14 offset:2048
ds_read_b64 v[98:99], v15 offset:2048
ds_read_b128 v[100:103], v16 offset:2048
ds_read_b128 v[104:107], v17 offset:2048
ds_read_b128 v[108:111], v18 offset:2048
s_waitcnt lgkmcnt(8)
v_smfmac_f32_16x16x64_bf16 v[60:63], v[44:47], v[28:35], v1
v_smfmac_f32_16x16x64_bf16 v[64:67], v[44:47], v[36:43], v1
v_smfmac_f32_16x16x64_bf16 v[68:71], v[44:47], v[20:27], v1
v_smfmac_f32_16x16x64_bf16 v[72:75], v[44:47], v[224:231], v1
s_waitcnt lgkmcnt(7)
v_smfmac_f32_16x16x64_bf16 v[60:63], v[48:51], v[128:135], v1
v_smfmac_f32_16x16x64_bf16 v[64:67], v[48:51], v[136:143], v1
v_smfmac_f32_16x16x64_bf16 v[68:71], v[48:51], v[144:151], v1
v_smfmac_f32_16x16x64_bf16 v[72:75], v[48:51], v[152:159], v1
s_waitcnt lgkmcnt(6)
v_smfmac_f32_16x16x64_bf16 v[60:63], v[52:55], v[160:167], v1
v_smfmac_f32_16x16x64_bf16 v[64:67], v[52:55], v[168:175], v1
v_smfmac_f32_16x16x64_bf16 v[68:71], v[52:55], v[176:183], v1
v_smfmac_f32_16x16x64_bf16 v[72:75], v[52:55], v[184:191], v1
s_waitcnt lgkmcnt(5)
v_smfmac_f32_16x16x64_bf16 v[60:63], v[56:59], v[192:199], v1
v_smfmac_f32_16x16x64_bf16 v[64:67], v[56:59], v[200:207], v1
v_smfmac_f32_16x16x64_bf16 v[68:71], v[56:59], v[208:215], v1
v_smfmac_f32_16x16x64_bf16 v[72:75], v[56:59], v[216:223], v1
v_mov_b64 v[76:77], 0
v_mov_b64 v[78:79], 0
v_mov_b64 v[80:81], 0
v_mov_b64 v[82:83], 0
v_mov_b64 v[84:85], 0
v_mov_b64 v[86:87], 0
v_mov_b64 v[88:89], 0
v_mov_b64 v[90:91], 0
ds_read_b64 v[44:45], v14 offset:4096
ds_read_b64 v[46:47], v15 offset:4096
ds_read_b128 v[48:51], v16 offset:4096
ds_read_b128 v[52:55], v17 offset:4096
ds_read_b128 v[56:59], v18 offset:4096
s_waitcnt lgkmcnt(8)
v_smfmac_f32_16x16x64_bf16 v[76:79], v[96:99], v[28:35], v1
v_smfmac_f32_16x16x64_bf16 v[80:83], v[96:99], v[36:43], v1
v_smfmac_f32_16x16x64_bf16 v[84:87], v[96:99], v[20:27], v1
v_smfmac_f32_16x16x64_bf16 v[88:91], v[96:99], v[224:231], v1
v_cvt_pk_bf16_f32 v60, v60, v61
v_cvt_pk_bf16_f32 v61, v62, v63
v_cvt_pk_bf16_f32 v62, v64, v65
v_cvt_pk_bf16_f32 v63, v66, v67
global_store_dwordx4 v120, v[60:63], s[24:25] sc1
s_add_u32 s24, s24, 0x20000
s_addc_u32 s25, s25, 0
v_cvt_pk_bf16_f32 v68, v68, v69
v_cvt_pk_bf16_f32 v69, v70, v71
v_cvt_pk_bf16_f32 v70, v72, v73
v_cvt_pk_bf16_f32 v71, v74, v75
global_store_dwordx4 v120, v[68:71], s[24:25] sc1
s_add_u32 s24, s24, 0x20000
s_addc_u32 s25, s25, 0
s_waitcnt lgkmcnt(7)
v_smfmac_f32_16x16x64_bf16 v[76:79], v[100:103], v[128:135], v1
v_smfmac_f32_16x16x64_bf16 v[80:83], v[100:103], v[136:143], v1
v_smfmac_f32_16x16x64_bf16 v[84:87], v[100:103], v[144:151], v1
v_smfmac_f32_16x16x64_bf16 v[88:91], v[100:103], v[152:159], v1
s_waitcnt lgkmcnt(6)
v_smfmac_f32_16x16x64_bf16 v[76:79], v[104:107], v[160:167], v1
v_smfmac_f32_16x16x64_bf16 v[80:83], v[104:107], v[168:175], v1
v_smfmac_f32_16x16x64_bf16 v[84:87], v[104:107], v[176:183], v1
v_smfmac_f32_16x16x64_bf16 v[88:91], v[104:107], v[184:191], v1
s_waitcnt lgkmcnt(5)
v_smfmac_f32_16x16x64_bf16 v[76:79], v[108:111], v[192:199], v1
v_smfmac_f32_16x16x64_bf16 v[80:83], v[108:111], v[200:207], v1
v_smfmac_f32_16x16x64_bf16 v[84:87], v[108:111], v[208:215], v1
v_smfmac_f32_16x16x64_bf16 v[88:91], v[108:111], v[216:223], v1
v_mov_b64 v[60:61], 0
v_mov_b64 v[62:63], 0
v_mov_b64 v[64:65], 0
v_mov_b64 v[66:67], 0
v_mov_b64 v[68:69], 0
v_mov_b64 v[70:71], 0
v_mov_b64 v[72:73], 0
v_mov_b64 v[74:75], 0
ds_read_b64 v[96:97], v14 offset:6144
ds_read_b64 v[98:99], v15 offset:6144
ds_read_b128 v[100:103], v16 offset:6144
ds_read_b128 v[104:107], v17 offset:6144
ds_read_b128 v[108:111], v18 offset:6144
s_waitcnt lgkmcnt(8)
v_smfmac_f32_16x16x64_bf16 v[60:63], v[44:47], v[28:35], v1
v_smfmac_f32_16x16x64_bf16 v[64:67], v[44:47], v[36:43], v1
v_smfmac_f32_16x16x64_bf16 v[68:71], v[44:47], v[20:27], v1
v_smfmac_f32_16x16x64_bf16 v[72:75], v[44:47], v[224:231], v1
v_cvt_pk_bf16_f32 v76, v76, v77
v_cvt_pk_bf16_f32 v77, v78, v79
v_cvt_pk_bf16_f32 v78, v80, v81
v_cvt_pk_bf16_f32 v79, v82, v83
global_store_dwordx4 v120, v[76:79], s[24:25] sc1
s_add_u32 s24, s24, 0x20000
s_addc_u32 s25, s25, 0
v_cvt_pk_bf16_f32 v84, v84, v85
v_cvt_pk_bf16_f32 v85, v86, v87
v_cvt_pk_bf16_f32 v86, v88, v89
v_cvt_pk_bf16_f32 v87, v90, v91
global_store_dwordx4 v120, v[84:87], s[24:25] sc1
s_add_u32 s24, s24, 0x20000
s_addc_u32 s25, s25, 0
s_waitcnt lgkmcnt(7)
v_smfmac_f32_16x16x64_bf16 v[60:63], v[48:51], v[128:135], v1
v_smfmac_f32_16x16x64_bf16 v[64:67], v[48:51], v[136:143], v1
v_smfmac_f32_16x16x64_bf16 v[68:71], v[48:51], v[144:151], v1
v_smfmac_f32_16x16x64_bf16 v[72:75], v[48:51], v[152:159], v1
s_waitcnt lgkmcnt(6)
v_smfmac_f32_16x16x64_bf16 v[60:63], v[52:55], v[160:167], v1
v_smfmac_f32_16x16x64_bf16 v[64:67], v[52:55], v[168:175], v1
v_smfmac_f32_16x16x64_bf16 v[68:71], v[52:55], v[176:183], v1
v_smfmac_f32_16x16x64_bf16 v[72:75], v[52:55], v[184:191], v1
s_waitcnt lgkmcnt(5)
v_smfmac_f32_16x16x64_bf16 v[60:63], v[56:59], v[192:199], v1
v_smfmac_f32_16x16x64_bf16 v[64:67], v[56:59], v[200:207], v1
v_smfmac_f32_16x16x64_bf16 v[68:71], v[56:59], v[208:215], v1
v_smfmac_f32_16x16x64_bf16 v[72:75], v[56:59], v[216:223], v1
v_mov_b64 v[76:77], 0
v_mov_b64 v[78:79], 0
v_mov_b64 v[80:81], 0
v_mov_b64 v[82:83], 0
v_mov_b64 v[84:85], 0
v_mov_b64 v[86:87], 0
v_mov_b64 v[88:89], 0
v_mov_b64 v[90:91], 0
s_waitcnt lgkmcnt(3)
v_smfmac_f32_16x16x64_bf16 v[76:79], v[96:99], v[28:35], v1
v_smfmac_f32_16x16x64_bf16 v[80:83], v[96:99], v[36:43], v1
v_smfmac_f32_16x16x64_bf16 v[84:87], v[96:99], v[20:27], v1
v_smfmac_f32_16x16x64_bf16 v[88:91], v[96:99], v[224:231], v1
v_cvt_pk_bf16_f32 v60, v60, v61
v_cvt_pk_bf16_f32 v61, v62, v63
v_cvt_pk_bf16_f32 v62, v64, v65
v_cvt_pk_bf16_f32 v63, v66, v67
global_store_dwordx4 v120, v[60:63], s[24:25] sc1
s_add_u32 s24, s24, 0x20000
s_addc_u32 s25, s25, 0
v_cvt_pk_bf16_f32 v68, v68, v69
v_cvt_pk_bf16_f32 v69, v70, v71
v_cvt_pk_bf16_f32 v70, v72, v73
v_cvt_pk_bf16_f32 v71, v74, v75
global_store_dwordx4 v120, v[68:71], s[24:25] sc1
s_add_u32 s24, s24, 0x20000
s_addc_u32 s25, s25, 0
s_waitcnt lgkmcnt(2)
v_smfmac_f32_16x16x64_bf16 v[76:79], v[100:103], v[128:135], v1
v_smfmac_f32_16x16x64_bf16 v[80:83], v[100:103], v[136:143], v1
v_smfmac_f32_16x16x64_bf16 v[84:87], v[100:103], v[144:151], v1
v_smfmac_f32_16x16x64_bf16 v[88:91], v[100:103], v[152:159], v1
s_waitcnt lgkmcnt(1)
v_smfmac_f32_16x16x64_bf16 v[76:79], v[104:107], v[160:167], v1
v_smfmac_f32_16x16x64_bf16 v[80:83], v[104:107], v[168:175], v1
v_smfmac_f32_16x16x64_bf16 v[84:87], v[104:107], v[176:183], v1
v_smfmac_f32_16x16x64_bf16 v[88:91], v[104:107], v[184:191], v1
s_waitcnt lgkmcnt(0)
v_smfmac_f32_16x16x64_bf16 v[76:79], v[108:111], v[192:199], v1
v_smfmac_f32_16x16x64_bf16 v[80:83], v[108:111], v[200:207], v1
v_smfmac_f32_16x16x64_bf16 v[84:87], v[108:111], v[208:215], v1
v_smfmac_f32_16x16x64_bf16 v[88:91], v[108:111], v[216:223], v1
v_cvt_pk_bf16_f32 v76, v76, v77
v_cvt_pk_bf16_f32 v77, v78, v79
v_cvt_pk_bf16_f32 v78, v80, v81
v_cvt_pk_bf16_f32 v79, v82, v83
global_store_dwordx4 v120, v[76:79], s[24:25] sc1
s_add_u32 s24, s24, 0x20000
s_addc_u32 s25, s25, 0
v_cvt_pk_bf16_f32 v84, v84, v85
v_cvt_pk_bf16_f32 v85, v86, v87
v_cvt_pk_bf16_f32 v86, v88, v89
v_cvt_pk_bf16_f32 v87, v90, v91
global_store_dwordx4 v120, v[84:87], s[24:25] sc1
s_add_u32 s24, s24, 0x20000
s_addc_u32 s25, s25, 0
v_and_b32 v26, 15, v0
v_lshrrev_b32 v27, 4, v0
v_and_b32 v122, 3, v26
v_lshlrev_b32 v122, 2, v122
v_lshrrev_b32 v123, 2, v26
v_add_u32 v124, v122, v123
v_mov_b32 v122, 0x3f80
v_mov_b32 v123, 0x3f800000
v_cmp_eq_u32 vcc, 0, v124
s_nop 1
v_cndmask_b32 v20, 0, v122, vcc
v_cmp_eq_u32 vcc, 1, v124
s_nop 1
v_cndmask_b32 v20, v20, v123, vcc
v_cmp_eq_u32 vcc, 2, v124
s_nop 1
v_cndmask_b32 v21, 0, v122, vcc
v_cmp_eq_u32 vcc, 3, v124
s_nop 1
v_cndmask_b32 v21, v21, v123, vcc
v_cmp_eq_u32 vcc, 4, v124
s_nop 1
v_cndmask_b32 v22, 0, v122, vcc
v_cmp_eq_u32 vcc, 5, v124
s_nop 1
v_cndmask_b32 v22, v22, v123, vcc
v_cmp_eq_u32 vcc, 6, v124
s_nop 1
v_cndmask_b32 v23, 0, v122, vcc
v_cmp_eq_u32 vcc, 7, v124
s_nop 1
v_cndmask_b32 v23, v23, v123, vcc
s_and_b32 s17, s11, 3
s_lshl_b32 s15, s17, 16
s_lshl_b32 s16, s10, 14
s_add_u32 s15, s15, s16
s_lshr_b32 s16, s11, 3
s_lshl_b32 s16, s16, 18
s_add_u32 s15, s15, s16
s_bfe_u32 s16, s11, 0x10002
s_lshl_b32 s16, s16, 11
s_add_u32 s15, s15, s16
s_xor_b32 s37, s37, 0x100000
s_add_u32 s28, s28, s15
s_addc_u32 s29, s29, 0
v_and_b32 v122, 3, v26
v_lshlrev_b32 v122, 2, v122
v_lshl_add_u32 v122, v27, 4, v122
v_lshrrev_b32 v123, 2, v26
v_lshl_add_u32 v25, v123, 7, v122
s_lshl_b32 s14, s36, 15
s_lshr_b32 s15, s15, 5
s_add_u32 s15, s15, s14
s_lshl_b32 s16, s13, 21
s_add_u32 s15, s15, s16
s_add_u32 s24, s8, s15
s_addc_u32 s25, s9, 0
s_add_u32 s24, s24, 0xe00000
s_addc_u32 s25, s25, 0
global_load_dword v25, v25, s[24:25] sc1
s_cmp_eq_u32 s13, 0
s_cbranch_scc0 Sw_B_o1
v_lshl_add_u32 v24, v123, 8, v122
s_lshl_b32 s15, s17, 13
s_lshr_b32 s16, s11, 4
s_lshl_b32 s16, s16, 12
s_add_u32 s15, s15, s16
s_lshl_b32 s16, s10, 10
s_add_u32 s15, s15, s16
s_bfe_u32 s16, s11, 0x20002
s_lshl_b32 s16, s16, 6
s_add_u32 s15, s15, s16
s_add_u32 s15, s15, s14
s_add_u32 s26, s8, s15
s_addc_u32 s27, s9, 0
s_add_u32 s26, s26, 0x1200000
s_addc_u32 s27, s27, 0
s_branch Sw_B_o2
Sw_B_o1:
v_lshlrev_b32 v24, 10, v27
v_lshl_add_u32 v24, v26, 2, v24
s_lshr_b32 s15, s11, 2
s_lshl_b32 s15, s15, 12
s_lshl_b32 s16, s17, 8
s_add_u32 s15, s15, s16
s_lshl_b32 s16, s10, 6
s_add_u32 s15, s15, s16
s_add_u32 s15, s15, s14
s_add_u32 s26, s6, s15
s_addc_u32 s27, s7, 0
Sw_B_o2:
s_add_u32 s18, s18, 1
s_waitcnt vmcnt(0)
s_barrier
s_cmp_eq_u32 s10, 0
s_cbranch_scc0 Sw_B_g2_d
s_lshl_b32 s22, s12, 8
s_add_u32 s20, s8, s22
s_addc_u32 s21, s9, 0
s_add_u32 s20, s20, 0x1000
s_addc_u32 s21, s21, 0
v_mov_b32 v127, s18
v_and_b32 v126, 31, v0
v_lshlrev_b32 v126, 2, v126
v_cmp_eq_u32 vcc, s11, v0
s_mov_b64 exec, vcc
global_store_dword v126, v127, s[20:21] sc1
s_mov_b64 exec, -1
s_mov_b32 s19, 0
Sw_B_g2_p:
global_load_dword v127, v126, s[20:21] sc1
s_add_u32 s19, s19, 1
s_cmp_gt_u32 s19, 400000
s_cbranch_scc1 KB_fail
s_waitcnt vmcnt(0)
v_cmp_gt_u32 vcc, s18, v127
s_cbranch_vccnz Sw_B_g2_p
Sw_B_g2_d:
s_barrier
global_load_dwordx4 v[28:31], v4, s[28:29] offset:0 sc1
global_load_dwordx4 v[32:35], v4, s[28:29] offset:1024 sc1
s_add_u32 s28, s28, 0x1000
s_addc_u32 s29, s29, 0
global_load_dwordx4 v[36:39], v4, s[28:29] offset:0 sc1
global_load_dwordx4 v[40:43], v4, s[28:29] offset:1024 sc1
s_add_u32 s28, s28, 0x1000
s_addc_u32 s29, s29, 0
global_load_dwordx4 v[44:47], v4, s[28:29] offset:0 sc1
global_load_dwordx4 v[48:51], v4, s[28:29] offset:1024 sc1
s_add_u32 s28, s28, 0x1000
s_addc_u32 s29, s29, 0
global_load_dwordx4 v[52:55], v4, s[28:29] offset:0 sc1
global_load_dwordx4 v[56:59], v4, s[28:29] offset:1024 sc1
s_add_u32 s17, s36, 7
s_min_u32 s17, s17, 63
s_cmp_lt_u32 s36, 57
s_cselect_b64 exec, -1, 0
s_lshl_b32 s14, s17, 5
s_add_u32 s14, s14, s11
s_lshl_b32 s14, s14, 2
s_add_u32 s14, s14, s10
s_lshl_b32 s15, s14, 11
s_lshl_b32 s14, s14, 12
s_mul_i32 s16, s13, 0x2400000
s_add_u32 s14, s14, s16
s_add_u32 s28, s8, s14
s_addc_u32 s29, s9, 0
s_add_u32 s28, s28, 0x4000000
s_addc_u32 s29, s29, 0
s_add_u32 s30, s8, s15
s_addc_u32 s31, s9, 0
s_add_u32 s30, s30, 0x2800000
s_addc_u32 s31, s31, 0
global_load_dwordx4 v[96:99], v4, s[30:31] offset:0 sc1
global_load_dwordx4 v[100:103], v4, s[30:31] offset:1024 sc1
global_load_dwordx4 v[104:107], v4, s[28:29] offset:0 sc1
global_load_dwordx4 v[108:111], v4, s[28:29] offset:1024 sc1
global_load_dwordx4 v[112:115], v4, s[28:29] offset:2048 sc1
global_load_dwordx4 v[116:119], v4, s[28:29] offset:3072 sc1
s_mov_b64 exec, -1
s_waitcnt vmcnt(13)
v_mfma_f32_16x16x32_bf16 v[64:67], v[20:23], v[28:31], 0
s_waitcnt vmcnt(12)
v_mfma_f32_16x16x32_bf16 v[64:67], v[20:23], v[32:35], v[64:67]
s_waitcnt vmcnt(11)
v_mfma_f32_16x16x32_bf16 v[68:71], v[20:23], v[36:39], 0
s_waitcnt vmcnt(10)
v_mfma_f32_16x16x32_bf16 v[68:71], v[20:23], v[40:43], v[68:71]
s_waitcnt vmcnt(9)
v_mfma_f32_16x16x32_bf16 v[72:75], v[20:23], v[44:47], 0
s_waitcnt vmcnt(8)
v_mfma_f32_16x16x32_bf16 v[72:75], v[20:23], v[48:51], v[72:75]
s_waitcnt vmcnt(7)
v_mfma_f32_16x16x32_bf16 v[76:79], v[20:23], v[52:55], 0
s_waitcnt vmcnt(6)
v_mfma_f32_16x16x32_bf16 v[76:79], v[20:23], v[56:59], v[76:79]
v_add_f32_dpp v64, v64, v64 row_ror:8 row_mask:0xf bank_mask:0xf
v_add_f32_dpp v65, v65, v65 row_ror:8 row_mask:0xf bank_mask:0xf
v_add_f32_dpp v68, v68, v68 row_ror:8 row_mask:0xf bank_mask:0xf
v_add_f32_dpp v69, v69, v69 row_ror:8 row_mask:0xf bank_mask:0xf
v_add_f32_dpp v72, v72, v72 row_ror:8 row_mask:0xf bank_mask:0xf
v_add_f32_dpp v73, v73, v73 row_ror:8 row_mask:0xf bank_mask:0xf
s_nop 1
v_add_f32_dpp v76, v76, v76 row_ror:8 row_mask:0xf bank_mask:0xf
v_add_f32_dpp v77, v77, v77 row_ror:8 row_mask:0xf bank_mask:0xf
v_add_f32_dpp v80, v64, v64 row_ror:4 row_mask:0xf bank_mask:0x1
v_add_f32_dpp v81, v65, v65 row_ror:4 row_mask:0xf bank_mask:0x1
s_nop 0
v_add_f32_dpp v80, v68, v68 row_ror:4 row_mask:0xf bank_mask:0x2
v_add_f32_dpp v81, v69, v69 row_ror:4 row_mask:0xf bank_mask:0x2
s_nop 0
v_add_f32_dpp v80, v72, v72 row_ror:4 row_mask:0xf bank_mask:0x4
v_add_f32_dpp v81, v73, v73 row_ror:4 row_mask:0xf bank_mask:0x4
s_nop 0
v_add_f32_dpp v80, v76, v76 row_ror:4 row_mask:0xf bank_mask:0x8
v_add_f32_dpp v81, v77, v77 row_ror:4 row_mask:0xf bank_mask:0x8
v_cvt_pk_bf16_f32 v80, v80, v81
v_lshlrev_b32 v82, 16, v80
v_and_b32 v83, 0xffff0000, v80
v_lshlrev_b32 v84, 16, v25
v_and_b32 v85, 0xffff0000, v25
v_pk_add_f32 v[82:83], v[82:83], v[84:85]
v_cvt_pk_bf16_f32 v80, v82, v83
global_store_dword v24, v80, s[26:27] sc1
s_cmp_eq_u32 s13, 0
s_cbranch_scc0 Sw_B_e
v_lshlrev_b32 v90, 4, v0
s_lshl_b32 s14, s11, 14
s_lshl_b32 s15, s10, 12
s_add_u32 s14, s14, s15
s_add_u32 s20, s8, s14
s_addc_u32 s21, s9, 0
s_add_u32 s20, s20, 0x200000
s_addc_u32 s21, s21, 0
global_load_dwordx4 v[8:11], v90, s[20:21] offset:0
global_load_dwordx4 v[12:15], v90, s[20:21] offset:1024
global_load_dwordx4 v[16:19], v90, s[20:21] offset:2048
global_load_dwordx4 v[20:23], v90, s[20:21] offset:3072
v_and_b32 v68, 15, v0
v_lshrrev_b32 v69, 4, v0
v_lshlrev_b32 v1, 10, v68
v_lshl_add_u32 v1, v69, 4, v1
s_lshl_b32 s14, s10, 8
v_add_u32 v1, s14, v1
v_lshlrev_b32 v70, 4, v0
s_lshl_b32 s14, s10, 11
v_add_u32 v2, s14, v70
s_lshl_b32 s14, s10, 2
v_add_u32 v3, s14, v70
v_and_b32 v70, 1, v69
v_lshlrev_b32 v4, 10, v70
v_lshl_add_u32 v4, v68, 4, v4
s_lshl_b32 s14, s10, 8
v_add_u32 v4, s14, v4
v_lshlrev_b32 v5, 9, v70
v_lshl_add_u32 v5, v68, 4, v5
v_lshrrev_b32 v70, 5, v0
v_lshl_add_u32 v4, v70, 3, v4
v_lshlrev_b32 v6, 13, v70
v_and_b32 v70, 31, v0
v_lshl_add_u32 v6, v70, 2, v6
s_lshl_b32 s14, s10, 14
v_add_u32 v6, s14, v6
v_mov_b32 v7, 0x3f803f80
s_lshl_b32 s14, s36, 15
s_lshl_b32 s15, s10, 13
s_add_u32 s14, s14, s15
s_add_u32 s24, s8, s14
s_addc_u32 s25, s9, 0
s_add_u32 s24, s24, 0x1201000
s_addc_u32 s25, s25, 0
s_lshl_b32 s14, s11, 16
s_lshl_b32 s15, s36, 7
s_add_u32 s14, s14, s15
s_add_u32 s28, s8, s14
s_addc_u32 s29, s9, 0
s_add_u32 s28, s28, 0x800000
s_addc_u32 s29, s29, 0
s_add_u32 s18, s18, 1
s_waitcnt vmcnt(0)
s_barrier
s_cmp_eq_u32 s10, 0
s_cbranch_scc0 Sw_B_g3_d
s_lshl_b32 s22, s12, 8
s_add_u32 s20, s8, s22
s_addc_u32 s21, s9, 0
s_add_u32 s20, s20, 0x1000
s_addc_u32 s21, s21, 0
v_mov_b32 v127, s18
v_and_b32 v126, 31, v0
v_lshlrev_b32 v126, 2, v126
v_cmp_eq_u32 vcc, s11, v0
s_mov_b64 exec, vcc
global_store_dword v126, v127, s[20:21] sc1
s_mov_b64 exec, -1
s_mov_b32 s19, 0
Sw_B_g3_p:
global_load_dword v127, v126, s[20:21] sc1
s_add_u32 s19, s19, 1
s_cmp_gt_u32 s19, 400000
s_cbranch_scc1 KB_fail
s_waitcnt vmcnt(0)
v_cmp_gt_u32 vcc, s18, v127
s_cbranch_vccnz Sw_B_g3_p
Sw_B_g3_d:
s_barrier
global_load_dwordx4 v[24:27], v90, s[24:25] offset:-4096 sc1
global_load_dwordx4 v[40:43], v90, s[24:25] offset:0 sc1
global_load_dwordx4 v[28:31], v90, s[24:25] offset:-3072 sc1
global_load_dwordx4 v[44:47], v90, s[24:25] offset:1024 sc1
global_load_dwordx4 v[32:35], v90, s[24:25] offset:-2048 sc1
global_load_dwordx4 v[48:51], v90, s[24:25] offset:2048 sc1
global_load_dwordx4 v[36:39], v90, s[24:25] offset:-1024 sc1
global_load_dwordx4 v[52:55], v90, s[24:25] offset:3072 sc1
v_mov_b32 v64, 0
v_mov_b32 v65, 0
v_mov_b32 v66, 0
v_mov_b32 v67, 0
s_waitcnt vmcnt(7)
v_mfma_f32_16x16x32_bf16 v[56:59], v[8:11], v[24:27], 0
v_dot2c_f32_bf16 v64, v24, v7
v_dot2c_f32_bf16 v66, v24, v24
v_dot2c_f32_bf16 v64, v25, v7
v_dot2c_f32_bf16 v66, v25, v25
v_dot2c_f32_bf16 v64, v26, v7
v_dot2c_f32_bf16 v66, v26, v26
v_dot2c_f32_bf16 v64, v27, v7
v_dot2c_f32_bf16 v66, v27, v27
s_waitcnt vmcnt(6)
v_mfma_f32_16x16x32_bf16 v[60:63], v[8:11], v[40:43], 0
v_dot2c_f32_bf16 v65, v40, v7
v_dot2c_f32_bf16 v67, v40, v40
v_dot2c_f32_bf16 v65, v41, v7
v_dot2c_f32_bf16 v67, v41, v41
v_dot2c_f32_bf16 v65, v42, v7
v_dot2c_f32_bf16 v67, v42, v42
v_dot2c_f32_bf16 v65, v43, v7
v_dot2c_f32_bf16 v67, v43, v43
s_waitcnt vmcnt(5)
v_mfma_f32_16x16x32_bf16 v[56:59], v[12:15], v[28:31], v[56:59]
v_dot2c_f32_bf16 v64, v28, v7
v_dot2c_f32_bf16 v66, v28, v28
v_dot2c_f32_bf16 v64, v29, v7
v_dot2c_f32_bf16 v66, v29, v29
v_dot2c_f32_bf16 v64, v30, v7
v_dot2c_f32_bf16 v66, v30, v30
v_dot2c_f32_bf16 v64, v31, v7
v_dot2c_f32_bf16 v66, v31, v31
s_waitcnt vmcnt(4)
v_mfma_f32_16x16x32_bf16 v[60:63], v[12:15], v[44:47], v[60:63]
v_dot2c_f32_bf16 v65, v44, v7
v_dot2c_f32_bf16 v67, v44, v44
v_dot2c_f32_bf16 v65, v45, v7
v_dot2c_f32_bf16 v67, v45, v45
v_dot2c_f32_bf16 v65, v46, v7
v_dot2c_f32_bf16 v67, v46, v46
v_dot2c_f32_bf16 v65, v47, v7
v_dot2c_f32_bf16 v67, v47, v47
s_waitcnt vmcnt(3)
v_mfma_f32_16x16x32_bf16 v[56:59], v[16:19], v[32:35], v[56:59]
v_dot2c_f32_bf16 v64, v32, v7
v_dot2c_f32_bf16 v66, v32, v32
v_dot2c_f32_bf16 v64, v33, v7
v_dot2c_f32_bf16 v66, v33, v33
v_dot2c_f32_bf16 v64, v34, v7
v_dot2c_f32_bf16 v66, v34, v34
v_dot2c_f32_bf16 v64, v35, v7
v_dot2c_f32_bf16 v66, v35, v35
s_waitcnt vmcnt(2)
v_mfma_f32_16x16x32_bf16 v[60:63], v[16:19], v[48:51], v[60:63]
v_dot2c_f32_bf16 v65, v48, v7
v_dot2c_f32_bf16 v67, v48, v48
v_dot2c_f32_bf16 v65, v49, v7
v_dot2c_f32_bf16 v67, v49, v49
v_dot2c_f32_bf16 v65, v50, v7
v_dot2c_f32_bf16 v67, v50, v50
v_dot2c_f32_bf16 v65, v51, v7
v_dot2c_f32_bf16 v67, v51, v51
s_waitcnt vmcnt(1)
v_mfma_f32_16x16x32_bf16 v[56:59], v[20:23], v[36:39], v[56:59]
v_dot2c_f32_bf16 v64, v36, v7
v_dot2c_f32_bf16 v66, v36, v36
v_dot2c_f32_bf16 v64, v37, v7
v_dot2c_f32_bf16 v66, v37, v37
v_dot2c_f32_bf16 v64, v38, v7
v_dot2c_f32_bf16 v66, v38, v38
v_dot2c_f32_bf16 v64, v39, v7
v_dot2c_f32_bf16 v66, v39, v39
s_waitcnt vmcnt(0)
v_mfma_f32_16x16x32_bf16 v[60:63], v[20:23], v[52:55], v[60:63]
v_dot2c_f32_bf16 v65, v52, v7
v_dot2c_f32_bf16 v67, v52, v52
v_dot2c_f32_bf16 v65, v53, v7
v_dot2c_f32_bf16 v67, v53, v53
v_dot2c_f32_bf16 v65, v54, v7
v_dot2c_f32_bf16 v67, v54, v54
v_dot2c_f32_bf16 v65, v55, v7
v_dot2c_f32_bf16 v67, v55, v55
ds_write_b128 v2, v[56:59] offset:0
ds_write_b128 v2, v[60:63] offset:1024
v_permlane32_swap_b32 v64, v65
v_permlane32_swap_b32 v66, v67
v_add_f32 v64, v64, v65
v_add_f32 v66, v66, v67
s_nop 1
v_permlane16_swap_b32 v64, v66
v_add_f32 v64, v64, v66
ds_write_b32 v3, v64 offset:8192
s_waitcnt lgkmcnt(0)
s_barrier
ds_read_b128 v[76:79], v5 offset:8192
ds_read_b128 v[80:83], v5 offset:8448
ds_read_b64 v[68:69], v4 offset:0
ds_read_b64 v[70:71], v4 offset:2048
ds_read_b64 v[72:73], v4 offset:4096
ds_read_b64 v[74:75], v4 offset:6144
s_waitcnt lgkmcnt(4)
v_pk_add_f32 v[76:77], v[76:77], v[78:79]
v_pk_add_f32 v[80:81], v[80:81], v[82:83]
v_add_f32 v76, v76, v77
v_add_f32 v80, v80, v81
v_mul_f32 v76, 0x3b000000, v76
v_mul_f32 v80, 0x3b000000, v80
v_fma_f32 v80, -v76, v76, v80
v_max_f32 v80, 0, v80
v_add_f32 v80, 0x3727c5ac, v80
v_rsq_f32 v80, v80
s_waitcnt lgkmcnt(0)
s_barrier
v_pk_add_f32 v[68:69], v[68:69], v[70:71]
v_pk_add_f32 v[72:73], v[72:73], v[74:75]
v_pk_add_f32 v[68:69], v[68:69], v[72:73]
v_pk_mul_f32 v[68:69], v[68:69], v[80:81] op_sel_hi:[1,0]
v_cvt_pk_bf16_f32 v68, v68, v69
global_store_dword v6, v68, s[28:29] sc1
s_lshl_b32 s14, s11, 6
s_add_u32 s14, s14, s36
s_waitcnt vmcnt(0)
s_barrier
s_cmp_eq_u32 s10, 0
s_cbranch_scc0 Sw_B_f
s_lshl_b32 s22, s14, 2
s_add_u32 s20, s8, s22
s_addc_u32 s21, s9, 0
s_add_u32 s20, s20, 0x5000
s_addc_u32 s21, s21, 0
s_add_u32 s22, s13, 1
v_mov_b32 v126, 0
v_mov_b32 v127, s22
s_mov_b64 exec, 1
global_store_dword v126, v127, s[20:21] sc1
s_mov_b64 exec, -1
Sw_B_f:
Sw_B_e:
s_add_u32 s36, s36, 7
s_cmp_lt_u32 s36, 64
s_cbranch_scc1 Sw_B
s_branch KB_next
KB_next:
s_add_u32 s13, s13, 1
s_cmp_lt_u32 s13, 2
s_cbranch_scc1 KB_layer
s_waitcnt vmcnt(0)
KB_end:
s_endpgm
KB_fail:
s_load_dwordx2 s[20:21], s[0:1], 88
s_mov_b64 exec, -1
v_mov_b32 v1, 0
v_mov_b32 v2, 1
s_waitcnt lgkmcnt(0)
global_atomic_add v1, v2, s[20:21]
s_waitcnt vmcnt(0)
s_endpgm

.section .rodata,"a"
.p2align 6
.amdhsa_kernel prep_kernel
  .amdhsa_next_free_vgpr 192
  .amdhsa_next_free_sgpr 102
  .amdhsa_accum_offset 192
  .amdhsa_group_segment_fixed_size 0
  .amdhsa_kernarg_size 104
  .amdhsa_user_sgpr_count 2
  .amdhsa_user_sgpr_kernarg_segment_ptr 1
  .amdhsa_system_sgpr_workgroup_id_x 1
  .amdhsa_float_denorm_mode_32 3
  .amdhsa_float_denorm_mode_16_64 3
.end_amdhsa_kernel
.p2align 6
.amdhsa_kernel main_kernel
  .amdhsa_next_free_vgpr 512
  .amdhsa_next_free_sgpr 102
  .amdhsa_accum_offset 256
  .amdhsa_group_segment_fixed_size 0
  .amdhsa_kernarg_size 104
  .amdhsa_user_sgpr_count 2
  .amdhsa_user_sgpr_kernarg_segment_ptr 1
  .amdhsa_system_sgpr_workgroup_id_x 1
  .amdhsa_float_denorm_mode_32 3
  .amdhsa_float_denorm_mode_16_64 3
.end_amdhsa_kernel
```
